```python
import torch

def _softmax(x, axis=-1):
    return torch.softmax(x, dim=axis)
def _gelu(x):
    return torch.nn.functional.gelu(x, approximate="tanh")
def _silu(x):
    return torch.nn.functional.silu(x)
def _sigmoid(x):
    return torch.sigmoid(x)
def _layernorm(x, axis=-1, eps=1e-5):
    m = x.mean(dim=axis, keepdim=True)
    v = x.var(dim=axis, keepdim=True, unbiased=False)
    return (x - m) / torch.sqrt(v + eps)
def _scatter_add(tgt, idx, src, axis=0):
    return tgt.clone().index_add_(axis, idx, src)
def _segment_sum(src, seg, n):
    out = torch.zeros((n,) + src.shape[1:], dtype=src.dtype)
    return out.index_add_(0, seg, src)
def _pad(x, pw):
    flat = tuple(v for pair in reversed(pw) for v in pair)
    return torch.nn.functional.pad(x, flat)

kernel_name = 'sequential_preLN__linear_attn_block__mixer_s_mlp__prompt'

def setup_inputs():

    _w = (lambda a: (lambda t: t.to(torch.bfloat16) if t.is_floating_point() else t)(torch.as_tensor(a)))
    def _A_setup():
        B, S, D = 1, 2048, 640
        return {
            "x": _w((lambda *s: torch.randn(*s, dtype=torch.bfloat16) * 0.05)(B, S, D)),
            "wqkv": _w((lambda *s: torch.randn(*s, dtype=torch.bfloat16) * 0.05)(D, 3 * D)),
            "wo": _w((lambda *s: torch.randn(*s, dtype=torch.bfloat16) * 0.05)(D, D)),
        }
    _A_in = _A_setup()

    def _B_setup():
        B, S, D, F = 1, 2048, 640, 1536
        return {
            "x":  _w((lambda *s: torch.randn(*s, dtype=torch.bfloat16) * 0.05)(B, S, D)),
            "w1": _w((lambda *s: torch.randn(*s, dtype=torch.bfloat16) * 3.2)(D, D) * (D ** -0.5)),
            "w2": _w((lambda *s: torch.randn(*s, dtype=torch.bfloat16) * 3.2)(D, D) * (D ** -0.5)),
            "w3": _w((lambda *s: torch.randn(*s, dtype=torch.bfloat16) * 3.2)(D, F) * (D ** -0.5)),
            "w4": _w((lambda *s: torch.randn(*s, dtype=torch.bfloat16) * 3.2)(F, D) * (F ** -0.5)),
        }
    _B_in = _B_setup()

    return {
        "A_x": _A_in["x"],
        "A_wqkv": _A_in["wqkv"],
        "A_wo": _A_in["wo"],
        "B_x": _B_in["x"],
        "B_w1": _B_in["w1"],
        "B_w2": _B_in["w2"],
        "B_w3": _B_in["w3"],
        "B_w4": _B_in["w4"],
    }

def reference(A_x, A_wqkv, A_wo, B_x, B_w1, B_w2, B_w3, B_w4):
    def _A_ref(x, wqkv, wo):
        B, S, D = x.shape
        H = 32; Dh = D // H
        qkv = (lambda x, *d: x.permute(*d))((x @ wqkv).reshape(B, S, 3, H, Dh), 2, 0, 3, 1, 4)
        q, k, v = qkv[0], qkv[1], qkv[2]
        phi = lambda t: torch.where(t > 0, t + 1, torch.exp(t)) + 1e-6
        pq, pk = phi(q), phi(k)
        kv = torch.einsum("bhsd,bhse->bhde", pk, v)
        z = torch.einsum("bhsd->bhd", pk)
        num = torch.einsum("bhqd,bhde->bhqe", pq, kv)
        den = torch.einsum("bhqd,bhd->bhq", pq, z)[..., None] + 1e-6
        o = num / den
        return (lambda x, *d: x.permute(*d))(o, 0, 2, 1, 3).reshape(B, S, D) @ wo

    def _B_ref(x, w1, w2, w3, w4):
        B, S, D = x.shape
        h = _gelu(_layernorm(x, axis=-1) @ w1)
        c = D // 4
        g0 = _pad(h[:, :, 0*c:1*c], ((0, 0), (1, 0), (0, 0)))[:, :S, :]
        g1 = _pad(h[:, :, 1*c:2*c], ((0, 0), (0, 1), (0, 0)))[:, 1:, :]
        g2 = _pad(h[:, :, 2*c:3*c], ((0, 0), (2, 0), (0, 0)))[:, :S, :]
        g3 = _pad(h[:, :, 3*c:   ], ((0, 0), (0, 2), (0, 0)))[:, 2:, :]
        hs = torch.concatenate([g0, g1, g2, g3], axis=-1) @ w2
        x1 = x + hs
        h2 = _gelu(_layernorm(x1, axis=-1) @ w3) @ w4
        return x1 + h2

    x = A_x
    h = x + _A_ref(_layernorm(x, axis=-1), A_wqkv, A_wo)
    h2 = h + _B_ref(_layernorm(h, axis=-1), B_w1, B_w2, B_w3, B_w4)
    return h2
```

```asm
; @launch kernel=prep_kernel grid=(1960,1,1) block=(256,1,1) lds=0
; @launch kernel=qq_kernel grid=(128,1,1) block=(320,1,1) lds=81920
; @launch kernel=kv_kernel grid=(256,1,1) block=(320,1,1) lds=81920
; @launch kernel=red_kernel grid=(32,1,1) block=(640,1,1) lds=2048
; @launch kernel=attn_kernel grid=(256,1,1) block=(320,1,1) lds=81920
; @launch kernel=mix1_kernel grid=(256,1,1) block=(320,1,1) lds=81920
; @launch kernel=mix2_kernel grid=(256,1,1) block=(320,1,1) lds=81920
; @launch kernel=mlp1_kernel grid=(512,1,1) block=(384,1,1) lds=81920
; @launch kernel=mlp2_kernel grid=(256,1,1) block=(320,1,1) lds=98304
.amdgcn_target "amdgcn-amd-amdhsa--gfx950"
.text
.globl prep_kernel
.p2align 8
.type prep_kernel,@function
prep_kernel:
    s_cmp_ge_u32 s2, 1960
    s_cbranch_scc1 prep_done
    s_load_dwordx2 s[4:5], s[0:1], 80
    s_cmp_ge_u32 s2, 600
    s_cbranch_scc1 prep_s1
    s_load_dwordx2 s[6:7], s[0:1], 8
    s_sub_u32 s3, s2, 0
    s_mov_b32 s20, 3840
    s_mov_b32 s21, 20
    s_mov_b32 s22, 214748365
    s_mov_b32 s23, 0
    s_mov_b32 s24, 2457600
    s_mov_b32 s25, 1
    s_branch prep_go
prep_s1:
    s_cmp_ge_u32 s2, 800
    s_cbranch_scc1 prep_s2
    s_load_dwordx2 s[6:7], s[0:1], 32
    s_sub_u32 s3, s2, 600
    s_mov_b32 s20, 1280
    s_mov_b32 s21, 20
    s_mov_b32 s22, 214748365
    s_mov_b32 s23, 2457600
    s_mov_b32 s24, 819200
    s_mov_b32 s25, 0
    s_branch prep_go
prep_s2:
    s_cmp_ge_u32 s2, 1000
    s_cbranch_scc1 prep_s3
    s_load_dwordx2 s[6:7], s[0:1], 40
    s_sub_u32 s3, s2, 800
    s_mov_b32 s20, 1280
    s_mov_b32 s21, 20
    s_mov_b32 s22, 214748365
    s_mov_b32 s23, 3276800
    s_mov_b32 s24, 819200
    s_mov_b32 s25, 0
    s_branch prep_go
prep_s3:
    s_cmp_ge_u32 s2, 1480
    s_cbranch_scc1 prep_s4
    s_load_dwordx2 s[6:7], s[0:1], 48
    s_sub_u32 s3, s2, 1000
    s_mov_b32 s20, 3072
    s_mov_b32 s21, 20
    s_mov_b32 s22, 214748365
    s_mov_b32 s23, 4096000
    s_mov_b32 s24, 1966080
    s_mov_b32 s25, 0
    s_branch prep_go
prep_s4:
    s_cmp_ge_u32 s2, 1960
    s_cbranch_scc1 prep_s5
    s_load_dwordx2 s[6:7], s[0:1], 56
    s_sub_u32 s3, s2, 1480
    s_mov_b32 s20, 1280
    s_mov_b32 s21, 48
    s_mov_b32 s22, 89478486
    s_mov_b32 s23, 6062080
    s_mov_b32 s24, 1966080
    s_mov_b32 s25, 0
    s_branch prep_go
prep_s5:
    s_endpgm
prep_go:
    s_waitcnt lgkmcnt(0)
    s_mov_b32 s8, s6
    s_and_b32 s9, s7, 0xffff
    s_mov_b32 s10, s24
    s_mov_b32 s11, 0x00020000
    s_add_u32 s12, s4, s23
    s_addc_u32 s13, s5, 0
    s_and_b32 s13, s13, 0xffff
    s_mov_b32 s14, s24
    s_mov_b32 s15, 0x00020000
    s_lshl_b32 s16, s3, 2
    v_lshrrev_b32 v1, 6, v0
    v_add_u32 v1, s16, v1
    v_mul_hi_u32 v2, v1, s22
    v_mul_lo_u32 v3, v2, s21
    v_sub_u32 v3, v1, v3
    v_and_b32 v4, 15, v0
    v_lshl_add_u32 v4, v2, 4, v4
    v_bfe_u32 v5, v0, 4, 2
    v_lshlrev_b32 v5, 3, v5
    v_lshl_add_u32 v5, v3, 5, v5
    s_cmp_eq_u32 s25, 0
    s_cbranch_scc1 prep_nomap
    v_subrev_u32 v6, 640, v4
    s_mov_b32 s26, 26843546
    v_mul_hi_u32 v7, v6, s26
    v_mul_u32_u24 v8, 160, v7
    v_sub_u32 v8, v6, v8
    v_mul_u32_u24 v9, 80, v7
    v_add_u32 v9, v9, v8
    v_add_u32 v9, 640, v9
    v_add_u32 v10, 560, v9
    v_cmp_gt_u32 vcc, 80, v8
    s_nop 1
    v_cndmask_b32 v9, v10, v9, vcc
    v_cmp_gt_u32 vcc, 640, v4
    s_nop 1
    v_cndmask_b32 v4, v9, v4, vcc
prep_nomap:
    v_mul_lo_u32 v6, v5, s20
    v_lshl_add_u32 v6, v4, 1, v6
    buffer_load_ushort v16, v6, s[8:11], 0 offen
    v_add_u32 v6, s20, v6
    buffer_load_ushort v17, v6, s[8:11], 0 offen
    v_add_u32 v6, s20, v6
    buffer_load_ushort v18, v6, s[8:11], 0 offen
    v_add_u32 v6, s20, v6
    buffer_load_ushort v19, v6, s[8:11], 0 offen
    v_add_u32 v6, s20, v6
    buffer_load_ushort v20, v6, s[8:11], 0 offen
    v_add_u32 v6, s20, v6
    buffer_load_ushort v21, v6, s[8:11], 0 offen
    v_add_u32 v6, s20, v6
    buffer_load_ushort v22, v6, s[8:11], 0 offen
    v_add_u32 v6, s20, v6
    buffer_load_ushort v23, v6, s[8:11], 0 offen
    v_add_u32 v6, s20, v6
    v_lshlrev_b32 v7, 4, v0
    s_lshl_b32 s16, s3, 12
    v_add_u32 v7, s16, v7
    s_waitcnt vmcnt(0)
    v_lshl_or_b32 v24, v17, 16, v16
    v_lshl_or_b32 v25, v19, 16, v18
    v_lshl_or_b32 v26, v21, 16, v20
    v_lshl_or_b32 v27, v23, 16, v22
    buffer_store_dwordx4 v[24:27], v7, s[12:15], 0 offen
prep_done:
    s_endpgm
.globl qq_kernel
.p2align 8
.type qq_kernel,@function
qq_kernel:
    s_cmp_ge_u32 s2, 128
    s_cbranch_scc1 qq_k_done
    s_load_dwordx2 s[4:5], s[0:1], 80
    s_load_dwordx2 s[6:7], s[0:1], 0
    s_load_dwordx2 s[28:29], s[0:1], 64
    s_mul_hi_u32 s30, s2, 1073741825
    s_mul_i32 s31, s30, 4
    s_sub_u32 s31, s2, s31
    v_lshrrev_b32 v1, 6, v0
    s_nop 0
    v_readfirstlane_b32 s32, v1
    v_and_b32 v1, 63, v0
    s_waitcnt lgkmcnt(0)
    s_mov_b32 s8, s4
    s_mov_b32 s9, s5
    s_and_b32 s9, s9, 0xffff
    s_mov_b32 s10, 268435456
    s_mov_b32 s11, 0x00020000
    s_mov_b32 s12, s6
    s_mov_b32 s13, s7
    s_and_b32 s13, s13, 0xffff
    s_mov_b32 s14, 2621440
    s_mov_b32 s15, 0x00020000
    s_mov_b32 s16, s28
    s_mov_b32 s17, s29
    s_and_b32 s17, s17, 0xffff
    s_mov_b32 s18, 2621440
    s_mov_b32 s19, 0x00020000
    s_mul_i32 s33, s31, 5
    s_add_u32 s33, s33, s32
    s_mul_i32 s33, s33, 40960
    s_add_u32 s33, s33, 0
    v_lshlrev_b32 v2, 4, v1
    s_add_u32 s34, s33, 0
    buffer_load_dwordx4 v[14:17], v2, s[8:11], s34 offen
    s_add_u32 s34, s33, 20480
    buffer_load_dwordx4 v[18:21], v2, s[8:11], s34 offen
    s_add_u32 s34, s33, 1024
    buffer_load_dwordx4 v[22:25], v2, s[8:11], s34 offen
    s_add_u32 s34, s33, 21504
    buffer_load_dwordx4 v[26:29], v2, s[8:11], s34 offen
    s_add_u32 s34, s33, 2048
    buffer_load_dwordx4 v[30:33], v2, s[8:11], s34 offen
    s_add_u32 s34, s33, 22528
    buffer_load_dwordx4 v[34:37], v2, s[8:11], s34 offen
    s_add_u32 s34, s33, 3072
    buffer_load_dwordx4 v[38:41], v2, s[8:11], s34 offen
    s_add_u32 s34, s33, 23552
    buffer_load_dwordx4 v[42:45], v2, s[8:11], s34 offen
    s_add_u32 s34, s33, 4096
    buffer_load_dwordx4 v[46:49], v2, s[8:11], s34 offen
    s_add_u32 s34, s33, 24576
    buffer_load_dwordx4 v[50:53], v2, s[8:11], s34 offen
    s_add_u32 s34, s33, 5120
    buffer_load_dwordx4 v[54:57], v2, s[8:11], s34 offen
    s_add_u32 s34, s33, 25600
    buffer_load_dwordx4 v[58:61], v2, s[8:11], s34 offen
    s_add_u32 s34, s33, 6144
    buffer_load_dwordx4 v[62:65], v2, s[8:11], s34 offen
    s_add_u32 s34, s33, 26624
    buffer_load_dwordx4 v[66:69], v2, s[8:11], s34 offen
    s_add_u32 s34, s33, 7168
    buffer_load_dwordx4 v[70:73], v2, s[8:11], s34 offen
    s_add_u32 s34, s33, 27648
    buffer_load_dwordx4 v[74:77], v2, s[8:11], s34 offen
    v_and_b32 v3, 15, v1
    v_lshrrev_b32 v4, 4, v1
    s_lshl_b32 s35, s30, 6
    v_add_u32 v5, s35, v3
    s_mov_b32 s36, 1280
    v_mul_lo_u32 v5, v5, s36
    s_mul_i32 s36, s31, 320
    s_mul_i32 s37, s32, 64
    s_add_u32 s36, s36, s37
    v_lshl_add_u32 v5, v4, 3, v5
    v_add_u32 v5, s36, v5
    v_and_b32 v6, 7, v1
    v_xor_b32 v7, v4, v6
    v_or_b32 v6, 4, v4
    v_and_b32 v3, 7, v1
    v_xor_b32 v6, v6, v3
    v_and_b32 v3, 15, v1
    v_mul_u32_u24 v3, 1280, v3
    v_lshl_add_u32 v7, v7, 4, v3
    v_lshl_add_u32 v6, v6, 4, v3
    v_mov_b32 v78, 0
    v_mov_b32 v79, 0
    v_mov_b32 v80, 0
    v_mov_b32 v81, 0
    v_mov_b32 v82, 0
    v_mov_b32 v83, 0
    v_mov_b32 v84, 0
    v_mov_b32 v85, 0
    v_mov_b32 v86, 0
    v_mov_b32 v87, 0
    v_mov_b32 v88, 0
    v_mov_b32 v89, 0
    v_mov_b32 v90, 0
    v_mov_b32 v91, 0
    v_mov_b32 v92, 0
    v_mov_b32 v93, 0
    v_mov_b32 v94, 0
    v_mov_b32 v95, 0
    v_mov_b32 v96, 0
    v_mov_b32 v97, 0
    v_mov_b32 v98, 0
    v_mov_b32 v99, 0
    v_mov_b32 v100, 0
    v_mov_b32 v101, 0
    v_mov_b32 v102, 0
    v_mov_b32 v103, 0
    v_mov_b32 v104, 0
    v_mov_b32 v105, 0
    v_mov_b32 v106, 0
    v_mov_b32 v107, 0
    v_mov_b32 v108, 0
    v_mov_b32 v109, 0
    s_cmp_ge_u32 s32, 4
    s_cbranch_scc1 qq_k_psk0
    v_and_b32 v3, 15, v1
    s_lshl_b32 s34, s32, 4
    s_add_u32 s34, s34, s35
    v_add_u32 v8, s34, v4
    s_mov_b32 s34, 1280
    v_mul_lo_u32 v8, v8, s34
    v_lshl_add_u32 v8, v3, 4, v8
    s_lshl_b32 s34, s32, 4
    v_add_u32 v9, s34, v4
    v_mul_u32_u24 v9, 1280, v9
    s_mov_b32 s34, 0
    buffer_load_dwordx4 v[110:113], v8, s[12:15], s34 offen
    s_mov_b32 s34, 256
    buffer_load_dwordx4 v[114:117], v8, s[12:15], s34 offen
    s_mov_b32 s34, 512
    buffer_load_dwordx4 v[118:121], v8, s[12:15], s34 offen
    s_mov_b32 s34, 768
    buffer_load_dwordx4 v[122:125], v8, s[12:15], s34 offen
    s_mov_b32 s34, 1024
    buffer_load_dwordx4 v[126:129], v8, s[12:15], s34 offen
    s_mov_b32 s34, 5120
    buffer_load_dwordx4 v[130:133], v8, s[12:15], s34 offen
    s_mov_b32 s34, 5376
    buffer_load_dwordx4 v[134:137], v8, s[12:15], s34 offen
    s_mov_b32 s34, 5632
    buffer_load_dwordx4 v[138:141], v8, s[12:15], s34 offen
    s_mov_b32 s34, 5888
    buffer_load_dwordx4 v[142:145], v8, s[12:15], s34 offen
    s_mov_b32 s34, 6144
    buffer_load_dwordx4 v[146:149], v8, s[12:15], s34 offen
    s_mov_b32 s34, 10240
    buffer_load_dwordx4 v[150:153], v8, s[12:15], s34 offen
    s_mov_b32 s34, 10496
    buffer_load_dwordx4 v[154:157], v8, s[12:15], s34 offen
    s_mov_b32 s34, 10752
    buffer_load_dwordx4 v[158:161], v8, s[12:15], s34 offen
    s_mov_b32 s34, 11008
    buffer_load_dwordx4 v[162:165], v8, s[12:15], s34 offen
    s_mov_b32 s34, 11264
    buffer_load_dwordx4 v[166:169], v8, s[12:15], s34 offen
    s_mov_b32 s34, 15360
    buffer_load_dwordx4 v[170:173], v8, s[12:15], s34 offen
    s_mov_b32 s34, 15616
    buffer_load_dwordx4 v[174:177], v8, s[12:15], s34 offen
    s_mov_b32 s34, 15872
    buffer_load_dwordx4 v[178:181], v8, s[12:15], s34 offen
    s_mov_b32 s34, 16128
    buffer_load_dwordx4 v[182:185], v8, s[12:15], s34 offen
    s_mov_b32 s34, 16384
    buffer_load_dwordx4 v[186:189], v8, s[12:15], s34 offen
    s_waitcnt vmcnt(15)
    v_lshlrev_b32 v190, 16, v110
    v_and_b32 v191, 0xffff0000, v110
    v_lshlrev_b32 v192, 16, v111
    v_and_b32 v193, 0xffff0000, v111
    v_lshlrev_b32 v194, 16, v112
    v_and_b32 v195, 0xffff0000, v112
    v_lshlrev_b32 v196, 16, v113
    v_and_b32 v197, 0xffff0000, v113
    v_lshlrev_b32 v198, 16, v114
    v_and_b32 v199, 0xffff0000, v114
    v_lshlrev_b32 v200, 16, v115
    v_and_b32 v201, 0xffff0000, v115
    v_lshlrev_b32 v202, 16, v116
    v_and_b32 v203, 0xffff0000, v116
    v_lshlrev_b32 v204, 16, v117
    v_and_b32 v205, 0xffff0000, v117
    v_lshlrev_b32 v206, 16, v118
    v_and_b32 v207, 0xffff0000, v118
    v_lshlrev_b32 v208, 16, v119
    v_and_b32 v209, 0xffff0000, v119
    v_lshlrev_b32 v210, 16, v120
    v_and_b32 v211, 0xffff0000, v120
    v_lshlrev_b32 v212, 16, v121
    v_and_b32 v213, 0xffff0000, v121
    v_lshlrev_b32 v214, 16, v122
    v_and_b32 v215, 0xffff0000, v122
    v_lshlrev_b32 v216, 16, v123
    v_and_b32 v217, 0xffff0000, v123
    v_lshlrev_b32 v218, 16, v124
    v_and_b32 v219, 0xffff0000, v124
    v_lshlrev_b32 v220, 16, v125
    v_and_b32 v221, 0xffff0000, v125
    v_lshlrev_b32 v222, 16, v126
    v_and_b32 v223, 0xffff0000, v126
    v_lshlrev_b32 v224, 16, v127
    v_and_b32 v225, 0xffff0000, v127
    v_lshlrev_b32 v226, 16, v128
    v_and_b32 v227, 0xffff0000, v128
    v_lshlrev_b32 v228, 16, v129
    v_and_b32 v229, 0xffff0000, v129
    v_add_f32 v230, v190, v191
    v_add_f32 v230, v230, v192
    v_add_f32 v230, v230, v193
    v_add_f32 v230, v230, v194
    v_add_f32 v230, v230, v195
    v_add_f32 v230, v230, v196
    v_add_f32 v230, v230, v197
    v_add_f32 v230, v230, v198
    v_add_f32 v230, v230, v199
    v_add_f32 v230, v230, v200
    v_add_f32 v230, v230, v201
    v_add_f32 v230, v230, v202
    v_add_f32 v230, v230, v203
    v_add_f32 v230, v230, v204
    v_add_f32 v230, v230, v205
    v_add_f32 v230, v230, v206
    v_add_f32 v230, v230, v207
    v_add_f32 v230, v230, v208
    v_add_f32 v230, v230, v209
    v_add_f32 v230, v230, v210
    v_add_f32 v230, v230, v211
    v_add_f32 v230, v230, v212
    v_add_f32 v230, v230, v213
    v_add_f32 v230, v230, v214
    v_add_f32 v230, v230, v215
    v_add_f32 v230, v230, v216
    v_add_f32 v230, v230, v217
    v_add_f32 v230, v230, v218
    v_add_f32 v230, v230, v219
    v_add_f32 v230, v230, v220
    v_add_f32 v230, v230, v221
    v_add_f32 v230, v230, v222
    v_add_f32 v230, v230, v223
    v_add_f32 v230, v230, v224
    v_add_f32 v230, v230, v225
    v_add_f32 v230, v230, v226
    v_add_f32 v230, v230, v227
    v_add_f32 v230, v230, v228
    v_add_f32 v230, v230, v229
    s_nop 1
    v_add_f32_dpp v230, v230, v230 row_ror:8 row_mask:0xf bank_mask:0xf
    s_nop 1
    v_add_f32_dpp v230, v230, v230 row_ror:4 row_mask:0xf bank_mask:0xf
    s_nop 1
    v_add_f32_dpp v230, v230, v230 row_ror:2 row_mask:0xf bank_mask:0xf
    s_nop 1
    v_add_f32_dpp v230, v230, v230 row_ror:1 row_mask:0xf bank_mask:0xf
    v_mul_f32 v230, 0.0015625, v230
    v_sub_f32 v190, v190, v230
    v_sub_f32 v191, v191, v230
    v_sub_f32 v192, v192, v230
    v_sub_f32 v193, v193, v230
    v_sub_f32 v194, v194, v230
    v_sub_f32 v195, v195, v230
    v_sub_f32 v196, v196, v230
    v_sub_f32 v197, v197, v230
    v_sub_f32 v198, v198, v230
    v_sub_f32 v199, v199, v230
    v_sub_f32 v200, v200, v230
    v_sub_f32 v201, v201, v230
    v_sub_f32 v202, v202, v230
    v_sub_f32 v203, v203, v230
    v_sub_f32 v204, v204, v230
    v_sub_f32 v205, v205, v230
    v_sub_f32 v206, v206, v230
    v_sub_f32 v207, v207, v230
    v_sub_f32 v208, v208, v230
    v_sub_f32 v209, v209, v230
    v_sub_f32 v210, v210, v230
    v_sub_f32 v211, v211, v230
    v_sub_f32 v212, v212, v230
    v_sub_f32 v213, v213, v230
    v_sub_f32 v214, v214, v230
    v_sub_f32 v215, v215, v230
    v_sub_f32 v216, v216, v230
    v_sub_f32 v217, v217, v230
    v_sub_f32 v218, v218, v230
    v_sub_f32 v219, v219, v230
    v_sub_f32 v220, v220, v230
    v_sub_f32 v221, v221, v230
    v_sub_f32 v222, v222, v230
    v_sub_f32 v223, v223, v230
    v_sub_f32 v224, v224, v230
    v_sub_f32 v225, v225, v230
    v_sub_f32 v226, v226, v230
    v_sub_f32 v227, v227, v230
    v_sub_f32 v228, v228, v230
    v_sub_f32 v229, v229, v230
    v_mul_f32 v230, v190, v190
    v_fmac_f32 v230, v191, v191
    v_fmac_f32 v230, v192, v192
    v_fmac_f32 v230, v193, v193
    v_fmac_f32 v230, v194, v194
    v_fmac_f32 v230, v195, v195
    v_fmac_f32 v230, v196, v196
    v_fmac_f32 v230, v197, v197
    v_fmac_f32 v230, v198, v198
    v_fmac_f32 v230, v199, v199
    v_fmac_f32 v230, v200, v200
    v_fmac_f32 v230, v201, v201
    v_fmac_f32 v230, v202, v202
    v_fmac_f32 v230, v203, v203
    v_fmac_f32 v230, v204, v204
    v_fmac_f32 v230, v205, v205
    v_fmac_f32 v230, v206, v206
    v_fmac_f32 v230, v207, v207
    v_fmac_f32 v230, v208, v208
    v_fmac_f32 v230, v209, v209
    v_fmac_f32 v230, v210, v210
    v_fmac_f32 v230, v211, v211
    v_fmac_f32 v230, v212, v212
    v_fmac_f32 v230, v213, v213
    v_fmac_f32 v230, v214, v214
    v_fmac_f32 v230, v215, v215
    v_fmac_f32 v230, v216, v216
    v_fmac_f32 v230, v217, v217
    v_fmac_f32 v230, v218, v218
    v_fmac_f32 v230, v219, v219
    v_fmac_f32 v230, v220, v220
    v_fmac_f32 v230, v221, v221
    v_fmac_f32 v230, v222, v222
    v_fmac_f32 v230, v223, v223
    v_fmac_f32 v230, v224, v224
    v_fmac_f32 v230, v225, v225
    v_fmac_f32 v230, v226, v226
    v_fmac_f32 v230, v227, v227
    v_fmac_f32 v230, v228, v228
    v_fmac_f32 v230, v229, v229
    s_nop 1
    v_add_f32_dpp v230, v230, v230 row_ror:8 row_mask:0xf bank_mask:0xf
    s_nop 1
    v_add_f32_dpp v230, v230, v230 row_ror:4 row_mask:0xf bank_mask:0xf
    s_nop 1
    v_add_f32_dpp v230, v230, v230 row_ror:2 row_mask:0xf bank_mask:0xf
    s_nop 1
    v_add_f32_dpp v230, v230, v230 row_ror:1 row_mask:0xf bank_mask:0xf
    v_mov_b32 v231, 0x3727c5ac
    v_fmac_f32 v231, 0.0015625, v230
    v_rsq_f32 v231, v231
    s_nop 0
    v_mul_f32 v190, v190, v231
    v_mul_f32 v191, v191, v231
    v_mul_f32 v192, v192, v231
    v_mul_f32 v193, v193, v231
    v_mul_f32 v194, v194, v231
    v_mul_f32 v195, v195, v231
    v_mul_f32 v196, v196, v231
    v_mul_f32 v197, v197, v231
    v_mul_f32 v198, v198, v231
    v_mul_f32 v199, v199, v231
    v_mul_f32 v200, v200, v231
    v_mul_f32 v201, v201, v231
    v_mul_f32 v202, v202, v231
    v_mul_f32 v203, v203, v231
    v_mul_f32 v204, v204, v231
    v_mul_f32 v205, v205, v231
    v_mul_f32 v206, v206, v231
    v_mul_f32 v207, v207, v231
    v_mul_f32 v208, v208, v231
    v_mul_f32 v209, v209, v231
    v_mul_f32 v210, v210, v231
    v_mul_f32 v211, v211, v231
    v_mul_f32 v212, v212, v231
    v_mul_f32 v213, v213, v231
    v_mul_f32 v214, v214, v231
    v_mul_f32 v215, v215, v231
    v_mul_f32 v216, v216, v231
    v_mul_f32 v217, v217, v231
    v_mul_f32 v218, v218, v231
    v_mul_f32 v219, v219, v231
    v_mul_f32 v220, v220, v231
    v_mul_f32 v221, v221, v231
    v_mul_f32 v222, v222, v231
    v_mul_f32 v223, v223, v231
    v_mul_f32 v224, v224, v231
    v_mul_f32 v225, v225, v231
    v_mul_f32 v226, v226, v231
    v_mul_f32 v227, v227, v231
    v_mul_f32 v228, v228, v231
    v_mul_f32 v229, v229, v231
    v_and_b32 v3, 15, v1
    v_add_u32 v10, 0, v4
    v_xor_b32 v3, v3, v10
    v_lshl_add_u32 v3, v3, 4, v9
    v_cvt_pk_bf16_f32 v190, v190, v191
    v_cvt_pk_bf16_f32 v191, v192, v193
    v_cvt_pk_bf16_f32 v192, v194, v195
    v_cvt_pk_bf16_f32 v193, v196, v197
    ds_write_b128 v3, v[190:193] offset:0
    v_cvt_pk_bf16_f32 v198, v198, v199
    v_cvt_pk_bf16_f32 v199, v200, v201
    v_cvt_pk_bf16_f32 v200, v202, v203
    v_cvt_pk_bf16_f32 v201, v204, v205
    ds_write_b128 v3, v[198:201] offset:256
    v_cvt_pk_bf16_f32 v206, v206, v207
    v_cvt_pk_bf16_f32 v207, v208, v209
    v_cvt_pk_bf16_f32 v208, v210, v211
    v_cvt_pk_bf16_f32 v209, v212, v213
    ds_write_b128 v3, v[206:209] offset:512
    v_cvt_pk_bf16_f32 v214, v214, v215
    v_cvt_pk_bf16_f32 v215, v216, v217
    v_cvt_pk_bf16_f32 v216, v218, v219
    v_cvt_pk_bf16_f32 v217, v220, v221
    ds_write_b128 v3, v[214:217] offset:768
    v_cvt_pk_bf16_f32 v222, v222, v223
    v_cvt_pk_bf16_f32 v223, v224, v225
    v_cvt_pk_bf16_f32 v224, v226, v227
    v_cvt_pk_bf16_f32 v225, v228, v229
    ds_write_b128 v3, v[222:225] offset:1024
    s_nop 0
    s_waitcnt vmcnt(10)
    v_lshlrev_b32 v190, 16, v130
    v_and_b32 v191, 0xffff0000, v130
    v_lshlrev_b32 v192, 16, v131
    v_and_b32 v193, 0xffff0000, v131
    v_lshlrev_b32 v194, 16, v132
    v_and_b32 v195, 0xffff0000, v132
    v_lshlrev_b32 v196, 16, v133
    v_and_b32 v197, 0xffff0000, v133
    v_lshlrev_b32 v198, 16, v134
    v_and_b32 v199, 0xffff0000, v134
    v_lshlrev_b32 v200, 16, v135
    v_and_b32 v201, 0xffff0000, v135
    v_lshlrev_b32 v202, 16, v136
    v_and_b32 v203, 0xffff0000, v136
    v_lshlrev_b32 v204, 16, v137
    v_and_b32 v205, 0xffff0000, v137
    v_lshlrev_b32 v206, 16, v138
    v_and_b32 v207, 0xffff0000, v138
    v_lshlrev_b32 v208, 16, v139
    v_and_b32 v209, 0xffff0000, v139
    v_lshlrev_b32 v210, 16, v140
    v_and_b32 v211, 0xffff0000, v140
    v_lshlrev_b32 v212, 16, v141
    v_and_b32 v213, 0xffff0000, v141
    v_lshlrev_b32 v214, 16, v142
    v_and_b32 v215, 0xffff0000, v142
    v_lshlrev_b32 v216, 16, v143
    v_and_b32 v217, 0xffff0000, v143
    v_lshlrev_b32 v218, 16, v144
    v_and_b32 v219, 0xffff0000, v144
    v_lshlrev_b32 v220, 16, v145
    v_and_b32 v221, 0xffff0000, v145
    v_lshlrev_b32 v222, 16, v146
    v_and_b32 v223, 0xffff0000, v146
    v_lshlrev_b32 v224, 16, v147
    v_and_b32 v225, 0xffff0000, v147
    v_lshlrev_b32 v226, 16, v148
    v_and_b32 v227, 0xffff0000, v148
    v_lshlrev_b32 v228, 16, v149
    v_and_b32 v229, 0xffff0000, v149
    v_add_f32 v230, v190, v191
    v_add_f32 v230, v230, v192
    v_add_f32 v230, v230, v193
    v_add_f32 v230, v230, v194
    v_add_f32 v230, v230, v195
    v_add_f32 v230, v230, v196
    v_add_f32 v230, v230, v197
    v_add_f32 v230, v230, v198
    v_add_f32 v230, v230, v199
    v_add_f32 v230, v230, v200
    v_add_f32 v230, v230, v201
    v_add_f32 v230, v230, v202
    v_add_f32 v230, v230, v203
    v_add_f32 v230, v230, v204
    v_add_f32 v230, v230, v205
    v_add_f32 v230, v230, v206
    v_add_f32 v230, v230, v207
    v_add_f32 v230, v230, v208
    v_add_f32 v230, v230, v209
    v_add_f32 v230, v230, v210
    v_add_f32 v230, v230, v211
    v_add_f32 v230, v230, v212
    v_add_f32 v230, v230, v213
    v_add_f32 v230, v230, v214
    v_add_f32 v230, v230, v215
    v_add_f32 v230, v230, v216
    v_add_f32 v230, v230, v217
    v_add_f32 v230, v230, v218
    v_add_f32 v230, v230, v219
    v_add_f32 v230, v230, v220
    v_add_f32 v230, v230, v221
    v_add_f32 v230, v230, v222
    v_add_f32 v230, v230, v223
    v_add_f32 v230, v230, v224
    v_add_f32 v230, v230, v225
    v_add_f32 v230, v230, v226
    v_add_f32 v230, v230, v227
    v_add_f32 v230, v230, v228
    v_add_f32 v230, v230, v229
    s_nop 1
    v_add_f32_dpp v230, v230, v230 row_ror:8 row_mask:0xf bank_mask:0xf
    s_nop 1
    v_add_f32_dpp v230, v230, v230 row_ror:4 row_mask:0xf bank_mask:0xf
    s_nop 1
    v_add_f32_dpp v230, v230, v230 row_ror:2 row_mask:0xf bank_mask:0xf
    s_nop 1
    v_add_f32_dpp v230, v230, v230 row_ror:1 row_mask:0xf bank_mask:0xf
    v_mul_f32 v230, 0.0015625, v230
    v_sub_f32 v190, v190, v230
    v_sub_f32 v191, v191, v230
    v_sub_f32 v192, v192, v230
    v_sub_f32 v193, v193, v230
    v_sub_f32 v194, v194, v230
    v_sub_f32 v195, v195, v230
    v_sub_f32 v196, v196, v230
    v_sub_f32 v197, v197, v230
    v_sub_f32 v198, v198, v230
    v_sub_f32 v199, v199, v230
    v_sub_f32 v200, v200, v230
    v_sub_f32 v201, v201, v230
    v_sub_f32 v202, v202, v230
    v_sub_f32 v203, v203, v230
    v_sub_f32 v204, v204, v230
    v_sub_f32 v205, v205, v230
    v_sub_f32 v206, v206, v230
    v_sub_f32 v207, v207, v230
    v_sub_f32 v208, v208, v230
    v_sub_f32 v209, v209, v230
    v_sub_f32 v210, v210, v230
    v_sub_f32 v211, v211, v230
    v_sub_f32 v212, v212, v230
    v_sub_f32 v213, v213, v230
    v_sub_f32 v214, v214, v230
    v_sub_f32 v215, v215, v230
    v_sub_f32 v216, v216, v230
    v_sub_f32 v217, v217, v230
    v_sub_f32 v218, v218, v230
    v_sub_f32 v219, v219, v230
    v_sub_f32 v220, v220, v230
    v_sub_f32 v221, v221, v230
    v_sub_f32 v222, v222, v230
    v_sub_f32 v223, v223, v230
    v_sub_f32 v224, v224, v230
    v_sub_f32 v225, v225, v230
    v_sub_f32 v226, v226, v230
    v_sub_f32 v227, v227, v230
    v_sub_f32 v228, v228, v230
    v_sub_f32 v229, v229, v230
    v_mul_f32 v230, v190, v190
    v_fmac_f32 v230, v191, v191
    v_fmac_f32 v230, v192, v192
    v_fmac_f32 v230, v193, v193
    v_fmac_f32 v230, v194, v194
    v_fmac_f32 v230, v195, v195
    v_fmac_f32 v230, v196, v196
    v_fmac_f32 v230, v197, v197
    v_fmac_f32 v230, v198, v198
    v_fmac_f32 v230, v199, v199
    v_fmac_f32 v230, v200, v200
    v_fmac_f32 v230, v201, v201
    v_fmac_f32 v230, v202, v202
    v_fmac_f32 v230, v203, v203
    v_fmac_f32 v230, v204, v204
    v_fmac_f32 v230, v205, v205
    v_fmac_f32 v230, v206, v206
    v_fmac_f32 v230, v207, v207
    v_fmac_f32 v230, v208, v208
    v_fmac_f32 v230, v209, v209
    v_fmac_f32 v230, v210, v210
    v_fmac_f32 v230, v211, v211
    v_fmac_f32 v230, v212, v212
    v_fmac_f32 v230, v213, v213
    v_fmac_f32 v230, v214, v214
    v_fmac_f32 v230, v215, v215
    v_fmac_f32 v230, v216, v216
    v_fmac_f32 v230, v217, v217
    v_fmac_f32 v230, v218, v218
    v_fmac_f32 v230, v219, v219
    v_fmac_f32 v230, v220, v220
    v_fmac_f32 v230, v221, v221
    v_fmac_f32 v230, v222, v222
    v_fmac_f32 v230, v223, v223
    v_fmac_f32 v230, v224, v224
    v_fmac_f32 v230, v225, v225
    v_fmac_f32 v230, v226, v226
    v_fmac_f32 v230, v227, v227
    v_fmac_f32 v230, v228, v228
    v_fmac_f32 v230, v229, v229
    s_nop 1
    v_add_f32_dpp v230, v230, v230 row_ror:8 row_mask:0xf bank_mask:0xf
    s_nop 1
    v_add_f32_dpp v230, v230, v230 row_ror:4 row_mask:0xf bank_mask:0xf
    s_nop 1
    v_add_f32_dpp v230, v230, v230 row_ror:2 row_mask:0xf bank_mask:0xf
    s_nop 1
    v_add_f32_dpp v230, v230, v230 row_ror:1 row_mask:0xf bank_mask:0xf
    v_mov_b32 v231, 0x3727c5ac
    v_fmac_f32 v231, 0.0015625, v230
    v_rsq_f32 v231, v231
    s_nop 0
    v_mul_f32 v190, v190, v231
    v_mul_f32 v191, v191, v231
    v_mul_f32 v192, v192, v231
    v_mul_f32 v193, v193, v231
    v_mul_f32 v194, v194, v231
    v_mul_f32 v195, v195, v231
    v_mul_f32 v196, v196, v231
    v_mul_f32 v197, v197, v231
    v_mul_f32 v198, v198, v231
    v_mul_f32 v199, v199, v231
    v_mul_f32 v200, v200, v231
    v_mul_f32 v201, v201, v231
    v_mul_f32 v202, v202, v231
    v_mul_f32 v203, v203, v231
    v_mul_f32 v204, v204, v231
    v_mul_f32 v205, v205, v231
    v_mul_f32 v206, v206, v231
    v_mul_f32 v207, v207, v231
    v_mul_f32 v208, v208, v231
    v_mul_f32 v209, v209, v231
    v_mul_f32 v210, v210, v231
    v_mul_f32 v211, v211, v231
    v_mul_f32 v212, v212, v231
    v_mul_f32 v213, v213, v231
    v_mul_f32 v214, v214, v231
    v_mul_f32 v215, v215, v231
    v_mul_f32 v216, v216, v231
    v_mul_f32 v217, v217, v231
    v_mul_f32 v218, v218, v231
    v_mul_f32 v219, v219, v231
    v_mul_f32 v220, v220, v231
    v_mul_f32 v221, v221, v231
    v_mul_f32 v222, v222, v231
    v_mul_f32 v223, v223, v231
    v_mul_f32 v224, v224, v231
    v_mul_f32 v225, v225, v231
    v_mul_f32 v226, v226, v231
    v_mul_f32 v227, v227, v231
    v_mul_f32 v228, v228, v231
    v_mul_f32 v229, v229, v231
    v_and_b32 v3, 15, v1
    v_add_u32 v10, 4, v4
    v_xor_b32 v3, v3, v10
    v_lshl_add_u32 v3, v3, 4, v9
    v_cvt_pk_bf16_f32 v190, v190, v191
    v_cvt_pk_bf16_f32 v191, v192, v193
    v_cvt_pk_bf16_f32 v192, v194, v195
    v_cvt_pk_bf16_f32 v193, v196, v197
    ds_write_b128 v3, v[190:193] offset:5120
    v_cvt_pk_bf16_f32 v198, v198, v199
    v_cvt_pk_bf16_f32 v199, v200, v201
    v_cvt_pk_bf16_f32 v200, v202, v203
    v_cvt_pk_bf16_f32 v201, v204, v205
    ds_write_b128 v3, v[198:201] offset:5376
    v_cvt_pk_bf16_f32 v206, v206, v207
    v_cvt_pk_bf16_f32 v207, v208, v209
    v_cvt_pk_bf16_f32 v208, v210, v211
    v_cvt_pk_bf16_f32 v209, v212, v213
    ds_write_b128 v3, v[206:209] offset:5632
    v_cvt_pk_bf16_f32 v214, v214, v215
    v_cvt_pk_bf16_f32 v215, v216, v217
    v_cvt_pk_bf16_f32 v216, v218, v219
    v_cvt_pk_bf16_f32 v217, v220, v221
    ds_write_b128 v3, v[214:217] offset:5888
    v_cvt_pk_bf16_f32 v222, v222, v223
    v_cvt_pk_bf16_f32 v223, v224, v225
    v_cvt_pk_bf16_f32 v224, v226, v227
    v_cvt_pk_bf16_f32 v225, v228, v229
    ds_write_b128 v3, v[222:225] offset:6144
    s_nop 0
    s_waitcnt vmcnt(5)
    v_lshlrev_b32 v190, 16, v150
    v_and_b32 v191, 0xffff0000, v150
    v_lshlrev_b32 v192, 16, v151
    v_and_b32 v193, 0xffff0000, v151
    v_lshlrev_b32 v194, 16, v152
    v_and_b32 v195, 0xffff0000, v152
    v_lshlrev_b32 v196, 16, v153
    v_and_b32 v197, 0xffff0000, v153
    v_lshlrev_b32 v198, 16, v154
    v_and_b32 v199, 0xffff0000, v154
    v_lshlrev_b32 v200, 16, v155
    v_and_b32 v201, 0xffff0000, v155
    v_lshlrev_b32 v202, 16, v156
    v_and_b32 v203, 0xffff0000, v156
    v_lshlrev_b32 v204, 16, v157
    v_and_b32 v205, 0xffff0000, v157
    v_lshlrev_b32 v206, 16, v158
    v_and_b32 v207, 0xffff0000, v158
    v_lshlrev_b32 v208, 16, v159
    v_and_b32 v209, 0xffff0000, v159
    v_lshlrev_b32 v210, 16, v160
    v_and_b32 v211, 0xffff0000, v160
    v_lshlrev_b32 v212, 16, v161
    v_and_b32 v213, 0xffff0000, v161
    v_lshlrev_b32 v214, 16, v162
    v_and_b32 v215, 0xffff0000, v162
    v_lshlrev_b32 v216, 16, v163
    v_and_b32 v217, 0xffff0000, v163
    v_lshlrev_b32 v218, 16, v164
    v_and_b32 v219, 0xffff0000, v164
    v_lshlrev_b32 v220, 16, v165
    v_and_b32 v221, 0xffff0000, v165
    v_lshlrev_b32 v222, 16, v166
    v_and_b32 v223, 0xffff0000, v166
    v_lshlrev_b32 v224, 16, v167
    v_and_b32 v225, 0xffff0000, v167
    v_lshlrev_b32 v226, 16, v168
    v_and_b32 v227, 0xffff0000, v168
    v_lshlrev_b32 v228, 16, v169
    v_and_b32 v229, 0xffff0000, v169
    v_add_f32 v230, v190, v191
    v_add_f32 v230, v230, v192
    v_add_f32 v230, v230, v193
    v_add_f32 v230, v230, v194
    v_add_f32 v230, v230, v195
    v_add_f32 v230, v230, v196
    v_add_f32 v230, v230, v197
    v_add_f32 v230, v230, v198
    v_add_f32 v230, v230, v199
    v_add_f32 v230, v230, v200
    v_add_f32 v230, v230, v201
    v_add_f32 v230, v230, v202
    v_add_f32 v230, v230, v203
    v_add_f32 v230, v230, v204
    v_add_f32 v230, v230, v205
    v_add_f32 v230, v230, v206
    v_add_f32 v230, v230, v207
    v_add_f32 v230, v230, v208
    v_add_f32 v230, v230, v209
    v_add_f32 v230, v230, v210
    v_add_f32 v230, v230, v211
    v_add_f32 v230, v230, v212
    v_add_f32 v230, v230, v213
    v_add_f32 v230, v230, v214
    v_add_f32 v230, v230, v215
    v_add_f32 v230, v230, v216
    v_add_f32 v230, v230, v217
    v_add_f32 v230, v230, v218
    v_add_f32 v230, v230, v219
    v_add_f32 v230, v230, v220
    v_add_f32 v230, v230, v221
    v_add_f32 v230, v230, v222
    v_add_f32 v230, v230, v223
    v_add_f32 v230, v230, v224
    v_add_f32 v230, v230, v225
    v_add_f32 v230, v230, v226
    v_add_f32 v230, v230, v227
    v_add_f32 v230, v230, v228
    v_add_f32 v230, v230, v229
    s_nop 1
    v_add_f32_dpp v230, v230, v230 row_ror:8 row_mask:0xf bank_mask:0xf
    s_nop 1
    v_add_f32_dpp v230, v230, v230 row_ror:4 row_mask:0xf bank_mask:0xf
    s_nop 1
    v_add_f32_dpp v230, v230, v230 row_ror:2 row_mask:0xf bank_mask:0xf
    s_nop 1
    v_add_f32_dpp v230, v230, v230 row_ror:1 row_mask:0xf bank_mask:0xf
    v_mul_f32 v230, 0.0015625, v230
    v_sub_f32 v190, v190, v230
    v_sub_f32 v191, v191, v230
    v_sub_f32 v192, v192, v230
    v_sub_f32 v193, v193, v230
    v_sub_f32 v194, v194, v230
    v_sub_f32 v195, v195, v230
    v_sub_f32 v196, v196, v230
    v_sub_f32 v197, v197, v230
    v_sub_f32 v198, v198, v230
    v_sub_f32 v199, v199, v230
    v_sub_f32 v200, v200, v230
    v_sub_f32 v201, v201, v230
    v_sub_f32 v202, v202, v230
    v_sub_f32 v203, v203, v230
    v_sub_f32 v204, v204, v230
    v_sub_f32 v205, v205, v230
    v_sub_f32 v206, v206, v230
    v_sub_f32 v207, v207, v230
    v_sub_f32 v208, v208, v230
    v_sub_f32 v209, v209, v230
    v_sub_f32 v210, v210, v230
    v_sub_f32 v211, v211, v230
    v_sub_f32 v212, v212, v230
    v_sub_f32 v213, v213, v230
    v_sub_f32 v214, v214, v230
    v_sub_f32 v215, v215, v230
    v_sub_f32 v216, v216, v230
    v_sub_f32 v217, v217, v230
    v_sub_f32 v218, v218, v230
    v_sub_f32 v219, v219, v230
    v_sub_f32 v220, v220, v230
    v_sub_f32 v221, v221, v230
    v_sub_f32 v222, v222, v230
    v_sub_f32 v223, v223, v230
    v_sub_f32 v224, v224, v230
    v_sub_f32 v225, v225, v230
    v_sub_f32 v226, v226, v230
    v_sub_f32 v227, v227, v230
    v_sub_f32 v228, v228, v230
    v_sub_f32 v229, v229, v230
    v_mul_f32 v230, v190, v190
    v_fmac_f32 v230, v191, v191
    v_fmac_f32 v230, v192, v192
    v_fmac_f32 v230, v193, v193
    v_fmac_f32 v230, v194, v194
    v_fmac_f32 v230, v195, v195
    v_fmac_f32 v230, v196, v196
    v_fmac_f32 v230, v197, v197
    v_fmac_f32 v230, v198, v198
    v_fmac_f32 v230, v199, v199
    v_fmac_f32 v230, v200, v200
    v_fmac_f32 v230, v201, v201
    v_fmac_f32 v230, v202, v202
    v_fmac_f32 v230, v203, v203
    v_fmac_f32 v230, v204, v204
    v_fmac_f32 v230, v205, v205
    v_fmac_f32 v230, v206, v206
    v_fmac_f32 v230, v207, v207
    v_fmac_f32 v230, v208, v208
    v_fmac_f32 v230, v209, v209
    v_fmac_f32 v230, v210, v210
    v_fmac_f32 v230, v211, v211
    v_fmac_f32 v230, v212, v212
    v_fmac_f32 v230, v213, v213
    v_fmac_f32 v230, v214, v214
    v_fmac_f32 v230, v215, v215
    v_fmac_f32 v230, v216, v216
    v_fmac_f32 v230, v217, v217
    v_fmac_f32 v230, v218, v218
    v_fmac_f32 v230, v219, v219
    v_fmac_f32 v230, v220, v220
    v_fmac_f32 v230, v221, v221
    v_fmac_f32 v230, v222, v222
    v_fmac_f32 v230, v223, v223
    v_fmac_f32 v230, v224, v224
    v_fmac_f32 v230, v225, v225
    v_fmac_f32 v230, v226, v226
    v_fmac_f32 v230, v227, v227
    v_fmac_f32 v230, v228, v228
    v_fmac_f32 v230, v229, v229
    s_nop 1
    v_add_f32_dpp v230, v230, v230 row_ror:8 row_mask:0xf bank_mask:0xf
    s_nop 1
    v_add_f32_dpp v230, v230, v230 row_ror:4 row_mask:0xf bank_mask:0xf
    s_nop 1
    v_add_f32_dpp v230, v230, v230 row_ror:2 row_mask:0xf bank_mask:0xf
    s_nop 1
    v_add_f32_dpp v230, v230, v230 row_ror:1 row_mask:0xf bank_mask:0xf
    v_mov_b32 v231, 0x3727c5ac
    v_fmac_f32 v231, 0.0015625, v230
    v_rsq_f32 v231, v231
    s_nop 0
    v_mul_f32 v190, v190, v231
    v_mul_f32 v191, v191, v231
    v_mul_f32 v192, v192, v231
    v_mul_f32 v193, v193, v231
    v_mul_f32 v194, v194, v231
    v_mul_f32 v195, v195, v231
    v_mul_f32 v196, v196, v231
    v_mul_f32 v197, v197, v231
    v_mul_f32 v198, v198, v231
    v_mul_f32 v199, v199, v231
    v_mul_f32 v200, v200, v231
    v_mul_f32 v201, v201, v231
    v_mul_f32 v202, v202, v231
    v_mul_f32 v203, v203, v231
    v_mul_f32 v204, v204, v231
    v_mul_f32 v205, v205, v231
    v_mul_f32 v206, v206, v231
    v_mul_f32 v207, v207, v231
    v_mul_f32 v208, v208, v231
    v_mul_f32 v209, v209, v231
    v_mul_f32 v210, v210, v231
    v_mul_f32 v211, v211, v231
    v_mul_f32 v212, v212, v231
    v_mul_f32 v213, v213, v231
    v_mul_f32 v214, v214, v231
    v_mul_f32 v215, v215, v231
    v_mul_f32 v216, v216, v231
    v_mul_f32 v217, v217, v231
    v_mul_f32 v218, v218, v231
    v_mul_f32 v219, v219, v231
    v_mul_f32 v220, v220, v231
    v_mul_f32 v221, v221, v231
    v_mul_f32 v222, v222, v231
    v_mul_f32 v223, v223, v231
    v_mul_f32 v224, v224, v231
    v_mul_f32 v225, v225, v231
    v_mul_f32 v226, v226, v231
    v_mul_f32 v227, v227, v231
    v_mul_f32 v228, v228, v231
    v_mul_f32 v229, v229, v231
    v_and_b32 v3, 15, v1
    v_add_u32 v10, 0, v4
    v_xor_b32 v3, v3, v10
    v_lshl_add_u32 v3, v3, 4, v9
    v_cvt_pk_bf16_f32 v190, v190, v191
    v_cvt_pk_bf16_f32 v191, v192, v193
    v_cvt_pk_bf16_f32 v192, v194, v195
    v_cvt_pk_bf16_f32 v193, v196, v197
    ds_write_b128 v3, v[190:193] offset:10240
    v_cvt_pk_bf16_f32 v198, v198, v199
    v_cvt_pk_bf16_f32 v199, v200, v201
    v_cvt_pk_bf16_f32 v200, v202, v203
    v_cvt_pk_bf16_f32 v201, v204, v205
    ds_write_b128 v3, v[198:201] offset:10496
    v_cvt_pk_bf16_f32 v206, v206, v207
    v_cvt_pk_bf16_f32 v207, v208, v209
    v_cvt_pk_bf16_f32 v208, v210, v211
    v_cvt_pk_bf16_f32 v209, v212, v213
    ds_write_b128 v3, v[206:209] offset:10752
    v_cvt_pk_bf16_f32 v214, v214, v215
    v_cvt_pk_bf16_f32 v215, v216, v217
    v_cvt_pk_bf16_f32 v216, v218, v219
    v_cvt_pk_bf16_f32 v217, v220, v221
    ds_write_b128 v3, v[214:217] offset:11008
    v_cvt_pk_bf16_f32 v222, v222, v223
    v_cvt_pk_bf16_f32 v223, v224, v225
    v_cvt_pk_bf16_f32 v224, v226, v227
    v_cvt_pk_bf16_f32 v225, v228, v229
    ds_write_b128 v3, v[222:225] offset:11264
    s_nop 0
    s_waitcnt vmcnt(0)
    v_lshlrev_b32 v190, 16, v170
    v_and_b32 v191, 0xffff0000, v170
    v_lshlrev_b32 v192, 16, v171
    v_and_b32 v193, 0xffff0000, v171
    v_lshlrev_b32 v194, 16, v172
    v_and_b32 v195, 0xffff0000, v172
    v_lshlrev_b32 v196, 16, v173
    v_and_b32 v197, 0xffff0000, v173
    v_lshlrev_b32 v198, 16, v174
    v_and_b32 v199, 0xffff0000, v174
    v_lshlrev_b32 v200, 16, v175
    v_and_b32 v201, 0xffff0000, v175
    v_lshlrev_b32 v202, 16, v176
    v_and_b32 v203, 0xffff0000, v176
    v_lshlrev_b32 v204, 16, v177
    v_and_b32 v205, 0xffff0000, v177
    v_lshlrev_b32 v206, 16, v178
    v_and_b32 v207, 0xffff0000, v178
    v_lshlrev_b32 v208, 16, v179
    v_and_b32 v209, 0xffff0000, v179
    v_lshlrev_b32 v210, 16, v180
    v_and_b32 v211, 0xffff0000, v180
    v_lshlrev_b32 v212, 16, v181
    v_and_b32 v213, 0xffff0000, v181
    v_lshlrev_b32 v214, 16, v182
    v_and_b32 v215, 0xffff0000, v182
    v_lshlrev_b32 v216, 16, v183
    v_and_b32 v217, 0xffff0000, v183
    v_lshlrev_b32 v218, 16, v184
    v_and_b32 v219, 0xffff0000, v184
    v_lshlrev_b32 v220, 16, v185
    v_and_b32 v221, 0xffff0000, v185
    v_lshlrev_b32 v222, 16, v186
    v_and_b32 v223, 0xffff0000, v186
    v_lshlrev_b32 v224, 16, v187
    v_and_b32 v225, 0xffff0000, v187
    v_lshlrev_b32 v226, 16, v188
    v_and_b32 v227, 0xffff0000, v188
    v_lshlrev_b32 v228, 16, v189
    v_and_b32 v229, 0xffff0000, v189
    v_add_f32 v230, v190, v191
    v_add_f32 v230, v230, v192
    v_add_f32 v230, v230, v193
    v_add_f32 v230, v230, v194
    v_add_f32 v230, v230, v195
    v_add_f32 v230, v230, v196
    v_add_f32 v230, v230, v197
    v_add_f32 v230, v230, v198
    v_add_f32 v230, v230, v199
    v_add_f32 v230, v230, v200
    v_add_f32 v230, v230, v201
    v_add_f32 v230, v230, v202
    v_add_f32 v230, v230, v203
    v_add_f32 v230, v230, v204
    v_add_f32 v230, v230, v205
    v_add_f32 v230, v230, v206
    v_add_f32 v230, v230, v207
    v_add_f32 v230, v230, v208
    v_add_f32 v230, v230, v209
    v_add_f32 v230, v230, v210
    v_add_f32 v230, v230, v211
    v_add_f32 v230, v230, v212
    v_add_f32 v230, v230, v213
    v_add_f32 v230, v230, v214
    v_add_f32 v230, v230, v215
    v_add_f32 v230, v230, v216
    v_add_f32 v230, v230, v217
    v_add_f32 v230, v230, v218
    v_add_f32 v230, v230, v219
    v_add_f32 v230, v230, v220
    v_add_f32 v230, v230, v221
    v_add_f32 v230, v230, v222
    v_add_f32 v230, v230, v223
    v_add_f32 v230, v230, v224
    v_add_f32 v230, v230, v225
    v_add_f32 v230, v230, v226
    v_add_f32 v230, v230, v227
    v_add_f32 v230, v230, v228
    v_add_f32 v230, v230, v229
    s_nop 1
    v_add_f32_dpp v230, v230, v230 row_ror:8 row_mask:0xf bank_mask:0xf
    s_nop 1
    v_add_f32_dpp v230, v230, v230 row_ror:4 row_mask:0xf bank_mask:0xf
    s_nop 1
    v_add_f32_dpp v230, v230, v230 row_ror:2 row_mask:0xf bank_mask:0xf
    s_nop 1
    v_add_f32_dpp v230, v230, v230 row_ror:1 row_mask:0xf bank_mask:0xf
    v_mul_f32 v230, 0.0015625, v230
    v_sub_f32 v190, v190, v230
    v_sub_f32 v191, v191, v230
    v_sub_f32 v192, v192, v230
    v_sub_f32 v193, v193, v230
    v_sub_f32 v194, v194, v230
    v_sub_f32 v195, v195, v230
    v_sub_f32 v196, v196, v230
    v_sub_f32 v197, v197, v230
    v_sub_f32 v198, v198, v230
    v_sub_f32 v199, v199, v230
    v_sub_f32 v200, v200, v230
    v_sub_f32 v201, v201, v230
    v_sub_f32 v202, v202, v230
    v_sub_f32 v203, v203, v230
    v_sub_f32 v204, v204, v230
    v_sub_f32 v205, v205, v230
    v_sub_f32 v206, v206, v230
    v_sub_f32 v207, v207, v230
    v_sub_f32 v208, v208, v230
    v_sub_f32 v209, v209, v230
    v_sub_f32 v210, v210, v230
    v_sub_f32 v211, v211, v230
    v_sub_f32 v212, v212, v230
    v_sub_f32 v213, v213, v230
    v_sub_f32 v214, v214, v230
    v_sub_f32 v215, v215, v230
    v_sub_f32 v216, v216, v230
    v_sub_f32 v217, v217, v230
    v_sub_f32 v218, v218, v230
    v_sub_f32 v219, v219, v230
    v_sub_f32 v220, v220, v230
    v_sub_f32 v221, v221, v230
    v_sub_f32 v222, v222, v230
    v_sub_f32 v223, v223, v230
    v_sub_f32 v224, v224, v230
    v_sub_f32 v225, v225, v230
    v_sub_f32 v226, v226, v230
    v_sub_f32 v227, v227, v230
    v_sub_f32 v228, v228, v230
    v_sub_f32 v229, v229, v230
    v_mul_f32 v230, v190, v190
    v_fmac_f32 v230, v191, v191
    v_fmac_f32 v230, v192, v192
    v_fmac_f32 v230, v193, v193
    v_fmac_f32 v230, v194, v194
    v_fmac_f32 v230, v195, v195
    v_fmac_f32 v230, v196, v196
    v_fmac_f32 v230, v197, v197
    v_fmac_f32 v230, v198, v198
    v_fmac_f32 v230, v199, v199
    v_fmac_f32 v230, v200, v200
    v_fmac_f32 v230, v201, v201
    v_fmac_f32 v230, v202, v202
    v_fmac_f32 v230, v203, v203
    v_fmac_f32 v230, v204, v204
    v_fmac_f32 v230, v205, v205
    v_fmac_f32 v230, v206, v206
    v_fmac_f32 v230, v207, v207
    v_fmac_f32 v230, v208, v208
    v_fmac_f32 v230, v209, v209
    v_fmac_f32 v230, v210, v210
    v_fmac_f32 v230, v211, v211
    v_fmac_f32 v230, v212, v212
    v_fmac_f32 v230, v213, v213
    v_fmac_f32 v230, v214, v214
    v_fmac_f32 v230, v215, v215
    v_fmac_f32 v230, v216, v216
    v_fmac_f32 v230, v217, v217
    v_fmac_f32 v230, v218, v218
    v_fmac_f32 v230, v219, v219
    v_fmac_f32 v230, v220, v220
    v_fmac_f32 v230, v221, v221
    v_fmac_f32 v230, v222, v222
    v_fmac_f32 v230, v223, v223
    v_fmac_f32 v230, v224, v224
    v_fmac_f32 v230, v225, v225
    v_fmac_f32 v230, v226, v226
    v_fmac_f32 v230, v227, v227
    v_fmac_f32 v230, v228, v228
    v_fmac_f32 v230, v229, v229
    s_nop 1
    v_add_f32_dpp v230, v230, v230 row_ror:8 row_mask:0xf bank_mask:0xf
    s_nop 1
    v_add_f32_dpp v230, v230, v230 row_ror:4 row_mask:0xf bank_mask:0xf
    s_nop 1
    v_add_f32_dpp v230, v230, v230 row_ror:2 row_mask:0xf bank_mask:0xf
    s_nop 1
    v_add_f32_dpp v230, v230, v230 row_ror:1 row_mask:0xf bank_mask:0xf
    v_mov_b32 v231, 0x3727c5ac
    v_fmac_f32 v231, 0.0015625, v230
    v_rsq_f32 v231, v231
    s_nop 0
    v_mul_f32 v190, v190, v231
    v_mul_f32 v191, v191, v231
    v_mul_f32 v192, v192, v231
    v_mul_f32 v193, v193, v231
    v_mul_f32 v194, v194, v231
    v_mul_f32 v195, v195, v231
    v_mul_f32 v196, v196, v231
    v_mul_f32 v197, v197, v231
    v_mul_f32 v198, v198, v231
    v_mul_f32 v199, v199, v231
    v_mul_f32 v200, v200, v231
    v_mul_f32 v201, v201, v231
    v_mul_f32 v202, v202, v231
    v_mul_f32 v203, v203, v231
    v_mul_f32 v204, v204, v231
    v_mul_f32 v205, v205, v231
    v_mul_f32 v206, v206, v231
    v_mul_f32 v207, v207, v231
    v_mul_f32 v208, v208, v231
    v_mul_f32 v209, v209, v231
    v_mul_f32 v210, v210, v231
    v_mul_f32 v211, v211, v231
    v_mul_f32 v212, v212, v231
    v_mul_f32 v213, v213, v231
    v_mul_f32 v214, v214, v231
    v_mul_f32 v215, v215, v231
    v_mul_f32 v216, v216, v231
    v_mul_f32 v217, v217, v231
    v_mul_f32 v218, v218, v231
    v_mul_f32 v219, v219, v231
    v_mul_f32 v220, v220, v231
    v_mul_f32 v221, v221, v231
    v_mul_f32 v222, v222, v231
    v_mul_f32 v223, v223, v231
    v_mul_f32 v224, v224, v231
    v_mul_f32 v225, v225, v231
    v_mul_f32 v226, v226, v231
    v_mul_f32 v227, v227, v231
    v_mul_f32 v228, v228, v231
    v_mul_f32 v229, v229, v231
    v_and_b32 v3, 15, v1
    v_add_u32 v10, 4, v4
    v_xor_b32 v3, v3, v10
    v_lshl_add_u32 v3, v3, 4, v9
    v_cvt_pk_bf16_f32 v190, v190, v191
    v_cvt_pk_bf16_f32 v191, v192, v193
    v_cvt_pk_bf16_f32 v192, v194, v195
    v_cvt_pk_bf16_f32 v193, v196, v197
    ds_write_b128 v3, v[190:193] offset:15360
    v_cvt_pk_bf16_f32 v198, v198, v199
    v_cvt_pk_bf16_f32 v199, v200, v201
    v_cvt_pk_bf16_f32 v200, v202, v203
    v_cvt_pk_bf16_f32 v201, v204, v205
    ds_write_b128 v3, v[198:201] offset:15616
    v_cvt_pk_bf16_f32 v206, v206, v207
    v_cvt_pk_bf16_f32 v207, v208, v209
    v_cvt_pk_bf16_f32 v208, v210, v211
    v_cvt_pk_bf16_f32 v209, v212, v213
    ds_write_b128 v3, v[206:209] offset:15872
    v_cvt_pk_bf16_f32 v214, v214, v215
    v_cvt_pk_bf16_f32 v215, v216, v217
    v_cvt_pk_bf16_f32 v216, v218, v219
    v_cvt_pk_bf16_f32 v217, v220, v221
    ds_write_b128 v3, v[214:217] offset:16128
    v_cvt_pk_bf16_f32 v222, v222, v223
    v_cvt_pk_bf16_f32 v223, v224, v225
    v_cvt_pk_bf16_f32 v224, v226, v227
    v_cvt_pk_bf16_f32 v225, v228, v229
    ds_write_b128 v3, v[222:225] offset:16384
    s_nop 0
qq_k_psk0:
    s_waitcnt vmcnt(0) lgkmcnt(0)
    s_barrier
    ds_read_b128 v[110:113], v7 offset:0
    ds_read_b128 v[114:117], v7 offset:20480
    ds_read_b128 v[118:121], v7 offset:40960
    ds_read_b128 v[122:125], v7 offset:61440
    ds_read_b128 v[126:129], v6 offset:0
    ds_read_b128 v[130:133], v6 offset:20480
    ds_read_b128 v[134:137], v6 offset:40960
    ds_read_b128 v[138:141], v6 offset:61440
    s_waitcnt vmcnt(14) lgkmcnt(4)
    v_mfma_f32_16x16x32_bf16 v[78:81], v[14:17], v[110:113], v[78:81]
    v_mfma_f32_16x16x32_bf16 v[82:85], v[18:21], v[110:113], v[82:85]
    v_mfma_f32_16x16x32_bf16 v[86:89], v[14:17], v[114:117], v[86:89]
    v_mfma_f32_16x16x32_bf16 v[90:93], v[18:21], v[114:117], v[90:93]
    v_mfma_f32_16x16x32_bf16 v[94:97], v[14:17], v[118:121], v[94:97]
    v_mfma_f32_16x16x32_bf16 v[98:101], v[18:21], v[118:121], v[98:101]
    v_mfma_f32_16x16x32_bf16 v[102:105], v[14:17], v[122:125], v[102:105]
    v_mfma_f32_16x16x32_bf16 v[106:109], v[18:21], v[122:125], v[106:109]
    s_add_u32 s34, s33, 8192
    buffer_load_dwordx4 v[14:17], v2, s[8:11], s34 offen
    s_add_u32 s34, s33, 28672
    buffer_load_dwordx4 v[18:21], v2, s[8:11], s34 offen
    ds_read_b128 v[110:113], v7 offset:128
    ds_read_b128 v[114:117], v7 offset:20608
    ds_read_b128 v[118:121], v7 offset:41088
    ds_read_b128 v[122:125], v7 offset:61568
    s_waitcnt vmcnt(14) lgkmcnt(4)
    v_mfma_f32_16x16x32_bf16 v[78:81], v[22:25], v[126:129], v[78:81]
    v_mfma_f32_16x16x32_bf16 v[82:85], v[26:29], v[126:129], v[82:85]
    v_mfma_f32_16x16x32_bf16 v[86:89], v[22:25], v[130:133], v[86:89]
    v_mfma_f32_16x16x32_bf16 v[90:93], v[26:29], v[130:133], v[90:93]
    v_mfma_f32_16x16x32_bf16 v[94:97], v[22:25], v[134:137], v[94:97]
    v_mfma_f32_16x16x32_bf16 v[98:101], v[26:29], v[134:137], v[98:101]
    v_mfma_f32_16x16x32_bf16 v[102:105], v[22:25], v[138:141], v[102:105]
    v_mfma_f32_16x16x32_bf16 v[106:109], v[26:29], v[138:141], v[106:109]
    s_add_u32 s34, s33, 9216
    buffer_load_dwordx4 v[22:25], v2, s[8:11], s34 offen
    s_add_u32 s34, s33, 29696
    buffer_load_dwordx4 v[26:29], v2, s[8:11], s34 offen
    ds_read_b128 v[126:129], v6 offset:128
    ds_read_b128 v[130:133], v6 offset:20608
    ds_read_b128 v[134:137], v6 offset:41088
    ds_read_b128 v[138:141], v6 offset:61568
    s_waitcnt vmcnt(14) lgkmcnt(4)
    v_mfma_f32_16x16x32_bf16 v[78:81], v[30:33], v[110:113], v[78:81]
    v_mfma_f32_16x16x32_bf16 v[82:85], v[34:37], v[110:113], v[82:85]
    v_mfma_f32_16x16x32_bf16 v[86:89], v[30:33], v[114:117], v[86:89]
    v_mfma_f32_16x16x32_bf16 v[90:93], v[34:37], v[114:117], v[90:93]
    v_mfma_f32_16x16x32_bf16 v[94:97], v[30:33], v[118:121], v[94:97]
    v_mfma_f32_16x16x32_bf16 v[98:101], v[34:37], v[118:121], v[98:101]
    v_mfma_f32_16x16x32_bf16 v[102:105], v[30:33], v[122:125], v[102:105]
    v_mfma_f32_16x16x32_bf16 v[106:109], v[34:37], v[122:125], v[106:109]
    s_add_u32 s34, s33, 10240
    buffer_load_dwordx4 v[30:33], v2, s[8:11], s34 offen
    s_add_u32 s34, s33, 30720
    buffer_load_dwordx4 v[34:37], v2, s[8:11], s34 offen
    ds_read_b128 v[110:113], v7 offset:256
    ds_read_b128 v[114:117], v7 offset:20736
    ds_read_b128 v[118:121], v7 offset:41216
    ds_read_b128 v[122:125], v7 offset:61696
    s_waitcnt vmcnt(14) lgkmcnt(4)
    v_mfma_f32_16x16x32_bf16 v[78:81], v[38:41], v[126:129], v[78:81]
    v_mfma_f32_16x16x32_bf16 v[82:85], v[42:45], v[126:129], v[82:85]
    v_mfma_f32_16x16x32_bf16 v[86:89], v[38:41], v[130:133], v[86:89]
    v_mfma_f32_16x16x32_bf16 v[90:93], v[42:45], v[130:133], v[90:93]
    v_mfma_f32_16x16x32_bf16 v[94:97], v[38:41], v[134:137], v[94:97]
    v_mfma_f32_16x16x32_bf16 v[98:101], v[42:45], v[134:137], v[98:101]
    v_mfma_f32_16x16x32_bf16 v[102:105], v[38:41], v[138:141], v[102:105]
    v_mfma_f32_16x16x32_bf16 v[106:109], v[42:45], v[138:141], v[106:109]
    s_add_u32 s34, s33, 11264
    buffer_load_dwordx4 v[38:41], v2, s[8:11], s34 offen
    s_add_u32 s34, s33, 31744
    buffer_load_dwordx4 v[42:45], v2, s[8:11], s34 offen
    ds_read_b128 v[126:129], v6 offset:256
    ds_read_b128 v[130:133], v6 offset:20736
    ds_read_b128 v[134:137], v6 offset:41216
    ds_read_b128 v[138:141], v6 offset:61696
    s_waitcnt vmcnt(14) lgkmcnt(4)
    v_mfma_f32_16x16x32_bf16 v[78:81], v[46:49], v[110:113], v[78:81]
    v_mfma_f32_16x16x32_bf16 v[82:85], v[50:53], v[110:113], v[82:85]
    v_mfma_f32_16x16x32_bf16 v[86:89], v[46:49], v[114:117], v[86:89]
    v_mfma_f32_16x16x32_bf16 v[90:93], v[50:53], v[114:117], v[90:93]
    v_mfma_f32_16x16x32_bf16 v[94:97], v[46:49], v[118:121], v[94:97]
    v_mfma_f32_16x16x32_bf16 v[98:101], v[50:53], v[118:121], v[98:101]
    v_mfma_f32_16x16x32_bf16 v[102:105], v[46:49], v[122:125], v[102:105]
    v_mfma_f32_16x16x32_bf16 v[106:109], v[50:53], v[122:125], v[106:109]
    s_add_u32 s34, s33, 12288
    buffer_load_dwordx4 v[46:49], v2, s[8:11], s34 offen
    s_add_u32 s34, s33, 32768
    buffer_load_dwordx4 v[50:53], v2, s[8:11], s34 offen
    ds_read_b128 v[110:113], v7 offset:384
    ds_read_b128 v[114:117], v7 offset:20864
    ds_read_b128 v[118:121], v7 offset:41344
    ds_read_b128 v[122:125], v7 offset:61824
    s_waitcnt vmcnt(14) lgkmcnt(4)
    v_mfma_f32_16x16x32_bf16 v[78:81], v[54:57], v[126:129], v[78:81]
    v_mfma_f32_16x16x32_bf16 v[82:85], v[58:61], v[126:129], v[82:85]
    v_mfma_f32_16x16x32_bf16 v[86:89], v[54:57], v[130:133], v[86:89]
    v_mfma_f32_16x16x32_bf16 v[90:93], v[58:61], v[130:133], v[90:93]
    v_mfma_f32_16x16x32_bf16 v[94:97], v[54:57], v[134:137], v[94:97]
    v_mfma_f32_16x16x32_bf16 v[98:101], v[58:61], v[134:137], v[98:101]
    v_mfma_f32_16x16x32_bf16 v[102:105], v[54:57], v[138:141], v[102:105]
    v_mfma_f32_16x16x32_bf16 v[106:109], v[58:61], v[138:141], v[106:109]
    s_add_u32 s34, s33, 13312
    buffer_load_dwordx4 v[54:57], v2, s[8:11], s34 offen
    s_add_u32 s34, s33, 33792
    buffer_load_dwordx4 v[58:61], v2, s[8:11], s34 offen
    ds_read_b128 v[126:129], v6 offset:384
    ds_read_b128 v[130:133], v6 offset:20864
    ds_read_b128 v[134:137], v6 offset:41344
    ds_read_b128 v[138:141], v6 offset:61824
    s_waitcnt vmcnt(14) lgkmcnt(4)
    v_mfma_f32_16x16x32_bf16 v[78:81], v[62:65], v[110:113], v[78:81]
    v_mfma_f32_16x16x32_bf16 v[82:85], v[66:69], v[110:113], v[82:85]
    v_mfma_f32_16x16x32_bf16 v[86:89], v[62:65], v[114:117], v[86:89]
    v_mfma_f32_16x16x32_bf16 v[90:93], v[66:69], v[114:117], v[90:93]
    v_mfma_f32_16x16x32_bf16 v[94:97], v[62:65], v[118:121], v[94:97]
    v_mfma_f32_16x16x32_bf16 v[98:101], v[66:69], v[118:121], v[98:101]
    v_mfma_f32_16x16x32_bf16 v[102:105], v[62:65], v[122:125], v[102:105]
    v_mfma_f32_16x16x32_bf16 v[106:109], v[66:69], v[122:125], v[106:109]
    s_add_u32 s34, s33, 14336
    buffer_load_dwordx4 v[62:65], v2, s[8:11], s34 offen
    s_add_u32 s34, s33, 34816
    buffer_load_dwordx4 v[66:69], v2, s[8:11], s34 offen
    ds_read_b128 v[110:113], v7 offset:512
    ds_read_b128 v[114:117], v7 offset:20992
    ds_read_b128 v[118:121], v7 offset:41472
    ds_read_b128 v[122:125], v7 offset:61952
    s_waitcnt vmcnt(14) lgkmcnt(4)
    v_mfma_f32_16x16x32_bf16 v[78:81], v[70:73], v[126:129], v[78:81]
    v_mfma_f32_16x16x32_bf16 v[82:85], v[74:77], v[126:129], v[82:85]
    v_mfma_f32_16x16x32_bf16 v[86:89], v[70:73], v[130:133], v[86:89]
    v_mfma_f32_16x16x32_bf16 v[90:93], v[74:77], v[130:133], v[90:93]
    v_mfma_f32_16x16x32_bf16 v[94:97], v[70:73], v[134:137], v[94:97]
    v_mfma_f32_16x16x32_bf16 v[98:101], v[74:77], v[134:137], v[98:101]
    v_mfma_f32_16x16x32_bf16 v[102:105], v[70:73], v[138:141], v[102:105]
    v_mfma_f32_16x16x32_bf16 v[106:109], v[74:77], v[138:141], v[106:109]
    s_add_u32 s34, s33, 15360
    buffer_load_dwordx4 v[70:73], v2, s[8:11], s34 offen
    s_add_u32 s34, s33, 35840
    buffer_load_dwordx4 v[74:77], v2, s[8:11], s34 offen
    ds_read_b128 v[126:129], v6 offset:512
    ds_read_b128 v[130:133], v6 offset:20992
    ds_read_b128 v[134:137], v6 offset:41472
    ds_read_b128 v[138:141], v6 offset:61952
    s_waitcnt vmcnt(14) lgkmcnt(4)
    v_mfma_f32_16x16x32_bf16 v[78:81], v[14:17], v[110:113], v[78:81]
    v_mfma_f32_16x16x32_bf16 v[82:85], v[18:21], v[110:113], v[82:85]
    v_mfma_f32_16x16x32_bf16 v[86:89], v[14:17], v[114:117], v[86:89]
    v_mfma_f32_16x16x32_bf16 v[90:93], v[18:21], v[114:117], v[90:93]
    v_mfma_f32_16x16x32_bf16 v[94:97], v[14:17], v[118:121], v[94:97]
    v_mfma_f32_16x16x32_bf16 v[98:101], v[18:21], v[118:121], v[98:101]
    v_mfma_f32_16x16x32_bf16 v[102:105], v[14:17], v[122:125], v[102:105]
    v_mfma_f32_16x16x32_bf16 v[106:109], v[18:21], v[122:125], v[106:109]
    s_add_u32 s34, s33, 16384
    buffer_load_dwordx4 v[14:17], v2, s[8:11], s34 offen
    s_add_u32 s34, s33, 36864
    buffer_load_dwordx4 v[18:21], v2, s[8:11], s34 offen
    ds_read_b128 v[110:113], v7 offset:640
    ds_read_b128 v[114:117], v7 offset:21120
    ds_read_b128 v[118:121], v7 offset:41600
    ds_read_b128 v[122:125], v7 offset:62080
    s_waitcnt vmcnt(14) lgkmcnt(4)
    v_mfma_f32_16x16x32_bf16 v[78:81], v[22:25], v[126:129], v[78:81]
    v_mfma_f32_16x16x32_bf16 v[82:85], v[26:29], v[126:129], v[82:85]
    v_mfma_f32_16x16x32_bf16 v[86:89], v[22:25], v[130:133], v[86:89]
    v_mfma_f32_16x16x32_bf16 v[90:93], v[26:29], v[130:133], v[90:93]
    v_mfma_f32_16x16x32_bf16 v[94:97], v[22:25], v[134:137], v[94:97]
    v_mfma_f32_16x16x32_bf16 v[98:101], v[26:29], v[134:137], v[98:101]
    v_mfma_f32_16x16x32_bf16 v[102:105], v[22:25], v[138:141], v[102:105]
    v_mfma_f32_16x16x32_bf16 v[106:109], v[26:29], v[138:141], v[106:109]
    s_add_u32 s34, s33, 17408
    buffer_load_dwordx4 v[22:25], v2, s[8:11], s34 offen
    s_add_u32 s34, s33, 37888
    buffer_load_dwordx4 v[26:29], v2, s[8:11], s34 offen
    ds_read_b128 v[126:129], v6 offset:640
    ds_read_b128 v[130:133], v6 offset:21120
    ds_read_b128 v[134:137], v6 offset:41600
    ds_read_b128 v[138:141], v6 offset:62080
    s_waitcnt vmcnt(14) lgkmcnt(4)
    v_mfma_f32_16x16x32_bf16 v[78:81], v[30:33], v[110:113], v[78:81]
    v_mfma_f32_16x16x32_bf16 v[82:85], v[34:37], v[110:113], v[82:85]
    v_mfma_f32_16x16x32_bf16 v[86:89], v[30:33], v[114:117], v[86:89]
    v_mfma_f32_16x16x32_bf16 v[90:93], v[34:37], v[114:117], v[90:93]
    v_mfma_f32_16x16x32_bf16 v[94:97], v[30:33], v[118:121], v[94:97]
    v_mfma_f32_16x16x32_bf16 v[98:101], v[34:37], v[118:121], v[98:101]
    v_mfma_f32_16x16x32_bf16 v[102:105], v[30:33], v[122:125], v[102:105]
    v_mfma_f32_16x16x32_bf16 v[106:109], v[34:37], v[122:125], v[106:109]
    s_add_u32 s34, s33, 18432
    buffer_load_dwordx4 v[30:33], v2, s[8:11], s34 offen
    s_add_u32 s34, s33, 38912
    buffer_load_dwordx4 v[34:37], v2, s[8:11], s34 offen
    ds_read_b128 v[110:113], v7 offset:768
    ds_read_b128 v[114:117], v7 offset:21248
    ds_read_b128 v[118:121], v7 offset:41728
    ds_read_b128 v[122:125], v7 offset:62208
    s_waitcnt vmcnt(14) lgkmcnt(4)
    v_mfma_f32_16x16x32_bf16 v[78:81], v[38:41], v[126:129], v[78:81]
    v_mfma_f32_16x16x32_bf16 v[82:85], v[42:45], v[126:129], v[82:85]
    v_mfma_f32_16x16x32_bf16 v[86:89], v[38:41], v[130:133], v[86:89]
    v_mfma_f32_16x16x32_bf16 v[90:93], v[42:45], v[130:133], v[90:93]
    v_mfma_f32_16x16x32_bf16 v[94:97], v[38:41], v[134:137], v[94:97]
    v_mfma_f32_16x16x32_bf16 v[98:101], v[42:45], v[134:137], v[98:101]
    v_mfma_f32_16x16x32_bf16 v[102:105], v[38:41], v[138:141], v[102:105]
    v_mfma_f32_16x16x32_bf16 v[106:109], v[42:45], v[138:141], v[106:109]
    s_add_u32 s34, s33, 19456
    buffer_load_dwordx4 v[38:41], v2, s[8:11], s34 offen
    s_add_u32 s34, s33, 39936
    buffer_load_dwordx4 v[42:45], v2, s[8:11], s34 offen
    ds_read_b128 v[126:129], v6 offset:768
    ds_read_b128 v[130:133], v6 offset:21248
    ds_read_b128 v[134:137], v6 offset:41728
    ds_read_b128 v[138:141], v6 offset:62208
    s_waitcnt vmcnt(14) lgkmcnt(4)
    v_mfma_f32_16x16x32_bf16 v[78:81], v[46:49], v[110:113], v[78:81]
    v_mfma_f32_16x16x32_bf16 v[82:85], v[50:53], v[110:113], v[82:85]
    v_mfma_f32_16x16x32_bf16 v[86:89], v[46:49], v[114:117], v[86:89]
    v_mfma_f32_16x16x32_bf16 v[90:93], v[50:53], v[114:117], v[90:93]
    v_mfma_f32_16x16x32_bf16 v[94:97], v[46:49], v[118:121], v[94:97]
    v_mfma_f32_16x16x32_bf16 v[98:101], v[50:53], v[118:121], v[98:101]
    v_mfma_f32_16x16x32_bf16 v[102:105], v[46:49], v[122:125], v[102:105]
    v_mfma_f32_16x16x32_bf16 v[106:109], v[50:53], v[122:125], v[106:109]
    ds_read_b128 v[110:113], v7 offset:896
    ds_read_b128 v[114:117], v7 offset:21376
    ds_read_b128 v[118:121], v7 offset:41856
    ds_read_b128 v[122:125], v7 offset:62336
    s_waitcnt vmcnt(12) lgkmcnt(4)
    v_mfma_f32_16x16x32_bf16 v[78:81], v[54:57], v[126:129], v[78:81]
    v_mfma_f32_16x16x32_bf16 v[82:85], v[58:61], v[126:129], v[82:85]
    v_mfma_f32_16x16x32_bf16 v[86:89], v[54:57], v[130:133], v[86:89]
    v_mfma_f32_16x16x32_bf16 v[90:93], v[58:61], v[130:133], v[90:93]
    v_mfma_f32_16x16x32_bf16 v[94:97], v[54:57], v[134:137], v[94:97]
    v_mfma_f32_16x16x32_bf16 v[98:101], v[58:61], v[134:137], v[98:101]
    v_mfma_f32_16x16x32_bf16 v[102:105], v[54:57], v[138:141], v[102:105]
    v_mfma_f32_16x16x32_bf16 v[106:109], v[58:61], v[138:141], v[106:109]
    ds_read_b128 v[126:129], v6 offset:896
    ds_read_b128 v[130:133], v6 offset:21376
    ds_read_b128 v[134:137], v6 offset:41856
    ds_read_b128 v[138:141], v6 offset:62336
    s_waitcnt vmcnt(10) lgkmcnt(4)
    v_mfma_f32_16x16x32_bf16 v[78:81], v[62:65], v[110:113], v[78:81]
    v_mfma_f32_16x16x32_bf16 v[82:85], v[66:69], v[110:113], v[82:85]
    v_mfma_f32_16x16x32_bf16 v[86:89], v[62:65], v[114:117], v[86:89]
    v_mfma_f32_16x16x32_bf16 v[90:93], v[66:69], v[114:117], v[90:93]
    v_mfma_f32_16x16x32_bf16 v[94:97], v[62:65], v[118:121], v[94:97]
    v_mfma_f32_16x16x32_bf16 v[98:101], v[66:69], v[118:121], v[98:101]
    v_mfma_f32_16x16x32_bf16 v[102:105], v[62:65], v[122:125], v[102:105]
    v_mfma_f32_16x16x32_bf16 v[106:109], v[66:69], v[122:125], v[106:109]
    ds_read_b128 v[110:113], v7 offset:1024
    ds_read_b128 v[114:117], v7 offset:21504
    ds_read_b128 v[118:121], v7 offset:41984
    ds_read_b128 v[122:125], v7 offset:62464
    s_waitcnt vmcnt(8) lgkmcnt(4)
    v_mfma_f32_16x16x32_bf16 v[78:81], v[70:73], v[126:129], v[78:81]
    v_mfma_f32_16x16x32_bf16 v[82:85], v[74:77], v[126:129], v[82:85]
    v_mfma_f32_16x16x32_bf16 v[86:89], v[70:73], v[130:133], v[86:89]
    v_mfma_f32_16x16x32_bf16 v[90:93], v[74:77], v[130:133], v[90:93]
    v_mfma_f32_16x16x32_bf16 v[94:97], v[70:73], v[134:137], v[94:97]
    v_mfma_f32_16x16x32_bf16 v[98:101], v[74:77], v[134:137], v[98:101]
    v_mfma_f32_16x16x32_bf16 v[102:105], v[70:73], v[138:141], v[102:105]
    v_mfma_f32_16x16x32_bf16 v[106:109], v[74:77], v[138:141], v[106:109]
    ds_read_b128 v[126:129], v6 offset:1024
    ds_read_b128 v[130:133], v6 offset:21504
    ds_read_b128 v[134:137], v6 offset:41984
    ds_read_b128 v[138:141], v6 offset:62464
    s_waitcnt vmcnt(6) lgkmcnt(4)
    v_mfma_f32_16x16x32_bf16 v[78:81], v[14:17], v[110:113], v[78:81]
    v_mfma_f32_16x16x32_bf16 v[82:85], v[18:21], v[110:113], v[82:85]
    v_mfma_f32_16x16x32_bf16 v[86:89], v[14:17], v[114:117], v[86:89]
    v_mfma_f32_16x16x32_bf16 v[90:93], v[18:21], v[114:117], v[90:93]
    v_mfma_f32_16x16x32_bf16 v[94:97], v[14:17], v[118:121], v[94:97]
    v_mfma_f32_16x16x32_bf16 v[98:101], v[18:21], v[118:121], v[98:101]
    v_mfma_f32_16x16x32_bf16 v[102:105], v[14:17], v[122:125], v[102:105]
    v_mfma_f32_16x16x32_bf16 v[106:109], v[18:21], v[122:125], v[106:109]
    ds_read_b128 v[110:113], v7 offset:1152
    ds_read_b128 v[114:117], v7 offset:21632
    ds_read_b128 v[118:121], v7 offset:42112
    ds_read_b128 v[122:125], v7 offset:62592
    s_waitcnt vmcnt(4) lgkmcnt(4)
    v_mfma_f32_16x16x32_bf16 v[78:81], v[22:25], v[126:129], v[78:81]
    v_mfma_f32_16x16x32_bf16 v[82:85], v[26:29], v[126:129], v[82:85]
    v_mfma_f32_16x16x32_bf16 v[86:89], v[22:25], v[130:133], v[86:89]
    v_mfma_f32_16x16x32_bf16 v[90:93], v[26:29], v[130:133], v[90:93]
    v_mfma_f32_16x16x32_bf16 v[94:97], v[22:25], v[134:137], v[94:97]
    v_mfma_f32_16x16x32_bf16 v[98:101], v[26:29], v[134:137], v[98:101]
    v_mfma_f32_16x16x32_bf16 v[102:105], v[22:25], v[138:141], v[102:105]
    v_mfma_f32_16x16x32_bf16 v[106:109], v[26:29], v[138:141], v[106:109]
    ds_read_b128 v[126:129], v6 offset:1152
    ds_read_b128 v[130:133], v6 offset:21632
    ds_read_b128 v[134:137], v6 offset:42112
    ds_read_b128 v[138:141], v6 offset:62592
    s_waitcnt vmcnt(2) lgkmcnt(4)
    v_mfma_f32_16x16x32_bf16 v[78:81], v[30:33], v[110:113], v[78:81]
    v_mfma_f32_16x16x32_bf16 v[82:85], v[34:37], v[110:113], v[82:85]
    v_mfma_f32_16x16x32_bf16 v[86:89], v[30:33], v[114:117], v[86:89]
    v_mfma_f32_16x16x32_bf16 v[90:93], v[34:37], v[114:117], v[90:93]
    v_mfma_f32_16x16x32_bf16 v[94:97], v[30:33], v[118:121], v[94:97]
    v_mfma_f32_16x16x32_bf16 v[98:101], v[34:37], v[118:121], v[98:101]
    v_mfma_f32_16x16x32_bf16 v[102:105], v[30:33], v[122:125], v[102:105]
    v_mfma_f32_16x16x32_bf16 v[106:109], v[34:37], v[122:125], v[106:109]
    s_waitcnt vmcnt(0) lgkmcnt(0)
    v_mfma_f32_16x16x32_bf16 v[78:81], v[38:41], v[126:129], v[78:81]
    v_mfma_f32_16x16x32_bf16 v[82:85], v[42:45], v[126:129], v[82:85]
    v_mfma_f32_16x16x32_bf16 v[86:89], v[38:41], v[130:133], v[86:89]
    v_mfma_f32_16x16x32_bf16 v[90:93], v[42:45], v[130:133], v[90:93]
    v_mfma_f32_16x16x32_bf16 v[94:97], v[38:41], v[134:137], v[94:97]
    v_mfma_f32_16x16x32_bf16 v[98:101], v[42:45], v[134:137], v[98:101]
    v_mfma_f32_16x16x32_bf16 v[102:105], v[38:41], v[138:141], v[102:105]
    v_mfma_f32_16x16x32_bf16 v[106:109], v[42:45], v[138:141], v[106:109]
    s_nop 7
    s_nop 7
    v_mul_f32 v110, 0x3fb8aa3b, v78
    v_exp_f32 v110, v110
    v_add_f32 v111, 1.0, v78
    v_cmp_lt_f32 vcc, 0, v78
    s_nop 1
    v_cndmask_b32 v78, v110, v111, vcc
    v_add_f32 v78, 0x358637bd, v78
    v_mul_f32 v110, 0x3fb8aa3b, v79
    v_exp_f32 v110, v110
    v_add_f32 v111, 1.0, v79
    v_cmp_lt_f32 vcc, 0, v79
    s_nop 1
    v_cndmask_b32 v79, v110, v111, vcc
    v_add_f32 v79, 0x358637bd, v79
    v_mul_f32 v110, 0x3fb8aa3b, v80
    v_exp_f32 v110, v110
    v_add_f32 v111, 1.0, v80
    v_cmp_lt_f32 vcc, 0, v80
    s_nop 1
    v_cndmask_b32 v80, v110, v111, vcc
    v_add_f32 v80, 0x358637bd, v80
    v_mul_f32 v110, 0x3fb8aa3b, v81
    v_exp_f32 v110, v110
    v_add_f32 v111, 1.0, v81
    v_cmp_lt_f32 vcc, 0, v81
    s_nop 1
    v_cndmask_b32 v81, v110, v111, vcc
    v_add_f32 v81, 0x358637bd, v81
    v_cvt_pk_bf16_f32 v78, v78, v79
    v_cvt_pk_bf16_f32 v79, v80, v81
    s_mov_b32 s34, 8847360
    buffer_store_dwordx2 v[78:79], v5, s[8:11], s34 offen
    v_mul_f32 v110, 0x3fb8aa3b, v82
    v_exp_f32 v110, v110
    v_add_f32 v111, 1.0, v82
    v_cmp_lt_f32 vcc, 0, v82
    s_nop 1
    v_cndmask_b32 v82, v110, v111, vcc
    v_add_f32 v82, 0x358637bd, v82
    v_mul_f32 v110, 0x3fb8aa3b, v83
    v_exp_f32 v110, v110
    v_add_f32 v111, 1.0, v83
    v_cmp_lt_f32 vcc, 0, v83
    s_nop 1
    v_cndmask_b32 v83, v110, v111, vcc
    v_add_f32 v83, 0x358637bd, v83
    v_mul_f32 v110, 0x3fb8aa3b, v84
    v_exp_f32 v110, v110
    v_add_f32 v111, 1.0, v84
    v_cmp_lt_f32 vcc, 0, v84
    s_nop 1
    v_cndmask_b32 v84, v110, v111, vcc
    v_add_f32 v84, 0x358637bd, v84
    v_mul_f32 v110, 0x3fb8aa3b, v85
    v_exp_f32 v110, v110
    v_add_f32 v111, 1.0, v85
    v_cmp_lt_f32 vcc, 0, v85
    s_nop 1
    v_cndmask_b32 v85, v110, v111, vcc
    v_add_f32 v85, 0x358637bd, v85
    v_cvt_pk_bf16_f32 v82, v82, v83
    v_cvt_pk_bf16_f32 v83, v84, v85
    s_mov_b32 s34, 8847392
    buffer_store_dwordx2 v[82:83], v5, s[8:11], s34 offen
    v_mul_f32 v110, 0x3fb8aa3b, v86
    v_exp_f32 v110, v110
    v_add_f32 v111, 1.0, v86
    v_cmp_lt_f32 vcc, 0, v86
    s_nop 1
    v_cndmask_b32 v86, v110, v111, vcc
    v_add_f32 v86, 0x358637bd, v86
    v_mul_f32 v110, 0x3fb8aa3b, v87
    v_exp_f32 v110, v110
    v_add_f32 v111, 1.0, v87
    v_cmp_lt_f32 vcc, 0, v87
    s_nop 1
    v_cndmask_b32 v87, v110, v111, vcc
    v_add_f32 v87, 0x358637bd, v87
    v_mul_f32 v110, 0x3fb8aa3b, v88
    v_exp_f32 v110, v110
    v_add_f32 v111, 1.0, v88
    v_cmp_lt_f32 vcc, 0, v88
    s_nop 1
    v_cndmask_b32 v88, v110, v111, vcc
    v_add_f32 v88, 0x358637bd, v88
    v_mul_f32 v110, 0x3fb8aa3b, v89
    v_exp_f32 v110, v110
    v_add_f32 v111, 1.0, v89
    v_cmp_lt_f32 vcc, 0, v89
    s_nop 1
    v_cndmask_b32 v89, v110, v111, vcc
    v_add_f32 v89, 0x358637bd, v89
    v_cvt_pk_bf16_f32 v86, v86, v87
    v_cvt_pk_bf16_f32 v87, v88, v89
    s_mov_b32 s34, 8867840
    buffer_store_dwordx2 v[86:87], v5, s[8:11], s34 offen
    v_mul_f32 v110, 0x3fb8aa3b, v90
    v_exp_f32 v110, v110
    v_add_f32 v111, 1.0, v90
    v_cmp_lt_f32 vcc, 0, v90
    s_nop 1
    v_cndmask_b32 v90, v110, v111, vcc
    v_add_f32 v90, 0x358637bd, v90
    v_mul_f32 v110, 0x3fb8aa3b, v91
    v_exp_f32 v110, v110
    v_add_f32 v111, 1.0, v91
    v_cmp_lt_f32 vcc, 0, v91
    s_nop 1
    v_cndmask_b32 v91, v110, v111, vcc
    v_add_f32 v91, 0x358637bd, v91
    v_mul_f32 v110, 0x3fb8aa3b, v92
    v_exp_f32 v110, v110
    v_add_f32 v111, 1.0, v92
    v_cmp_lt_f32 vcc, 0, v92
    s_nop 1
    v_cndmask_b32 v92, v110, v111, vcc
    v_add_f32 v92, 0x358637bd, v92
    v_mul_f32 v110, 0x3fb8aa3b, v93
    v_exp_f32 v110, v110
    v_add_f32 v111, 1.0, v93
    v_cmp_lt_f32 vcc, 0, v93
    s_nop 1
    v_cndmask_b32 v93, v110, v111, vcc
    v_add_f32 v93, 0x358637bd, v93
    v_cvt_pk_bf16_f32 v90, v90, v91
    v_cvt_pk_bf16_f32 v91, v92, v93
    s_mov_b32 s34, 8867872
    buffer_store_dwordx2 v[90:91], v5, s[8:11], s34 offen
    v_mul_f32 v110, 0x3fb8aa3b, v94
    v_exp_f32 v110, v110
    v_add_f32 v111, 1.0, v94
    v_cmp_lt_f32 vcc, 0, v94
    s_nop 1
    v_cndmask_b32 v94, v110, v111, vcc
    v_add_f32 v94, 0x358637bd, v94
    v_mul_f32 v110, 0x3fb8aa3b, v95
    v_exp_f32 v110, v110
    v_add_f32 v111, 1.0, v95
    v_cmp_lt_f32 vcc, 0, v95
    s_nop 1
    v_cndmask_b32 v95, v110, v111, vcc
    v_add_f32 v95, 0x358637bd, v95
    v_mul_f32 v110, 0x3fb8aa3b, v96
    v_exp_f32 v110, v110
    v_add_f32 v111, 1.0, v96
    v_cmp_lt_f32 vcc, 0, v96
    s_nop 1
    v_cndmask_b32 v96, v110, v111, vcc
    v_add_f32 v96, 0x358637bd, v96
    v_mul_f32 v110, 0x3fb8aa3b, v97
    v_exp_f32 v110, v110
    v_add_f32 v111, 1.0, v97
    v_cmp_lt_f32 vcc, 0, v97
    s_nop 1
    v_cndmask_b32 v97, v110, v111, vcc
    v_add_f32 v97, 0x358637bd, v97
    v_cvt_pk_bf16_f32 v94, v94, v95
    v_cvt_pk_bf16_f32 v95, v96, v97
    s_mov_b32 s34, 8888320
    buffer_store_dwordx2 v[94:95], v5, s[8:11], s34 offen
    v_mul_f32 v110, 0x3fb8aa3b, v98
    v_exp_f32 v110, v110
    v_add_f32 v111, 1.0, v98
    v_cmp_lt_f32 vcc, 0, v98
    s_nop 1
    v_cndmask_b32 v98, v110, v111, vcc
    v_add_f32 v98, 0x358637bd, v98
    v_mul_f32 v110, 0x3fb8aa3b, v99
    v_exp_f32 v110, v110
    v_add_f32 v111, 1.0, v99
    v_cmp_lt_f32 vcc, 0, v99
    s_nop 1
    v_cndmask_b32 v99, v110, v111, vcc
    v_add_f32 v99, 0x358637bd, v99
    v_mul_f32 v110, 0x3fb8aa3b, v100
    v_exp_f32 v110, v110
    v_add_f32 v111, 1.0, v100
    v_cmp_lt_f32 vcc, 0, v100
    s_nop 1
    v_cndmask_b32 v100, v110, v111, vcc
    v_add_f32 v100, 0x358637bd, v100
    v_mul_f32 v110, 0x3fb8aa3b, v101
    v_exp_f32 v110, v110
    v_add_f32 v111, 1.0, v101
    v_cmp_lt_f32 vcc, 0, v101
    s_nop 1
    v_cndmask_b32 v101, v110, v111, vcc
    v_add_f32 v101, 0x358637bd, v101
    v_cvt_pk_bf16_f32 v98, v98, v99
    v_cvt_pk_bf16_f32 v99, v100, v101
    s_mov_b32 s34, 8888352
    buffer_store_dwordx2 v[98:99], v5, s[8:11], s34 offen
    v_mul_f32 v110, 0x3fb8aa3b, v102
    v_exp_f32 v110, v110
    v_add_f32 v111, 1.0, v102
    v_cmp_lt_f32 vcc, 0, v102
    s_nop 1
    v_cndmask_b32 v102, v110, v111, vcc
    v_add_f32 v102, 0x358637bd, v102
    v_mul_f32 v110, 0x3fb8aa3b, v103
    v_exp_f32 v110, v110
    v_add_f32 v111, 1.0, v103
    v_cmp_lt_f32 vcc, 0, v103
    s_nop 1
    v_cndmask_b32 v103, v110, v111, vcc
    v_add_f32 v103, 0x358637bd, v103
    v_mul_f32 v110, 0x3fb8aa3b, v104
    v_exp_f32 v110, v110
    v_add_f32 v111, 1.0, v104
    v_cmp_lt_f32 vcc, 0, v104
    s_nop 1
    v_cndmask_b32 v104, v110, v111, vcc
    v_add_f32 v104, 0x358637bd, v104
    v_mul_f32 v110, 0x3fb8aa3b, v105
    v_exp_f32 v110, v110
    v_add_f32 v111, 1.0, v105
    v_cmp_lt_f32 vcc, 0, v105
    s_nop 1
    v_cndmask_b32 v105, v110, v111, vcc
    v_add_f32 v105, 0x358637bd, v105
    v_cvt_pk_bf16_f32 v102, v102, v103
    v_cvt_pk_bf16_f32 v103, v104, v105
    s_mov_b32 s34, 8908800
    buffer_store_dwordx2 v[102:103], v5, s[8:11], s34 offen
    v_mul_f32 v110, 0x3fb8aa3b, v106
    v_exp_f32 v110, v110
    v_add_f32 v111, 1.0, v106
    v_cmp_lt_f32 vcc, 0, v106
    s_nop 1
    v_cndmask_b32 v106, v110, v111, vcc
    v_add_f32 v106, 0x358637bd, v106
    v_mul_f32 v110, 0x3fb8aa3b, v107
    v_exp_f32 v110, v110
    v_add_f32 v111, 1.0, v107
    v_cmp_lt_f32 vcc, 0, v107
    s_nop 1
    v_cndmask_b32 v107, v110, v111, vcc
    v_add_f32 v107, 0x358637bd, v107
    v_mul_f32 v110, 0x3fb8aa3b, v108
    v_exp_f32 v110, v110
    v_add_f32 v111, 1.0, v108
    v_cmp_lt_f32 vcc, 0, v108
    s_nop 1
    v_cndmask_b32 v108, v110, v111, vcc
    v_add_f32 v108, 0x358637bd, v108
    v_mul_f32 v110, 0x3fb8aa3b, v109
    v_exp_f32 v110, v110
    v_add_f32 v111, 1.0, v109
    v_cmp_lt_f32 vcc, 0, v109
    s_nop 1
    v_cndmask_b32 v109, v110, v111, vcc
    v_add_f32 v109, 0x358637bd, v109
    v_cvt_pk_bf16_f32 v106, v106, v107
    v_cvt_pk_bf16_f32 v107, v108, v109
    s_mov_b32 s34, 8908832
    buffer_store_dwordx2 v[106:107], v5, s[8:11], s34 offen
qq_k_done:
    s_endpgm
.globl kv_kernel
.p2align 8
.type kv_kernel,@function
kv_kernel:
    s_cmp_ge_u32 s2, 256
    s_cbranch_scc1 kv_k_done
    s_load_dwordx2 s[4:5], s[0:1], 80
    s_load_dwordx2 s[6:7], s[0:1], 0
    s_load_dwordx2 s[28:29], s[0:1], 64
    s_mul_hi_u32 s30, s2, 536870913
    s_mul_i32 s31, s30, 8
    s_sub_u32 s31, s2, s31
    v_lshrrev_b32 v1, 6, v0
    s_nop 0
    v_readfirstlane_b32 s32, v1
    v_and_b32 v1, 63, v0
    s_waitcnt lgkmcnt(0)
    s_mov_b32 s8, s4
    s_mov_b32 s9, s5
    s_and_b32 s9, s9, 0xffff
    s_mov_b32 s10, 268435456
    s_mov_b32 s11, 0x00020000
    s_mov_b32 s12, s6
    s_mov_b32 s13, s7
    s_and_b32 s13, s13, 0xffff
    s_mov_b32 s14, 2621440
    s_mov_b32 s15, 0x00020000
    s_mov_b32 s16, s28
    s_mov_b32 s17, s29
    s_and_b32 s17, s17, 0xffff
    s_mov_b32 s18, 2621440
    s_mov_b32 s19, 0x00020000
    s_mul_i32 s33, s31, 5
    s_add_u32 s33, s33, s32
    s_mul_i32 s33, s33, 40960
    s_add_u32 s33, s33, 819200
    v_lshlrev_b32 v2, 4, v1
    s_add_u32 s34, s33, 0
    buffer_load_dwordx4 v[14:17], v2, s[8:11], s34 offen
    s_add_u32 s34, s33, 20480
    buffer_load_dwordx4 v[18:21], v2, s[8:11], s34 offen
    s_add_u32 s34, s33, 1024
    buffer_load_dwordx4 v[22:25], v2, s[8:11], s34 offen
    s_add_u32 s34, s33, 21504
    buffer_load_dwordx4 v[26:29], v2, s[8:11], s34 offen
    s_add_u32 s34, s33, 2048
    buffer_load_dwordx4 v[30:33], v2, s[8:11], s34 offen
    s_add_u32 s34, s33, 22528
    buffer_load_dwordx4 v[34:37], v2, s[8:11], s34 offen
    s_add_u32 s34, s33, 3072
    buffer_load_dwordx4 v[38:41], v2, s[8:11], s34 offen
    s_add_u32 s34, s33, 23552
    buffer_load_dwordx4 v[42:45], v2, s[8:11], s34 offen
    s_add_u32 s34, s33, 4096
    buffer_load_dwordx4 v[46:49], v2, s[8:11], s34 offen
    s_add_u32 s34, s33, 24576
    buffer_load_dwordx4 v[50:53], v2, s[8:11], s34 offen
    s_add_u32 s34, s33, 5120
    buffer_load_dwordx4 v[54:57], v2, s[8:11], s34 offen
    s_add_u32 s34, s33, 25600
    buffer_load_dwordx4 v[58:61], v2, s[8:11], s34 offen
    s_add_u32 s34, s33, 6144
    buffer_load_dwordx4 v[62:65], v2, s[8:11], s34 offen
    s_add_u32 s34, s33, 26624
    buffer_load_dwordx4 v[66:69], v2, s[8:11], s34 offen
    s_add_u32 s34, s33, 7168
    buffer_load_dwordx4 v[70:73], v2, s[8:11], s34 offen
    s_add_u32 s34, s33, 27648
    buffer_load_dwordx4 v[74:77], v2, s[8:11], s34 offen
    v_and_b32 v3, 15, v1
    v_lshrrev_b32 v4, 4, v1
    s_lshl_b32 s35, s30, 6
    v_add_u32 v5, s35, v3
    s_mov_b32 s36, 1280
    v_mul_lo_u32 v5, v5, s36
    s_mul_i32 s36, s31, 320
    s_mul_i32 s37, s32, 64
    s_add_u32 s36, s36, s37
    v_lshl_add_u32 v5, v4, 3, v5
    v_add_u32 v5, s36, v5
    v_and_b32 v6, 7, v1
    v_xor_b32 v7, v4, v6
    v_or_b32 v6, 4, v4
    v_and_b32 v3, 7, v1
    v_xor_b32 v6, v6, v3
    v_and_b32 v3, 15, v1
    v_mul_u32_u24 v3, 1280, v3
    v_lshl_add_u32 v7, v7, 4, v3
    v_lshl_add_u32 v6, v6, 4, v3
    v_mov_b32 v78, 0
    v_mov_b32 v79, 0
    v_mov_b32 v80, 0
    v_mov_b32 v81, 0
    v_mov_b32 v82, 0
    v_mov_b32 v83, 0
    v_mov_b32 v84, 0
    v_mov_b32 v85, 0
    v_mov_b32 v86, 0
    v_mov_b32 v87, 0
    v_mov_b32 v88, 0
    v_mov_b32 v89, 0
    v_mov_b32 v90, 0
    v_mov_b32 v91, 0
    v_mov_b32 v92, 0
    v_mov_b32 v93, 0
    v_mov_b32 v94, 0
    v_mov_b32 v95, 0
    v_mov_b32 v96, 0
    v_mov_b32 v97, 0
    v_mov_b32 v98, 0
    v_mov_b32 v99, 0
    v_mov_b32 v100, 0
    v_mov_b32 v101, 0
    v_mov_b32 v102, 0
    v_mov_b32 v103, 0
    v_mov_b32 v104, 0
    v_mov_b32 v105, 0
    v_mov_b32 v106, 0
    v_mov_b32 v107, 0
    v_mov_b32 v108, 0
    v_mov_b32 v109, 0
    s_cmp_ge_u32 s32, 4
    s_cbranch_scc1 kv_k_psk0
    v_and_b32 v3, 15, v1
    s_lshl_b32 s34, s32, 4
    s_add_u32 s34, s34, s35
    v_add_u32 v8, s34, v4
    s_mov_b32 s34, 1280
    v_mul_lo_u32 v8, v8, s34
    v_lshl_add_u32 v8, v3, 4, v8
    s_lshl_b32 s34, s32, 4
    v_add_u32 v9, s34, v4
    v_mul_u32_u24 v9, 1280, v9
    s_mov_b32 s34, 0
    buffer_load_dwordx4 v[110:113], v8, s[12:15], s34 offen
    s_mov_b32 s34, 256
    buffer_load_dwordx4 v[114:117], v8, s[12:15], s34 offen
    s_mov_b32 s34, 512
    buffer_load_dwordx4 v[118:121], v8, s[12:15], s34 offen
    s_mov_b32 s34, 768
    buffer_load_dwordx4 v[122:125], v8, s[12:15], s34 offen
    s_mov_b32 s34, 1024
    buffer_load_dwordx4 v[126:129], v8, s[12:15], s34 offen
    s_mov_b32 s34, 5120
    buffer_load_dwordx4 v[130:133], v8, s[12:15], s34 offen
    s_mov_b32 s34, 5376
    buffer_load_dwordx4 v[134:137], v8, s[12:15], s34 offen
    s_mov_b32 s34, 5632
    buffer_load_dwordx4 v[138:141], v8, s[12:15], s34 offen
    s_mov_b32 s34, 5888
    buffer_load_dwordx4 v[142:145], v8, s[12:15], s34 offen
    s_mov_b32 s34, 6144
    buffer_load_dwordx4 v[146:149], v8, s[12:15], s34 offen
    s_mov_b32 s34, 10240
    buffer_load_dwordx4 v[150:153], v8, s[12:15], s34 offen
    s_mov_b32 s34, 10496
    buffer_load_dwordx4 v[154:157], v8, s[12:15], s34 offen
    s_mov_b32 s34, 10752
    buffer_load_dwordx4 v[158:161], v8, s[12:15], s34 offen
    s_mov_b32 s34, 11008
    buffer_load_dwordx4 v[162:165], v8, s[12:15], s34 offen
    s_mov_b32 s34, 11264
    buffer_load_dwordx4 v[166:169], v8, s[12:15], s34 offen
    s_mov_b32 s34, 15360
    buffer_load_dwordx4 v[170:173], v8, s[12:15], s34 offen
    s_mov_b32 s34, 15616
    buffer_load_dwordx4 v[174:177], v8, s[12:15], s34 offen
    s_mov_b32 s34, 15872
    buffer_load_dwordx4 v[178:181], v8, s[12:15], s34 offen
    s_mov_b32 s34, 16128
    buffer_load_dwordx4 v[182:185], v8, s[12:15], s34 offen
    s_mov_b32 s34, 16384
    buffer_load_dwordx4 v[186:189], v8, s[12:15], s34 offen
    s_waitcnt vmcnt(15)
    v_lshlrev_b32 v190, 16, v110
    v_and_b32 v191, 0xffff0000, v110
    v_lshlrev_b32 v192, 16, v111
    v_and_b32 v193, 0xffff0000, v111
    v_lshlrev_b32 v194, 16, v112
    v_and_b32 v195, 0xffff0000, v112
    v_lshlrev_b32 v196, 16, v113
    v_and_b32 v197, 0xffff0000, v113
    v_lshlrev_b32 v198, 16, v114
    v_and_b32 v199, 0xffff0000, v114
    v_lshlrev_b32 v200, 16, v115
    v_and_b32 v201, 0xffff0000, v115
    v_lshlrev_b32 v202, 16, v116
    v_and_b32 v203, 0xffff0000, v116
    v_lshlrev_b32 v204, 16, v117
    v_and_b32 v205, 0xffff0000, v117
    v_lshlrev_b32 v206, 16, v118
    v_and_b32 v207, 0xffff0000, v118
    v_lshlrev_b32 v208, 16, v119
    v_and_b32 v209, 0xffff0000, v119
    v_lshlrev_b32 v210, 16, v120
    v_and_b32 v211, 0xffff0000, v120
    v_lshlrev_b32 v212, 16, v121
    v_and_b32 v213, 0xffff0000, v121
    v_lshlrev_b32 v214, 16, v122
    v_and_b32 v215, 0xffff0000, v122
    v_lshlrev_b32 v216, 16, v123
    v_and_b32 v217, 0xffff0000, v123
    v_lshlrev_b32 v218, 16, v124
    v_and_b32 v219, 0xffff0000, v124
    v_lshlrev_b32 v220, 16, v125
    v_and_b32 v221, 0xffff0000, v125
    v_lshlrev_b32 v222, 16, v126
    v_and_b32 v223, 0xffff0000, v126
    v_lshlrev_b32 v224, 16, v127
    v_and_b32 v225, 0xffff0000, v127
    v_lshlrev_b32 v226, 16, v128
    v_and_b32 v227, 0xffff0000, v128
    v_lshlrev_b32 v228, 16, v129
    v_and_b32 v229, 0xffff0000, v129
    v_add_f32 v230, v190, v191
    v_add_f32 v230, v230, v192
    v_add_f32 v230, v230, v193
    v_add_f32 v230, v230, v194
    v_add_f32 v230, v230, v195
    v_add_f32 v230, v230, v196
    v_add_f32 v230, v230, v197
    v_add_f32 v230, v230, v198
    v_add_f32 v230, v230, v199
    v_add_f32 v230, v230, v200
    v_add_f32 v230, v230, v201
    v_add_f32 v230, v230, v202
    v_add_f32 v230, v230, v203
    v_add_f32 v230, v230, v204
    v_add_f32 v230, v230, v205
    v_add_f32 v230, v230, v206
    v_add_f32 v230, v230, v207
    v_add_f32 v230, v230, v208
    v_add_f32 v230, v230, v209
    v_add_f32 v230, v230, v210
    v_add_f32 v230, v230, v211
    v_add_f32 v230, v230, v212
    v_add_f32 v230, v230, v213
    v_add_f32 v230, v230, v214
    v_add_f32 v230, v230, v215
    v_add_f32 v230, v230, v216
    v_add_f32 v230, v230, v217
    v_add_f32 v230, v230, v218
    v_add_f32 v230, v230, v219
    v_add_f32 v230, v230, v220
    v_add_f32 v230, v230, v221
    v_add_f32 v230, v230, v222
    v_add_f32 v230, v230, v223
    v_add_f32 v230, v230, v224
    v_add_f32 v230, v230, v225
    v_add_f32 v230, v230, v226
    v_add_f32 v230, v230, v227
    v_add_f32 v230, v230, v228
    v_add_f32 v230, v230, v229
    s_nop 1
    v_add_f32_dpp v230, v230, v230 row_ror:8 row_mask:0xf bank_mask:0xf
    s_nop 1
    v_add_f32_dpp v230, v230, v230 row_ror:4 row_mask:0xf bank_mask:0xf
    s_nop 1
    v_add_f32_dpp v230, v230, v230 row_ror:2 row_mask:0xf bank_mask:0xf
    s_nop 1
    v_add_f32_dpp v230, v230, v230 row_ror:1 row_mask:0xf bank_mask:0xf
    v_mul_f32 v230, 0.0015625, v230
    v_sub_f32 v190, v190, v230
    v_sub_f32 v191, v191, v230
    v_sub_f32 v192, v192, v230
    v_sub_f32 v193, v193, v230
    v_sub_f32 v194, v194, v230
    v_sub_f32 v195, v195, v230
    v_sub_f32 v196, v196, v230
    v_sub_f32 v197, v197, v230
    v_sub_f32 v198, v198, v230
    v_sub_f32 v199, v199, v230
    v_sub_f32 v200, v200, v230
    v_sub_f32 v201, v201, v230
    v_sub_f32 v202, v202, v230
    v_sub_f32 v203, v203, v230
    v_sub_f32 v204, v204, v230
    v_sub_f32 v205, v205, v230
    v_sub_f32 v206, v206, v230
    v_sub_f32 v207, v207, v230
    v_sub_f32 v208, v208, v230
    v_sub_f32 v209, v209, v230
    v_sub_f32 v210, v210, v230
    v_sub_f32 v211, v211, v230
    v_sub_f32 v212, v212, v230
    v_sub_f32 v213, v213, v230
    v_sub_f32 v214, v214, v230
    v_sub_f32 v215, v215, v230
    v_sub_f32 v216, v216, v230
    v_sub_f32 v217, v217, v230
    v_sub_f32 v218, v218, v230
    v_sub_f32 v219, v219, v230
    v_sub_f32 v220, v220, v230
    v_sub_f32 v221, v221, v230
    v_sub_f32 v222, v222, v230
    v_sub_f32 v223, v223, v230
    v_sub_f32 v224, v224, v230
    v_sub_f32 v225, v225, v230
    v_sub_f32 v226, v226, v230
    v_sub_f32 v227, v227, v230
    v_sub_f32 v228, v228, v230
    v_sub_f32 v229, v229, v230
    v_mul_f32 v230, v190, v190
    v_fmac_f32 v230, v191, v191
    v_fmac_f32 v230, v192, v192
    v_fmac_f32 v230, v193, v193
    v_fmac_f32 v230, v194, v194
    v_fmac_f32 v230, v195, v195
    v_fmac_f32 v230, v196, v196
    v_fmac_f32 v230, v197, v197
    v_fmac_f32 v230, v198, v198
    v_fmac_f32 v230, v199, v199
    v_fmac_f32 v230, v200, v200
    v_fmac_f32 v230, v201, v201
    v_fmac_f32 v230, v202, v202
    v_fmac_f32 v230, v203, v203
    v_fmac_f32 v230, v204, v204
    v_fmac_f32 v230, v205, v205
    v_fmac_f32 v230, v206, v206
    v_fmac_f32 v230, v207, v207
    v_fmac_f32 v230, v208, v208
    v_fmac_f32 v230, v209, v209
    v_fmac_f32 v230, v210, v210
    v_fmac_f32 v230, v211, v211
    v_fmac_f32 v230, v212, v212
    v_fmac_f32 v230, v213, v213
    v_fmac_f32 v230, v214, v214
    v_fmac_f32 v230, v215, v215
    v_fmac_f32 v230, v216, v216
    v_fmac_f32 v230, v217, v217
    v_fmac_f32 v230, v218, v218
    v_fmac_f32 v230, v219, v219
    v_fmac_f32 v230, v220, v220
    v_fmac_f32 v230, v221, v221
    v_fmac_f32 v230, v222, v222
    v_fmac_f32 v230, v223, v223
    v_fmac_f32 v230, v224, v224
    v_fmac_f32 v230, v225, v225
    v_fmac_f32 v230, v226, v226
    v_fmac_f32 v230, v227, v227
    v_fmac_f32 v230, v228, v228
    v_fmac_f32 v230, v229, v229
    s_nop 1
    v_add_f32_dpp v230, v230, v230 row_ror:8 row_mask:0xf bank_mask:0xf
    s_nop 1
    v_add_f32_dpp v230, v230, v230 row_ror:4 row_mask:0xf bank_mask:0xf
    s_nop 1
    v_add_f32_dpp v230, v230, v230 row_ror:2 row_mask:0xf bank_mask:0xf
    s_nop 1
    v_add_f32_dpp v230, v230, v230 row_ror:1 row_mask:0xf bank_mask:0xf
    v_mov_b32 v231, 0x3727c5ac
    v_fmac_f32 v231, 0.0015625, v230
    v_rsq_f32 v231, v231
    s_nop 0
    v_mul_f32 v190, v190, v231
    v_mul_f32 v191, v191, v231
    v_mul_f32 v192, v192, v231
    v_mul_f32 v193, v193, v231
    v_mul_f32 v194, v194, v231
    v_mul_f32 v195, v195, v231
    v_mul_f32 v196, v196, v231
    v_mul_f32 v197, v197, v231
    v_mul_f32 v198, v198, v231
    v_mul_f32 v199, v199, v231
    v_mul_f32 v200, v200, v231
    v_mul_f32 v201, v201, v231
    v_mul_f32 v202, v202, v231
    v_mul_f32 v203, v203, v231
    v_mul_f32 v204, v204, v231
    v_mul_f32 v205, v205, v231
    v_mul_f32 v206, v206, v231
    v_mul_f32 v207, v207, v231
    v_mul_f32 v208, v208, v231
    v_mul_f32 v209, v209, v231
    v_mul_f32 v210, v210, v231
    v_mul_f32 v211, v211, v231
    v_mul_f32 v212, v212, v231
    v_mul_f32 v213, v213, v231
    v_mul_f32 v214, v214, v231
    v_mul_f32 v215, v215, v231
    v_mul_f32 v216, v216, v231
    v_mul_f32 v217, v217, v231
    v_mul_f32 v218, v218, v231
    v_mul_f32 v219, v219, v231
    v_mul_f32 v220, v220, v231
    v_mul_f32 v221, v221, v231
    v_mul_f32 v222, v222, v231
    v_mul_f32 v223, v223, v231
    v_mul_f32 v224, v224, v231
    v_mul_f32 v225, v225, v231
    v_mul_f32 v226, v226, v231
    v_mul_f32 v227, v227, v231
    v_mul_f32 v228, v228, v231
    v_mul_f32 v229, v229, v231
    v_and_b32 v3, 15, v1
    v_add_u32 v10, 0, v4
    v_xor_b32 v3, v3, v10
    v_lshl_add_u32 v3, v3, 4, v9
    v_cvt_pk_bf16_f32 v190, v190, v191
    v_cvt_pk_bf16_f32 v191, v192, v193
    v_cvt_pk_bf16_f32 v192, v194, v195
    v_cvt_pk_bf16_f32 v193, v196, v197
    ds_write_b128 v3, v[190:193] offset:0
    v_cvt_pk_bf16_f32 v198, v198, v199
    v_cvt_pk_bf16_f32 v199, v200, v201
    v_cvt_pk_bf16_f32 v200, v202, v203
    v_cvt_pk_bf16_f32 v201, v204, v205
    ds_write_b128 v3, v[198:201] offset:256
    v_cvt_pk_bf16_f32 v206, v206, v207
    v_cvt_pk_bf16_f32 v207, v208, v209
    v_cvt_pk_bf16_f32 v208, v210, v211
    v_cvt_pk_bf16_f32 v209, v212, v213
    ds_write_b128 v3, v[206:209] offset:512
    v_cvt_pk_bf16_f32 v214, v214, v215
    v_cvt_pk_bf16_f32 v215, v216, v217
    v_cvt_pk_bf16_f32 v216, v218, v219
    v_cvt_pk_bf16_f32 v217, v220, v221
    ds_write_b128 v3, v[214:217] offset:768
    v_cvt_pk_bf16_f32 v222, v222, v223
    v_cvt_pk_bf16_f32 v223, v224, v225
    v_cvt_pk_bf16_f32 v224, v226, v227
    v_cvt_pk_bf16_f32 v225, v228, v229
    ds_write_b128 v3, v[222:225] offset:1024
    s_nop 0
    s_waitcnt vmcnt(10)
    v_lshlrev_b32 v190, 16, v130
    v_and_b32 v191, 0xffff0000, v130
    v_lshlrev_b32 v192, 16, v131
    v_and_b32 v193, 0xffff0000, v131
    v_lshlrev_b32 v194, 16, v132
    v_and_b32 v195, 0xffff0000, v132
    v_lshlrev_b32 v196, 16, v133
    v_and_b32 v197, 0xffff0000, v133
    v_lshlrev_b32 v198, 16, v134
    v_and_b32 v199, 0xffff0000, v134
    v_lshlrev_b32 v200, 16, v135
    v_and_b32 v201, 0xffff0000, v135
    v_lshlrev_b32 v202, 16, v136
    v_and_b32 v203, 0xffff0000, v136
    v_lshlrev_b32 v204, 16, v137
    v_and_b32 v205, 0xffff0000, v137
    v_lshlrev_b32 v206, 16, v138
    v_and_b32 v207, 0xffff0000, v138
    v_lshlrev_b32 v208, 16, v139
    v_and_b32 v209, 0xffff0000, v139
    v_lshlrev_b32 v210, 16, v140
    v_and_b32 v211, 0xffff0000, v140
    v_lshlrev_b32 v212, 16, v141
    v_and_b32 v213, 0xffff0000, v141
    v_lshlrev_b32 v214, 16, v142
    v_and_b32 v215, 0xffff0000, v142
    v_lshlrev_b32 v216, 16, v143
    v_and_b32 v217, 0xffff0000, v143
    v_lshlrev_b32 v218, 16, v144
    v_and_b32 v219, 0xffff0000, v144
    v_lshlrev_b32 v220, 16, v145
    v_and_b32 v221, 0xffff0000, v145
    v_lshlrev_b32 v222, 16, v146
    v_and_b32 v223, 0xffff0000, v146
    v_lshlrev_b32 v224, 16, v147
    v_and_b32 v225, 0xffff0000, v147
    v_lshlrev_b32 v226, 16, v148
    v_and_b32 v227, 0xffff0000, v148
    v_lshlrev_b32 v228, 16, v149
    v_and_b32 v229, 0xffff0000, v149
    v_add_f32 v230, v190, v191
    v_add_f32 v230, v230, v192
    v_add_f32 v230, v230, v193
    v_add_f32 v230, v230, v194
    v_add_f32 v230, v230, v195
    v_add_f32 v230, v230, v196
    v_add_f32 v230, v230, v197
    v_add_f32 v230, v230, v198
    v_add_f32 v230, v230, v199
    v_add_f32 v230, v230, v200
    v_add_f32 v230, v230, v201
    v_add_f32 v230, v230, v202
    v_add_f32 v230, v230, v203
    v_add_f32 v230, v230, v204
    v_add_f32 v230, v230, v205
    v_add_f32 v230, v230, v206
    v_add_f32 v230, v230, v207
    v_add_f32 v230, v230, v208
    v_add_f32 v230, v230, v209
    v_add_f32 v230, v230, v210
    v_add_f32 v230, v230, v211
    v_add_f32 v230, v230, v212
    v_add_f32 v230, v230, v213
    v_add_f32 v230, v230, v214
    v_add_f32 v230, v230, v215
    v_add_f32 v230, v230, v216
    v_add_f32 v230, v230, v217
    v_add_f32 v230, v230, v218
    v_add_f32 v230, v230, v219
    v_add_f32 v230, v230, v220
    v_add_f32 v230, v230, v221
    v_add_f32 v230, v230, v222
    v_add_f32 v230, v230, v223
    v_add_f32 v230, v230, v224
    v_add_f32 v230, v230, v225
    v_add_f32 v230, v230, v226
    v_add_f32 v230, v230, v227
    v_add_f32 v230, v230, v228
    v_add_f32 v230, v230, v229
    s_nop 1
    v_add_f32_dpp v230, v230, v230 row_ror:8 row_mask:0xf bank_mask:0xf
    s_nop 1
    v_add_f32_dpp v230, v230, v230 row_ror:4 row_mask:0xf bank_mask:0xf
    s_nop 1
    v_add_f32_dpp v230, v230, v230 row_ror:2 row_mask:0xf bank_mask:0xf
    s_nop 1
    v_add_f32_dpp v230, v230, v230 row_ror:1 row_mask:0xf bank_mask:0xf
    v_mul_f32 v230, 0.0015625, v230
    v_sub_f32 v190, v190, v230
    v_sub_f32 v191, v191, v230
    v_sub_f32 v192, v192, v230
    v_sub_f32 v193, v193, v230
    v_sub_f32 v194, v194, v230
    v_sub_f32 v195, v195, v230
    v_sub_f32 v196, v196, v230
    v_sub_f32 v197, v197, v230
    v_sub_f32 v198, v198, v230
    v_sub_f32 v199, v199, v230
    v_sub_f32 v200, v200, v230
    v_sub_f32 v201, v201, v230
    v_sub_f32 v202, v202, v230
    v_sub_f32 v203, v203, v230
    v_sub_f32 v204, v204, v230
    v_sub_f32 v205, v205, v230
    v_sub_f32 v206, v206, v230
    v_sub_f32 v207, v207, v230
    v_sub_f32 v208, v208, v230
    v_sub_f32 v209, v209, v230
    v_sub_f32 v210, v210, v230
    v_sub_f32 v211, v211, v230
    v_sub_f32 v212, v212, v230
    v_sub_f32 v213, v213, v230
    v_sub_f32 v214, v214, v230
    v_sub_f32 v215, v215, v230
    v_sub_f32 v216, v216, v230
    v_sub_f32 v217, v217, v230
    v_sub_f32 v218, v218, v230
    v_sub_f32 v219, v219, v230
    v_sub_f32 v220, v220, v230
    v_sub_f32 v221, v221, v230
    v_sub_f32 v222, v222, v230
    v_sub_f32 v223, v223, v230
    v_sub_f32 v224, v224, v230
    v_sub_f32 v225, v225, v230
    v_sub_f32 v226, v226, v230
    v_sub_f32 v227, v227, v230
    v_sub_f32 v228, v228, v230
    v_sub_f32 v229, v229, v230
    v_mul_f32 v230, v190, v190
    v_fmac_f32 v230, v191, v191
    v_fmac_f32 v230, v192, v192
    v_fmac_f32 v230, v193, v193
    v_fmac_f32 v230, v194, v194
    v_fmac_f32 v230, v195, v195
    v_fmac_f32 v230, v196, v196
    v_fmac_f32 v230, v197, v197
    v_fmac_f32 v230, v198, v198
    v_fmac_f32 v230, v199, v199
    v_fmac_f32 v230, v200, v200
    v_fmac_f32 v230, v201, v201
    v_fmac_f32 v230, v202, v202
    v_fmac_f32 v230, v203, v203
    v_fmac_f32 v230, v204, v204
    v_fmac_f32 v230, v205, v205
    v_fmac_f32 v230, v206, v206
    v_fmac_f32 v230, v207, v207
    v_fmac_f32 v230, v208, v208
    v_fmac_f32 v230, v209, v209
    v_fmac_f32 v230, v210, v210
    v_fmac_f32 v230, v211, v211
    v_fmac_f32 v230, v212, v212
    v_fmac_f32 v230, v213, v213
    v_fmac_f32 v230, v214, v214
    v_fmac_f32 v230, v215, v215
    v_fmac_f32 v230, v216, v216
    v_fmac_f32 v230, v217, v217
    v_fmac_f32 v230, v218, v218
    v_fmac_f32 v230, v219, v219
    v_fmac_f32 v230, v220, v220
    v_fmac_f32 v230, v221, v221
    v_fmac_f32 v230, v222, v222
    v_fmac_f32 v230, v223, v223
    v_fmac_f32 v230, v224, v224
    v_fmac_f32 v230, v225, v225
    v_fmac_f32 v230, v226, v226
    v_fmac_f32 v230, v227, v227
    v_fmac_f32 v230, v228, v228
    v_fmac_f32 v230, v229, v229
    s_nop 1
    v_add_f32_dpp v230, v230, v230 row_ror:8 row_mask:0xf bank_mask:0xf
    s_nop 1
    v_add_f32_dpp v230, v230, v230 row_ror:4 row_mask:0xf bank_mask:0xf
    s_nop 1
    v_add_f32_dpp v230, v230, v230 row_ror:2 row_mask:0xf bank_mask:0xf
    s_nop 1
    v_add_f32_dpp v230, v230, v230 row_ror:1 row_mask:0xf bank_mask:0xf
    v_mov_b32 v231, 0x3727c5ac
    v_fmac_f32 v231, 0.0015625, v230
    v_rsq_f32 v231, v231
    s_nop 0
    v_mul_f32 v190, v190, v231
    v_mul_f32 v191, v191, v231
    v_mul_f32 v192, v192, v231
    v_mul_f32 v193, v193, v231
    v_mul_f32 v194, v194, v231
    v_mul_f32 v195, v195, v231
    v_mul_f32 v196, v196, v231
    v_mul_f32 v197, v197, v231
    v_mul_f32 v198, v198, v231
    v_mul_f32 v199, v199, v231
    v_mul_f32 v200, v200, v231
    v_mul_f32 v201, v201, v231
    v_mul_f32 v202, v202, v231
    v_mul_f32 v203, v203, v231
    v_mul_f32 v204, v204, v231
    v_mul_f32 v205, v205, v231
    v_mul_f32 v206, v206, v231
    v_mul_f32 v207, v207, v231
    v_mul_f32 v208, v208, v231
    v_mul_f32 v209, v209, v231
    v_mul_f32 v210, v210, v231
    v_mul_f32 v211, v211, v231
    v_mul_f32 v212, v212, v231
    v_mul_f32 v213, v213, v231
    v_mul_f32 v214, v214, v231
    v_mul_f32 v215, v215, v231
    v_mul_f32 v216, v216, v231
    v_mul_f32 v217, v217, v231
    v_mul_f32 v218, v218, v231
    v_mul_f32 v219, v219, v231
    v_mul_f32 v220, v220, v231
    v_mul_f32 v221, v221, v231
    v_mul_f32 v222, v222, v231
    v_mul_f32 v223, v223, v231
    v_mul_f32 v224, v224, v231
    v_mul_f32 v225, v225, v231
    v_mul_f32 v226, v226, v231
    v_mul_f32 v227, v227, v231
    v_mul_f32 v228, v228, v231
    v_mul_f32 v229, v229, v231
    v_and_b32 v3, 15, v1
    v_add_u32 v10, 4, v4
    v_xor_b32 v3, v3, v10
    v_lshl_add_u32 v3, v3, 4, v9
    v_cvt_pk_bf16_f32 v190, v190, v191
    v_cvt_pk_bf16_f32 v191, v192, v193
    v_cvt_pk_bf16_f32 v192, v194, v195
    v_cvt_pk_bf16_f32 v193, v196, v197
    ds_write_b128 v3, v[190:193] offset:5120
    v_cvt_pk_bf16_f32 v198, v198, v199
    v_cvt_pk_bf16_f32 v199, v200, v201
    v_cvt_pk_bf16_f32 v200, v202, v203
    v_cvt_pk_bf16_f32 v201, v204, v205
    ds_write_b128 v3, v[198:201] offset:5376
    v_cvt_pk_bf16_f32 v206, v206, v207
    v_cvt_pk_bf16_f32 v207, v208, v209
    v_cvt_pk_bf16_f32 v208, v210, v211
    v_cvt_pk_bf16_f32 v209, v212, v213
    ds_write_b128 v3, v[206:209] offset:5632
    v_cvt_pk_bf16_f32 v214, v214, v215
    v_cvt_pk_bf16_f32 v215, v216, v217
    v_cvt_pk_bf16_f32 v216, v218, v219
    v_cvt_pk_bf16_f32 v217, v220, v221
    ds_write_b128 v3, v[214:217] offset:5888
    v_cvt_pk_bf16_f32 v222, v222, v223
    v_cvt_pk_bf16_f32 v223, v224, v225
    v_cvt_pk_bf16_f32 v224, v226, v227
    v_cvt_pk_bf16_f32 v225, v228, v229
    ds_write_b128 v3, v[222:225] offset:6144
    s_nop 0
    s_waitcnt vmcnt(5)
    v_lshlrev_b32 v190, 16, v150
    v_and_b32 v191, 0xffff0000, v150
    v_lshlrev_b32 v192, 16, v151
    v_and_b32 v193, 0xffff0000, v151
    v_lshlrev_b32 v194, 16, v152
    v_and_b32 v195, 0xffff0000, v152
    v_lshlrev_b32 v196, 16, v153
    v_and_b32 v197, 0xffff0000, v153
    v_lshlrev_b32 v198, 16, v154
    v_and_b32 v199, 0xffff0000, v154
    v_lshlrev_b32 v200, 16, v155
    v_and_b32 v201, 0xffff0000, v155
    v_lshlrev_b32 v202, 16, v156
    v_and_b32 v203, 0xffff0000, v156
    v_lshlrev_b32 v204, 16, v157
    v_and_b32 v205, 0xffff0000, v157
    v_lshlrev_b32 v206, 16, v158
    v_and_b32 v207, 0xffff0000, v158
    v_lshlrev_b32 v208, 16, v159
    v_and_b32 v209, 0xffff0000, v159
    v_lshlrev_b32 v210, 16, v160
    v_and_b32 v211, 0xffff0000, v160
    v_lshlrev_b32 v212, 16, v161
    v_and_b32 v213, 0xffff0000, v161
    v_lshlrev_b32 v214, 16, v162
    v_and_b32 v215, 0xffff0000, v162
    v_lshlrev_b32 v216, 16, v163
    v_and_b32 v217, 0xffff0000, v163
    v_lshlrev_b32 v218, 16, v164
    v_and_b32 v219, 0xffff0000, v164
    v_lshlrev_b32 v220, 16, v165
    v_and_b32 v221, 0xffff0000, v165
    v_lshlrev_b32 v222, 16, v166
    v_and_b32 v223, 0xffff0000, v166
    v_lshlrev_b32 v224, 16, v167
    v_and_b32 v225, 0xffff0000, v167
    v_lshlrev_b32 v226, 16, v168
    v_and_b32 v227, 0xffff0000, v168
    v_lshlrev_b32 v228, 16, v169
    v_and_b32 v229, 0xffff0000, v169
    v_add_f32 v230, v190, v191
    v_add_f32 v230, v230, v192
    v_add_f32 v230, v230, v193
    v_add_f32 v230, v230, v194
    v_add_f32 v230, v230, v195
    v_add_f32 v230, v230, v196
    v_add_f32 v230, v230, v197
    v_add_f32 v230, v230, v198
    v_add_f32 v230, v230, v199
    v_add_f32 v230, v230, v200
    v_add_f32 v230, v230, v201
    v_add_f32 v230, v230, v202
    v_add_f32 v230, v230, v203
    v_add_f32 v230, v230, v204
    v_add_f32 v230, v230, v205
    v_add_f32 v230, v230, v206
    v_add_f32 v230, v230, v207
    v_add_f32 v230, v230, v208
    v_add_f32 v230, v230, v209
    v_add_f32 v230, v230, v210
    v_add_f32 v230, v230, v211
    v_add_f32 v230, v230, v212
    v_add_f32 v230, v230, v213
    v_add_f32 v230, v230, v214
    v_add_f32 v230, v230, v215
    v_add_f32 v230, v230, v216
    v_add_f32 v230, v230, v217
    v_add_f32 v230, v230, v218
    v_add_f32 v230, v230, v219
    v_add_f32 v230, v230, v220
    v_add_f32 v230, v230, v221
    v_add_f32 v230, v230, v222
    v_add_f32 v230, v230, v223
    v_add_f32 v230, v230, v224
    v_add_f32 v230, v230, v225
    v_add_f32 v230, v230, v226
    v_add_f32 v230, v230, v227
    v_add_f32 v230, v230, v228
    v_add_f32 v230, v230, v229
    s_nop 1
    v_add_f32_dpp v230, v230, v230 row_ror:8 row_mask:0xf bank_mask:0xf
    s_nop 1
    v_add_f32_dpp v230, v230, v230 row_ror:4 row_mask:0xf bank_mask:0xf
    s_nop 1
    v_add_f32_dpp v230, v230, v230 row_ror:2 row_mask:0xf bank_mask:0xf
    s_nop 1
    v_add_f32_dpp v230, v230, v230 row_ror:1 row_mask:0xf bank_mask:0xf
    v_mul_f32 v230, 0.0015625, v230
    v_sub_f32 v190, v190, v230
    v_sub_f32 v191, v191, v230
    v_sub_f32 v192, v192, v230
    v_sub_f32 v193, v193, v230
    v_sub_f32 v194, v194, v230
    v_sub_f32 v195, v195, v230
    v_sub_f32 v196, v196, v230
    v_sub_f32 v197, v197, v230
    v_sub_f32 v198, v198, v230
    v_sub_f32 v199, v199, v230
    v_sub_f32 v200, v200, v230
    v_sub_f32 v201, v201, v230
    v_sub_f32 v202, v202, v230
    v_sub_f32 v203, v203, v230
    v_sub_f32 v204, v204, v230
    v_sub_f32 v205, v205, v230
    v_sub_f32 v206, v206, v230
    v_sub_f32 v207, v207, v230
    v_sub_f32 v208, v208, v230
    v_sub_f32 v209, v209, v230
    v_sub_f32 v210, v210, v230
    v_sub_f32 v211, v211, v230
    v_sub_f32 v212, v212, v230
    v_sub_f32 v213, v213, v230
    v_sub_f32 v214, v214, v230
    v_sub_f32 v215, v215, v230
    v_sub_f32 v216, v216, v230
    v_sub_f32 v217, v217, v230
    v_sub_f32 v218, v218, v230
    v_sub_f32 v219, v219, v230
    v_sub_f32 v220, v220, v230
    v_sub_f32 v221, v221, v230
    v_sub_f32 v222, v222, v230
    v_sub_f32 v223, v223, v230
    v_sub_f32 v224, v224, v230
    v_sub_f32 v225, v225, v230
    v_sub_f32 v226, v226, v230
    v_sub_f32 v227, v227, v230
    v_sub_f32 v228, v228, v230
    v_sub_f32 v229, v229, v230
    v_mul_f32 v230, v190, v190
    v_fmac_f32 v230, v191, v191
    v_fmac_f32 v230, v192, v192
    v_fmac_f32 v230, v193, v193
    v_fmac_f32 v230, v194, v194
    v_fmac_f32 v230, v195, v195
    v_fmac_f32 v230, v196, v196
    v_fmac_f32 v230, v197, v197
    v_fmac_f32 v230, v198, v198
    v_fmac_f32 v230, v199, v199
    v_fmac_f32 v230, v200, v200
    v_fmac_f32 v230, v201, v201
    v_fmac_f32 v230, v202, v202
    v_fmac_f32 v230, v203, v203
    v_fmac_f32 v230, v204, v204
    v_fmac_f32 v230, v205, v205
    v_fmac_f32 v230, v206, v206
    v_fmac_f32 v230, v207, v207
    v_fmac_f32 v230, v208, v208
    v_fmac_f32 v230, v209, v209
    v_fmac_f32 v230, v210, v210
    v_fmac_f32 v230, v211, v211
    v_fmac_f32 v230, v212, v212
    v_fmac_f32 v230, v213, v213
    v_fmac_f32 v230, v214, v214
    v_fmac_f32 v230, v215, v215
    v_fmac_f32 v230, v216, v216
    v_fmac_f32 v230, v217, v217
    v_fmac_f32 v230, v218, v218
    v_fmac_f32 v230, v219, v219
    v_fmac_f32 v230, v220, v220
    v_fmac_f32 v230, v221, v221
    v_fmac_f32 v230, v222, v222
    v_fmac_f32 v230, v223, v223
    v_fmac_f32 v230, v224, v224
    v_fmac_f32 v230, v225, v225
    v_fmac_f32 v230, v226, v226
    v_fmac_f32 v230, v227, v227
    v_fmac_f32 v230, v228, v228
    v_fmac_f32 v230, v229, v229
    s_nop 1
    v_add_f32_dpp v230, v230, v230 row_ror:8 row_mask:0xf bank_mask:0xf
    s_nop 1
    v_add_f32_dpp v230, v230, v230 row_ror:4 row_mask:0xf bank_mask:0xf
    s_nop 1
    v_add_f32_dpp v230, v230, v230 row_ror:2 row_mask:0xf bank_mask:0xf
    s_nop 1
    v_add_f32_dpp v230, v230, v230 row_ror:1 row_mask:0xf bank_mask:0xf
    v_mov_b32 v231, 0x3727c5ac
    v_fmac_f32 v231, 0.0015625, v230
    v_rsq_f32 v231, v231
    s_nop 0
    v_mul_f32 v190, v190, v231
    v_mul_f32 v191, v191, v231
    v_mul_f32 v192, v192, v231
    v_mul_f32 v193, v193, v231
    v_mul_f32 v194, v194, v231
    v_mul_f32 v195, v195, v231
    v_mul_f32 v196, v196, v231
    v_mul_f32 v197, v197, v231
    v_mul_f32 v198, v198, v231
    v_mul_f32 v199, v199, v231
    v_mul_f32 v200, v200, v231
    v_mul_f32 v201, v201, v231
    v_mul_f32 v202, v202, v231
    v_mul_f32 v203, v203, v231
    v_mul_f32 v204, v204, v231
    v_mul_f32 v205, v205, v231
    v_mul_f32 v206, v206, v231
    v_mul_f32 v207, v207, v231
    v_mul_f32 v208, v208, v231
    v_mul_f32 v209, v209, v231
    v_mul_f32 v210, v210, v231
    v_mul_f32 v211, v211, v231
    v_mul_f32 v212, v212, v231
    v_mul_f32 v213, v213, v231
    v_mul_f32 v214, v214, v231
    v_mul_f32 v215, v215, v231
    v_mul_f32 v216, v216, v231
    v_mul_f32 v217, v217, v231
    v_mul_f32 v218, v218, v231
    v_mul_f32 v219, v219, v231
    v_mul_f32 v220, v220, v231
    v_mul_f32 v221, v221, v231
    v_mul_f32 v222, v222, v231
    v_mul_f32 v223, v223, v231
    v_mul_f32 v224, v224, v231
    v_mul_f32 v225, v225, v231
    v_mul_f32 v226, v226, v231
    v_mul_f32 v227, v227, v231
    v_mul_f32 v228, v228, v231
    v_mul_f32 v229, v229, v231
    v_and_b32 v3, 15, v1
    v_add_u32 v10, 0, v4
    v_xor_b32 v3, v3, v10
    v_lshl_add_u32 v3, v3, 4, v9
    v_cvt_pk_bf16_f32 v190, v190, v191
    v_cvt_pk_bf16_f32 v191, v192, v193
    v_cvt_pk_bf16_f32 v192, v194, v195
    v_cvt_pk_bf16_f32 v193, v196, v197
    ds_write_b128 v3, v[190:193] offset:10240
    v_cvt_pk_bf16_f32 v198, v198, v199
    v_cvt_pk_bf16_f32 v199, v200, v201
    v_cvt_pk_bf16_f32 v200, v202, v203
    v_cvt_pk_bf16_f32 v201, v204, v205
    ds_write_b128 v3, v[198:201] offset:10496
    v_cvt_pk_bf16_f32 v206, v206, v207
    v_cvt_pk_bf16_f32 v207, v208, v209
    v_cvt_pk_bf16_f32 v208, v210, v211
    v_cvt_pk_bf16_f32 v209, v212, v213
    ds_write_b128 v3, v[206:209] offset:10752
    v_cvt_pk_bf16_f32 v214, v214, v215
    v_cvt_pk_bf16_f32 v215, v216, v217
    v_cvt_pk_bf16_f32 v216, v218, v219
    v_cvt_pk_bf16_f32 v217, v220, v221
    ds_write_b128 v3, v[214:217] offset:11008
    v_cvt_pk_bf16_f32 v222, v222, v223
    v_cvt_pk_bf16_f32 v223, v224, v225
    v_cvt_pk_bf16_f32 v224, v226, v227
    v_cvt_pk_bf16_f32 v225, v228, v229
    ds_write_b128 v3, v[222:225] offset:11264
    s_nop 0
    s_waitcnt vmcnt(0)
    v_lshlrev_b32 v190, 16, v170
    v_and_b32 v191, 0xffff0000, v170
    v_lshlrev_b32 v192, 16, v171
    v_and_b32 v193, 0xffff0000, v171
    v_lshlrev_b32 v194, 16, v172
    v_and_b32 v195, 0xffff0000, v172
    v_lshlrev_b32 v196, 16, v173
    v_and_b32 v197, 0xffff0000, v173
    v_lshlrev_b32 v198, 16, v174
    v_and_b32 v199, 0xffff0000, v174
    v_lshlrev_b32 v200, 16, v175
    v_and_b32 v201, 0xffff0000, v175
    v_lshlrev_b32 v202, 16, v176
    v_and_b32 v203, 0xffff0000, v176
    v_lshlrev_b32 v204, 16, v177
    v_and_b32 v205, 0xffff0000, v177
    v_lshlrev_b32 v206, 16, v178
    v_and_b32 v207, 0xffff0000, v178
    v_lshlrev_b32 v208, 16, v179
    v_and_b32 v209, 0xffff0000, v179
    v_lshlrev_b32 v210, 16, v180
    v_and_b32 v211, 0xffff0000, v180
    v_lshlrev_b32 v212, 16, v181
    v_and_b32 v213, 0xffff0000, v181
    v_lshlrev_b32 v214, 16, v182
    v_and_b32 v215, 0xffff0000, v182
    v_lshlrev_b32 v216, 16, v183
    v_and_b32 v217, 0xffff0000, v183
    v_lshlrev_b32 v218, 16, v184
    v_and_b32 v219, 0xffff0000, v184
    v_lshlrev_b32 v220, 16, v185
    v_and_b32 v221, 0xffff0000, v185
    v_lshlrev_b32 v222, 16, v186
    v_and_b32 v223, 0xffff0000, v186
    v_lshlrev_b32 v224, 16, v187
    v_and_b32 v225, 0xffff0000, v187
    v_lshlrev_b32 v226, 16, v188
    v_and_b32 v227, 0xffff0000, v188
    v_lshlrev_b32 v228, 16, v189
    v_and_b32 v229, 0xffff0000, v189
    v_add_f32 v230, v190, v191
    v_add_f32 v230, v230, v192
    v_add_f32 v230, v230, v193
    v_add_f32 v230, v230, v194
    v_add_f32 v230, v230, v195
    v_add_f32 v230, v230, v196
    v_add_f32 v230, v230, v197
    v_add_f32 v230, v230, v198
    v_add_f32 v230, v230, v199
    v_add_f32 v230, v230, v200
    v_add_f32 v230, v230, v201
    v_add_f32 v230, v230, v202
    v_add_f32 v230, v230, v203
    v_add_f32 v230, v230, v204
    v_add_f32 v230, v230, v205
    v_add_f32 v230, v230, v206
    v_add_f32 v230, v230, v207
    v_add_f32 v230, v230, v208
    v_add_f32 v230, v230, v209
    v_add_f32 v230, v230, v210
    v_add_f32 v230, v230, v211
    v_add_f32 v230, v230, v212
    v_add_f32 v230, v230, v213
    v_add_f32 v230, v230, v214
    v_add_f32 v230, v230, v215
    v_add_f32 v230, v230, v216
    v_add_f32 v230, v230, v217
    v_add_f32 v230, v230, v218
    v_add_f32 v230, v230, v219
    v_add_f32 v230, v230, v220
    v_add_f32 v230, v230, v221
    v_add_f32 v230, v230, v222
    v_add_f32 v230, v230, v223
    v_add_f32 v230, v230, v224
    v_add_f32 v230, v230, v225
    v_add_f32 v230, v230, v226
    v_add_f32 v230, v230, v227
    v_add_f32 v230, v230, v228
    v_add_f32 v230, v230, v229
    s_nop 1
    v_add_f32_dpp v230, v230, v230 row_ror:8 row_mask:0xf bank_mask:0xf
    s_nop 1
    v_add_f32_dpp v230, v230, v230 row_ror:4 row_mask:0xf bank_mask:0xf
    s_nop 1
    v_add_f32_dpp v230, v230, v230 row_ror:2 row_mask:0xf bank_mask:0xf
    s_nop 1
    v_add_f32_dpp v230, v230, v230 row_ror:1 row_mask:0xf bank_mask:0xf
    v_mul_f32 v230, 0.0015625, v230
    v_sub_f32 v190, v190, v230
    v_sub_f32 v191, v191, v230
    v_sub_f32 v192, v192, v230
    v_sub_f32 v193, v193, v230
    v_sub_f32 v194, v194, v230
    v_sub_f32 v195, v195, v230
    v_sub_f32 v196, v196, v230
    v_sub_f32 v197, v197, v230
    v_sub_f32 v198, v198, v230
    v_sub_f32 v199, v199, v230
    v_sub_f32 v200, v200, v230
    v_sub_f32 v201, v201, v230
    v_sub_f32 v202, v202, v230
    v_sub_f32 v203, v203, v230
    v_sub_f32 v204, v204, v230
    v_sub_f32 v205, v205, v230
    v_sub_f32 v206, v206, v230
    v_sub_f32 v207, v207, v230
    v_sub_f32 v208, v208, v230
    v_sub_f32 v209, v209, v230
    v_sub_f32 v210, v210, v230
    v_sub_f32 v211, v211, v230
    v_sub_f32 v212, v212, v230
    v_sub_f32 v213, v213, v230
    v_sub_f32 v214, v214, v230
    v_sub_f32 v215, v215, v230
    v_sub_f32 v216, v216, v230
    v_sub_f32 v217, v217, v230
    v_sub_f32 v218, v218, v230
    v_sub_f32 v219, v219, v230
    v_sub_f32 v220, v220, v230
    v_sub_f32 v221, v221, v230
    v_sub_f32 v222, v222, v230
    v_sub_f32 v223, v223, v230
    v_sub_f32 v224, v224, v230
    v_sub_f32 v225, v225, v230
    v_sub_f32 v226, v226, v230
    v_sub_f32 v227, v227, v230
    v_sub_f32 v228, v228, v230
    v_sub_f32 v229, v229, v230
    v_mul_f32 v230, v190, v190
    v_fmac_f32 v230, v191, v191
    v_fmac_f32 v230, v192, v192
    v_fmac_f32 v230, v193, v193
    v_fmac_f32 v230, v194, v194
    v_fmac_f32 v230, v195, v195
    v_fmac_f32 v230, v196, v196
    v_fmac_f32 v230, v197, v197
    v_fmac_f32 v230, v198, v198
    v_fmac_f32 v230, v199, v199
    v_fmac_f32 v230, v200, v200
    v_fmac_f32 v230, v201, v201
    v_fmac_f32 v230, v202, v202
    v_fmac_f32 v230, v203, v203
    v_fmac_f32 v230, v204, v204
    v_fmac_f32 v230, v205, v205
    v_fmac_f32 v230, v206, v206
    v_fmac_f32 v230, v207, v207
    v_fmac_f32 v230, v208, v208
    v_fmac_f32 v230, v209, v209
    v_fmac_f32 v230, v210, v210
    v_fmac_f32 v230, v211, v211
    v_fmac_f32 v230, v212, v212
    v_fmac_f32 v230, v213, v213
    v_fmac_f32 v230, v214, v214
    v_fmac_f32 v230, v215, v215
    v_fmac_f32 v230, v216, v216
    v_fmac_f32 v230, v217, v217
    v_fmac_f32 v230, v218, v218
    v_fmac_f32 v230, v219, v219
    v_fmac_f32 v230, v220, v220
    v_fmac_f32 v230, v221, v221
    v_fmac_f32 v230, v222, v222
    v_fmac_f32 v230, v223, v223
    v_fmac_f32 v230, v224, v224
    v_fmac_f32 v230, v225, v225
    v_fmac_f32 v230, v226, v226
    v_fmac_f32 v230, v227, v227
    v_fmac_f32 v230, v228, v228
    v_fmac_f32 v230, v229, v229
    s_nop 1
    v_add_f32_dpp v230, v230, v230 row_ror:8 row_mask:0xf bank_mask:0xf
    s_nop 1
    v_add_f32_dpp v230, v230, v230 row_ror:4 row_mask:0xf bank_mask:0xf
    s_nop 1
    v_add_f32_dpp v230, v230, v230 row_ror:2 row_mask:0xf bank_mask:0xf
    s_nop 1
    v_add_f32_dpp v230, v230, v230 row_ror:1 row_mask:0xf bank_mask:0xf
    v_mov_b32 v231, 0x3727c5ac
    v_fmac_f32 v231, 0.0015625, v230
    v_rsq_f32 v231, v231
    s_nop 0
    v_mul_f32 v190, v190, v231
    v_mul_f32 v191, v191, v231
    v_mul_f32 v192, v192, v231
    v_mul_f32 v193, v193, v231
    v_mul_f32 v194, v194, v231
    v_mul_f32 v195, v195, v231
    v_mul_f32 v196, v196, v231
    v_mul_f32 v197, v197, v231
    v_mul_f32 v198, v198, v231
    v_mul_f32 v199, v199, v231
    v_mul_f32 v200, v200, v231
    v_mul_f32 v201, v201, v231
    v_mul_f32 v202, v202, v231
    v_mul_f32 v203, v203, v231
    v_mul_f32 v204, v204, v231
    v_mul_f32 v205, v205, v231
    v_mul_f32 v206, v206, v231
    v_mul_f32 v207, v207, v231
    v_mul_f32 v208, v208, v231
    v_mul_f32 v209, v209, v231
    v_mul_f32 v210, v210, v231
    v_mul_f32 v211, v211, v231
    v_mul_f32 v212, v212, v231
    v_mul_f32 v213, v213, v231
    v_mul_f32 v214, v214, v231
    v_mul_f32 v215, v215, v231
    v_mul_f32 v216, v216, v231
    v_mul_f32 v217, v217, v231
    v_mul_f32 v218, v218, v231
    v_mul_f32 v219, v219, v231
    v_mul_f32 v220, v220, v231
    v_mul_f32 v221, v221, v231
    v_mul_f32 v222, v222, v231
    v_mul_f32 v223, v223, v231
    v_mul_f32 v224, v224, v231
    v_mul_f32 v225, v225, v231
    v_mul_f32 v226, v226, v231
    v_mul_f32 v227, v227, v231
    v_mul_f32 v228, v228, v231
    v_mul_f32 v229, v229, v231
    v_and_b32 v3, 15, v1
    v_add_u32 v10, 4, v4
    v_xor_b32 v3, v3, v10
    v_lshl_add_u32 v3, v3, 4, v9
    v_cvt_pk_bf16_f32 v190, v190, v191
    v_cvt_pk_bf16_f32 v191, v192, v193
    v_cvt_pk_bf16_f32 v192, v194, v195
    v_cvt_pk_bf16_f32 v193, v196, v197
    ds_write_b128 v3, v[190:193] offset:15360
    v_cvt_pk_bf16_f32 v198, v198, v199
    v_cvt_pk_bf16_f32 v199, v200, v201
    v_cvt_pk_bf16_f32 v200, v202, v203
    v_cvt_pk_bf16_f32 v201, v204, v205
    ds_write_b128 v3, v[198:201] offset:15616
    v_cvt_pk_bf16_f32 v206, v206, v207
    v_cvt_pk_bf16_f32 v207, v208, v209
    v_cvt_pk_bf16_f32 v208, v210, v211
    v_cvt_pk_bf16_f32 v209, v212, v213
    ds_write_b128 v3, v[206:209] offset:15872
    v_cvt_pk_bf16_f32 v214, v214, v215
    v_cvt_pk_bf16_f32 v215, v216, v217
    v_cvt_pk_bf16_f32 v216, v218, v219
    v_cvt_pk_bf16_f32 v217, v220, v221
    ds_write_b128 v3, v[214:217] offset:16128
    v_cvt_pk_bf16_f32 v222, v222, v223
    v_cvt_pk_bf16_f32 v223, v224, v225
    v_cvt_pk_bf16_f32 v224, v226, v227
    v_cvt_pk_bf16_f32 v225, v228, v229
    ds_write_b128 v3, v[222:225] offset:16384
    s_nop 0
kv_k_psk0:
    s_waitcnt vmcnt(0) lgkmcnt(0)
    s_barrier
    ds_read_b128 v[110:113], v7 offset:0
    ds_read_b128 v[114:117], v7 offset:20480
    ds_read_b128 v[118:121], v7 offset:40960
    ds_read_b128 v[122:125], v7 offset:61440
    ds_read_b128 v[126:129], v6 offset:0
    ds_read_b128 v[130:133], v6 offset:20480
    ds_read_b128 v[134:137], v6 offset:40960
    ds_read_b128 v[138:141], v6 offset:61440
    s_waitcnt vmcnt(14) lgkmcnt(4)
    v_mfma_f32_16x16x32_bf16 v[78:81], v[110:113], v[14:17], v[78:81]
    v_mfma_f32_16x16x32_bf16 v[82:85], v[110:113], v[18:21], v[82:85]
    v_mfma_f32_16x16x32_bf16 v[86:89], v[114:117], v[14:17], v[86:89]
    v_mfma_f32_16x16x32_bf16 v[90:93], v[114:117], v[18:21], v[90:93]
    v_mfma_f32_16x16x32_bf16 v[94:97], v[118:121], v[14:17], v[94:97]
    v_mfma_f32_16x16x32_bf16 v[98:101], v[118:121], v[18:21], v[98:101]
    v_mfma_f32_16x16x32_bf16 v[102:105], v[122:125], v[14:17], v[102:105]
    v_mfma_f32_16x16x32_bf16 v[106:109], v[122:125], v[18:21], v[106:109]
    s_add_u32 s34, s33, 8192
    buffer_load_dwordx4 v[14:17], v2, s[8:11], s34 offen
    s_add_u32 s34, s33, 28672
    buffer_load_dwordx4 v[18:21], v2, s[8:11], s34 offen
    ds_read_b128 v[110:113], v7 offset:128
    ds_read_b128 v[114:117], v7 offset:20608
    ds_read_b128 v[118:121], v7 offset:41088
    ds_read_b128 v[122:125], v7 offset:61568
    s_waitcnt vmcnt(14) lgkmcnt(4)
    v_mfma_f32_16x16x32_bf16 v[78:81], v[126:129], v[22:25], v[78:81]
    v_mfma_f32_16x16x32_bf16 v[82:85], v[126:129], v[26:29], v[82:85]
    v_mfma_f32_16x16x32_bf16 v[86:89], v[130:133], v[22:25], v[86:89]
    v_mfma_f32_16x16x32_bf16 v[90:93], v[130:133], v[26:29], v[90:93]
    v_mfma_f32_16x16x32_bf16 v[94:97], v[134:137], v[22:25], v[94:97]
    v_mfma_f32_16x16x32_bf16 v[98:101], v[134:137], v[26:29], v[98:101]
    v_mfma_f32_16x16x32_bf16 v[102:105], v[138:141], v[22:25], v[102:105]
    v_mfma_f32_16x16x32_bf16 v[106:109], v[138:141], v[26:29], v[106:109]
    s_add_u32 s34, s33, 9216
    buffer_load_dwordx4 v[22:25], v2, s[8:11], s34 offen
    s_add_u32 s34, s33, 29696
    buffer_load_dwordx4 v[26:29], v2, s[8:11], s34 offen
    ds_read_b128 v[126:129], v6 offset:128
    ds_read_b128 v[130:133], v6 offset:20608
    ds_read_b128 v[134:137], v6 offset:41088
    ds_read_b128 v[138:141], v6 offset:61568
    s_waitcnt vmcnt(14) lgkmcnt(4)
    v_mfma_f32_16x16x32_bf16 v[78:81], v[110:113], v[30:33], v[78:81]
    v_mfma_f32_16x16x32_bf16 v[82:85], v[110:113], v[34:37], v[82:85]
    v_mfma_f32_16x16x32_bf16 v[86:89], v[114:117], v[30:33], v[86:89]
    v_mfma_f32_16x16x32_bf16 v[90:93], v[114:117], v[34:37], v[90:93]
    v_mfma_f32_16x16x32_bf16 v[94:97], v[118:121], v[30:33], v[94:97]
    v_mfma_f32_16x16x32_bf16 v[98:101], v[118:121], v[34:37], v[98:101]
    v_mfma_f32_16x16x32_bf16 v[102:105], v[122:125], v[30:33], v[102:105]
    v_mfma_f32_16x16x32_bf16 v[106:109], v[122:125], v[34:37], v[106:109]
    s_add_u32 s34, s33, 10240
    buffer_load_dwordx4 v[30:33], v2, s[8:11], s34 offen
    s_add_u32 s34, s33, 30720
    buffer_load_dwordx4 v[34:37], v2, s[8:11], s34 offen
    ds_read_b128 v[110:113], v7 offset:256
    ds_read_b128 v[114:117], v7 offset:20736
    ds_read_b128 v[118:121], v7 offset:41216
    ds_read_b128 v[122:125], v7 offset:61696
    s_waitcnt vmcnt(14) lgkmcnt(4)
    v_mfma_f32_16x16x32_bf16 v[78:81], v[126:129], v[38:41], v[78:81]
    v_mfma_f32_16x16x32_bf16 v[82:85], v[126:129], v[42:45], v[82:85]
    v_mfma_f32_16x16x32_bf16 v[86:89], v[130:133], v[38:41], v[86:89]
    v_mfma_f32_16x16x32_bf16 v[90:93], v[130:133], v[42:45], v[90:93]
    v_mfma_f32_16x16x32_bf16 v[94:97], v[134:137], v[38:41], v[94:97]
    v_mfma_f32_16x16x32_bf16 v[98:101], v[134:137], v[42:45], v[98:101]
    v_mfma_f32_16x16x32_bf16 v[102:105], v[138:141], v[38:41], v[102:105]
    v_mfma_f32_16x16x32_bf16 v[106:109], v[138:141], v[42:45], v[106:109]
    s_add_u32 s34, s33, 11264
    buffer_load_dwordx4 v[38:41], v2, s[8:11], s34 offen
    s_add_u32 s34, s33, 31744
    buffer_load_dwordx4 v[42:45], v2, s[8:11], s34 offen
    ds_read_b128 v[126:129], v6 offset:256
    ds_read_b128 v[130:133], v6 offset:20736
    ds_read_b128 v[134:137], v6 offset:41216
    ds_read_b128 v[138:141], v6 offset:61696
    s_waitcnt vmcnt(14) lgkmcnt(4)
    v_mfma_f32_16x16x32_bf16 v[78:81], v[110:113], v[46:49], v[78:81]
    v_mfma_f32_16x16x32_bf16 v[82:85], v[110:113], v[50:53], v[82:85]
    v_mfma_f32_16x16x32_bf16 v[86:89], v[114:117], v[46:49], v[86:89]
    v_mfma_f32_16x16x32_bf16 v[90:93], v[114:117], v[50:53], v[90:93]
    v_mfma_f32_16x16x32_bf16 v[94:97], v[118:121], v[46:49], v[94:97]
    v_mfma_f32_16x16x32_bf16 v[98:101], v[118:121], v[50:53], v[98:101]
    v_mfma_f32_16x16x32_bf16 v[102:105], v[122:125], v[46:49], v[102:105]
    v_mfma_f32_16x16x32_bf16 v[106:109], v[122:125], v[50:53], v[106:109]
    s_add_u32 s34, s33, 12288
    buffer_load_dwordx4 v[46:49], v2, s[8:11], s34 offen
    s_add_u32 s34, s33, 32768
    buffer_load_dwordx4 v[50:53], v2, s[8:11], s34 offen
    ds_read_b128 v[110:113], v7 offset:384
    ds_read_b128 v[114:117], v7 offset:20864
    ds_read_b128 v[118:121], v7 offset:41344
    ds_read_b128 v[122:125], v7 offset:61824
    s_waitcnt vmcnt(14) lgkmcnt(4)
    v_mfma_f32_16x16x32_bf16 v[78:81], v[126:129], v[54:57], v[78:81]
    v_mfma_f32_16x16x32_bf16 v[82:85], v[126:129], v[58:61], v[82:85]
    v_mfma_f32_16x16x32_bf16 v[86:89], v[130:133], v[54:57], v[86:89]
    v_mfma_f32_16x16x32_bf16 v[90:93], v[130:133], v[58:61], v[90:93]
    v_mfma_f32_16x16x32_bf16 v[94:97], v[134:137], v[54:57], v[94:97]
    v_mfma_f32_16x16x32_bf16 v[98:101], v[134:137], v[58:61], v[98:101]
    v_mfma_f32_16x16x32_bf16 v[102:105], v[138:141], v[54:57], v[102:105]
    v_mfma_f32_16x16x32_bf16 v[106:109], v[138:141], v[58:61], v[106:109]
    s_add_u32 s34, s33, 13312
    buffer_load_dwordx4 v[54:57], v2, s[8:11], s34 offen
    s_add_u32 s34, s33, 33792
    buffer_load_dwordx4 v[58:61], v2, s[8:11], s34 offen
    ds_read_b128 v[126:129], v6 offset:384
    ds_read_b128 v[130:133], v6 offset:20864
    ds_read_b128 v[134:137], v6 offset:41344
    ds_read_b128 v[138:141], v6 offset:61824
    s_waitcnt vmcnt(14) lgkmcnt(4)
    v_mfma_f32_16x16x32_bf16 v[78:81], v[110:113], v[62:65], v[78:81]
    v_mfma_f32_16x16x32_bf16 v[82:85], v[110:113], v[66:69], v[82:85]
    v_mfma_f32_16x16x32_bf16 v[86:89], v[114:117], v[62:65], v[86:89]
    v_mfma_f32_16x16x32_bf16 v[90:93], v[114:117], v[66:69], v[90:93]
    v_mfma_f32_16x16x32_bf16 v[94:97], v[118:121], v[62:65], v[94:97]
    v_mfma_f32_16x16x32_bf16 v[98:101], v[118:121], v[66:69], v[98:101]
    v_mfma_f32_16x16x32_bf16 v[102:105], v[122:125], v[62:65], v[102:105]
    v_mfma_f32_16x16x32_bf16 v[106:109], v[122:125], v[66:69], v[106:109]
    s_add_u32 s34, s33, 14336
    buffer_load_dwordx4 v[62:65], v2, s[8:11], s34 offen
    s_add_u32 s34, s33, 34816
    buffer_load_dwordx4 v[66:69], v2, s[8:11], s34 offen
    ds_read_b128 v[110:113], v7 offset:512
    ds_read_b128 v[114:117], v7 offset:20992
    ds_read_b128 v[118:121], v7 offset:41472
    ds_read_b128 v[122:125], v7 offset:61952
    s_waitcnt vmcnt(14) lgkmcnt(4)
    v_mfma_f32_16x16x32_bf16 v[78:81], v[126:129], v[70:73], v[78:81]
    v_mfma_f32_16x16x32_bf16 v[82:85], v[126:129], v[74:77], v[82:85]
    v_mfma_f32_16x16x32_bf16 v[86:89], v[130:133], v[70:73], v[86:89]
    v_mfma_f32_16x16x32_bf16 v[90:93], v[130:133], v[74:77], v[90:93]
    v_mfma_f32_16x16x32_bf16 v[94:97], v[134:137], v[70:73], v[94:97]
    v_mfma_f32_16x16x32_bf16 v[98:101], v[134:137], v[74:77], v[98:101]
    v_mfma_f32_16x16x32_bf16 v[102:105], v[138:141], v[70:73], v[102:105]
    v_mfma_f32_16x16x32_bf16 v[106:109], v[138:141], v[74:77], v[106:109]
    s_add_u32 s34, s33, 15360
    buffer_load_dwordx4 v[70:73], v2, s[8:11], s34 offen
    s_add_u32 s34, s33, 35840
    buffer_load_dwordx4 v[74:77], v2, s[8:11], s34 offen
    ds_read_b128 v[126:129], v6 offset:512
    ds_read_b128 v[130:133], v6 offset:20992
    ds_read_b128 v[134:137], v6 offset:41472
    ds_read_b128 v[138:141], v6 offset:61952
    s_waitcnt vmcnt(14) lgkmcnt(4)
    v_mfma_f32_16x16x32_bf16 v[78:81], v[110:113], v[14:17], v[78:81]
    v_mfma_f32_16x16x32_bf16 v[82:85], v[110:113], v[18:21], v[82:85]
    v_mfma_f32_16x16x32_bf16 v[86:89], v[114:117], v[14:17], v[86:89]
    v_mfma_f32_16x16x32_bf16 v[90:93], v[114:117], v[18:21], v[90:93]
    v_mfma_f32_16x16x32_bf16 v[94:97], v[118:121], v[14:17], v[94:97]
    v_mfma_f32_16x16x32_bf16 v[98:101], v[118:121], v[18:21], v[98:101]
    v_mfma_f32_16x16x32_bf16 v[102:105], v[122:125], v[14:17], v[102:105]
    v_mfma_f32_16x16x32_bf16 v[106:109], v[122:125], v[18:21], v[106:109]
    s_add_u32 s34, s33, 16384
    buffer_load_dwordx4 v[14:17], v2, s[8:11], s34 offen
    s_add_u32 s34, s33, 36864
    buffer_load_dwordx4 v[18:21], v2, s[8:11], s34 offen
    ds_read_b128 v[110:113], v7 offset:640
    ds_read_b128 v[114:117], v7 offset:21120
    ds_read_b128 v[118:121], v7 offset:41600
    ds_read_b128 v[122:125], v7 offset:62080
    s_waitcnt vmcnt(14) lgkmcnt(4)
    v_mfma_f32_16x16x32_bf16 v[78:81], v[126:129], v[22:25], v[78:81]
    v_mfma_f32_16x16x32_bf16 v[82:85], v[126:129], v[26:29], v[82:85]
    v_mfma_f32_16x16x32_bf16 v[86:89], v[130:133], v[22:25], v[86:89]
    v_mfma_f32_16x16x32_bf16 v[90:93], v[130:133], v[26:29], v[90:93]
    v_mfma_f32_16x16x32_bf16 v[94:97], v[134:137], v[22:25], v[94:97]
    v_mfma_f32_16x16x32_bf16 v[98:101], v[134:137], v[26:29], v[98:101]
    v_mfma_f32_16x16x32_bf16 v[102:105], v[138:141], v[22:25], v[102:105]
    v_mfma_f32_16x16x32_bf16 v[106:109], v[138:141], v[26:29], v[106:109]
    s_add_u32 s34, s33, 17408
    buffer_load_dwordx4 v[22:25], v2, s[8:11], s34 offen
    s_add_u32 s34, s33, 37888
    buffer_load_dwordx4 v[26:29], v2, s[8:11], s34 offen
    ds_read_b128 v[126:129], v6 offset:640
    ds_read_b128 v[130:133], v6 offset:21120
    ds_read_b128 v[134:137], v6 offset:41600
    ds_read_b128 v[138:141], v6 offset:62080
    s_waitcnt vmcnt(14) lgkmcnt(4)
    v_mfma_f32_16x16x32_bf16 v[78:81], v[110:113], v[30:33], v[78:81]
    v_mfma_f32_16x16x32_bf16 v[82:85], v[110:113], v[34:37], v[82:85]
    v_mfma_f32_16x16x32_bf16 v[86:89], v[114:117], v[30:33], v[86:89]
    v_mfma_f32_16x16x32_bf16 v[90:93], v[114:117], v[34:37], v[90:93]
    v_mfma_f32_16x16x32_bf16 v[94:97], v[118:121], v[30:33], v[94:97]
    v_mfma_f32_16x16x32_bf16 v[98:101], v[118:121], v[34:37], v[98:101]
    v_mfma_f32_16x16x32_bf16 v[102:105], v[122:125], v[30:33], v[102:105]
    v_mfma_f32_16x16x32_bf16 v[106:109], v[122:125], v[34:37], v[106:109]
    s_add_u32 s34, s33, 18432
    buffer_load_dwordx4 v[30:33], v2, s[8:11], s34 offen
    s_add_u32 s34, s33, 38912
    buffer_load_dwordx4 v[34:37], v2, s[8:11], s34 offen
    ds_read_b128 v[110:113], v7 offset:768
    ds_read_b128 v[114:117], v7 offset:21248
    ds_read_b128 v[118:121], v7 offset:41728
    ds_read_b128 v[122:125], v7 offset:62208
    s_waitcnt vmcnt(14) lgkmcnt(4)
    v_mfma_f32_16x16x32_bf16 v[78:81], v[126:129], v[38:41], v[78:81]
    v_mfma_f32_16x16x32_bf16 v[82:85], v[126:129], v[42:45], v[82:85]
    v_mfma_f32_16x16x32_bf16 v[86:89], v[130:133], v[38:41], v[86:89]
    v_mfma_f32_16x16x32_bf16 v[90:93], v[130:133], v[42:45], v[90:93]
    v_mfma_f32_16x16x32_bf16 v[94:97], v[134:137], v[38:41], v[94:97]
    v_mfma_f32_16x16x32_bf16 v[98:101], v[134:137], v[42:45], v[98:101]
    v_mfma_f32_16x16x32_bf16 v[102:105], v[138:141], v[38:41], v[102:105]
    v_mfma_f32_16x16x32_bf16 v[106:109], v[138:141], v[42:45], v[106:109]
    s_add_u32 s34, s33, 19456
    buffer_load_dwordx4 v[38:41], v2, s[8:11], s34 offen
    s_add_u32 s34, s33, 39936
    buffer_load_dwordx4 v[42:45], v2, s[8:11], s34 offen
    ds_read_b128 v[126:129], v6 offset:768
    ds_read_b128 v[130:133], v6 offset:21248
    ds_read_b128 v[134:137], v6 offset:41728
    ds_read_b128 v[138:141], v6 offset:62208
    s_waitcnt vmcnt(14) lgkmcnt(4)
    v_mfma_f32_16x16x32_bf16 v[78:81], v[110:113], v[46:49], v[78:81]
    v_mfma_f32_16x16x32_bf16 v[82:85], v[110:113], v[50:53], v[82:85]
    v_mfma_f32_16x16x32_bf16 v[86:89], v[114:117], v[46:49], v[86:89]
    v_mfma_f32_16x16x32_bf16 v[90:93], v[114:117], v[50:53], v[90:93]
    v_mfma_f32_16x16x32_bf16 v[94:97], v[118:121], v[46:49], v[94:97]
    v_mfma_f32_16x16x32_bf16 v[98:101], v[118:121], v[50:53], v[98:101]
    v_mfma_f32_16x16x32_bf16 v[102:105], v[122:125], v[46:49], v[102:105]
    v_mfma_f32_16x16x32_bf16 v[106:109], v[122:125], v[50:53], v[106:109]
    ds_read_b128 v[110:113], v7 offset:896
    ds_read_b128 v[114:117], v7 offset:21376
    ds_read_b128 v[118:121], v7 offset:41856
    ds_read_b128 v[122:125], v7 offset:62336
    s_waitcnt vmcnt(12) lgkmcnt(4)
    v_mfma_f32_16x16x32_bf16 v[78:81], v[126:129], v[54:57], v[78:81]
    v_mfma_f32_16x16x32_bf16 v[82:85], v[126:129], v[58:61], v[82:85]
    v_mfma_f32_16x16x32_bf16 v[86:89], v[130:133], v[54:57], v[86:89]
    v_mfma_f32_16x16x32_bf16 v[90:93], v[130:133], v[58:61], v[90:93]
    v_mfma_f32_16x16x32_bf16 v[94:97], v[134:137], v[54:57], v[94:97]
    v_mfma_f32_16x16x32_bf16 v[98:101], v[134:137], v[58:61], v[98:101]
    v_mfma_f32_16x16x32_bf16 v[102:105], v[138:141], v[54:57], v[102:105]
    v_mfma_f32_16x16x32_bf16 v[106:109], v[138:141], v[58:61], v[106:109]
    ds_read_b128 v[126:129], v6 offset:896
    ds_read_b128 v[130:133], v6 offset:21376
    ds_read_b128 v[134:137], v6 offset:41856
    ds_read_b128 v[138:141], v6 offset:62336
    s_waitcnt vmcnt(10) lgkmcnt(4)
    v_mfma_f32_16x16x32_bf16 v[78:81], v[110:113], v[62:65], v[78:81]
    v_mfma_f32_16x16x32_bf16 v[82:85], v[110:113], v[66:69], v[82:85]
    v_mfma_f32_16x16x32_bf16 v[86:89], v[114:117], v[62:65], v[86:89]
    v_mfma_f32_16x16x32_bf16 v[90:93], v[114:117], v[66:69], v[90:93]
    v_mfma_f32_16x16x32_bf16 v[94:97], v[118:121], v[62:65], v[94:97]
    v_mfma_f32_16x16x32_bf16 v[98:101], v[118:121], v[66:69], v[98:101]
    v_mfma_f32_16x16x32_bf16 v[102:105], v[122:125], v[62:65], v[102:105]
    v_mfma_f32_16x16x32_bf16 v[106:109], v[122:125], v[66:69], v[106:109]
    ds_read_b128 v[110:113], v7 offset:1024
    ds_read_b128 v[114:117], v7 offset:21504
    ds_read_b128 v[118:121], v7 offset:41984
    ds_read_b128 v[122:125], v7 offset:62464
    s_waitcnt vmcnt(8) lgkmcnt(4)
    v_mfma_f32_16x16x32_bf16 v[78:81], v[126:129], v[70:73], v[78:81]
    v_mfma_f32_16x16x32_bf16 v[82:85], v[126:129], v[74:77], v[82:85]
    v_mfma_f32_16x16x32_bf16 v[86:89], v[130:133], v[70:73], v[86:89]
    v_mfma_f32_16x16x32_bf16 v[90:93], v[130:133], v[74:77], v[90:93]
    v_mfma_f32_16x16x32_bf16 v[94:97], v[134:137], v[70:73], v[94:97]
    v_mfma_f32_16x16x32_bf16 v[98:101], v[134:137], v[74:77], v[98:101]
    v_mfma_f32_16x16x32_bf16 v[102:105], v[138:141], v[70:73], v[102:105]
    v_mfma_f32_16x16x32_bf16 v[106:109], v[138:141], v[74:77], v[106:109]
    ds_read_b128 v[126:129], v6 offset:1024
    ds_read_b128 v[130:133], v6 offset:21504
    ds_read_b128 v[134:137], v6 offset:41984
    ds_read_b128 v[138:141], v6 offset:62464
    s_waitcnt vmcnt(6) lgkmcnt(4)
    v_mfma_f32_16x16x32_bf16 v[78:81], v[110:113], v[14:17], v[78:81]
    v_mfma_f32_16x16x32_bf16 v[82:85], v[110:113], v[18:21], v[82:85]
    v_mfma_f32_16x16x32_bf16 v[86:89], v[114:117], v[14:17], v[86:89]
    v_mfma_f32_16x16x32_bf16 v[90:93], v[114:117], v[18:21], v[90:93]
    v_mfma_f32_16x16x32_bf16 v[94:97], v[118:121], v[14:17], v[94:97]
    v_mfma_f32_16x16x32_bf16 v[98:101], v[118:121], v[18:21], v[98:101]
    v_mfma_f32_16x16x32_bf16 v[102:105], v[122:125], v[14:17], v[102:105]
    v_mfma_f32_16x16x32_bf16 v[106:109], v[122:125], v[18:21], v[106:109]
    ds_read_b128 v[110:113], v7 offset:1152
    ds_read_b128 v[114:117], v7 offset:21632
    ds_read_b128 v[118:121], v7 offset:42112
    ds_read_b128 v[122:125], v7 offset:62592
    s_waitcnt vmcnt(4) lgkmcnt(4)
    v_mfma_f32_16x16x32_bf16 v[78:81], v[126:129], v[22:25], v[78:81]
    v_mfma_f32_16x16x32_bf16 v[82:85], v[126:129], v[26:29], v[82:85]
    v_mfma_f32_16x16x32_bf16 v[86:89], v[130:133], v[22:25], v[86:89]
    v_mfma_f32_16x16x32_bf16 v[90:93], v[130:133], v[26:29], v[90:93]
    v_mfma_f32_16x16x32_bf16 v[94:97], v[134:137], v[22:25], v[94:97]
    v_mfma_f32_16x16x32_bf16 v[98:101], v[134:137], v[26:29], v[98:101]
    v_mfma_f32_16x16x32_bf16 v[102:105], v[138:141], v[22:25], v[102:105]
    v_mfma_f32_16x16x32_bf16 v[106:109], v[138:141], v[26:29], v[106:109]
    ds_read_b128 v[126:129], v6 offset:1152
    ds_read_b128 v[130:133], v6 offset:21632
    ds_read_b128 v[134:137], v6 offset:42112
    ds_read_b128 v[138:141], v6 offset:62592
    s_waitcnt vmcnt(2) lgkmcnt(4)
    v_mfma_f32_16x16x32_bf16 v[78:81], v[110:113], v[30:33], v[78:81]
    v_mfma_f32_16x16x32_bf16 v[82:85], v[110:113], v[34:37], v[82:85]
    v_mfma_f32_16x16x32_bf16 v[86:89], v[114:117], v[30:33], v[86:89]
    v_mfma_f32_16x16x32_bf16 v[90:93], v[114:117], v[34:37], v[90:93]
    v_mfma_f32_16x16x32_bf16 v[94:97], v[118:121], v[30:33], v[94:97]
    v_mfma_f32_16x16x32_bf16 v[98:101], v[118:121], v[34:37], v[98:101]
    v_mfma_f32_16x16x32_bf16 v[102:105], v[122:125], v[30:33], v[102:105]
    v_mfma_f32_16x16x32_bf16 v[106:109], v[122:125], v[34:37], v[106:109]
    s_waitcnt vmcnt(0) lgkmcnt(0)
    v_mfma_f32_16x16x32_bf16 v[78:81], v[126:129], v[38:41], v[78:81]
    v_mfma_f32_16x16x32_bf16 v[82:85], v[126:129], v[42:45], v[82:85]
    v_mfma_f32_16x16x32_bf16 v[86:89], v[130:133], v[38:41], v[86:89]
    v_mfma_f32_16x16x32_bf16 v[90:93], v[130:133], v[42:45], v[90:93]
    v_mfma_f32_16x16x32_bf16 v[94:97], v[134:137], v[38:41], v[94:97]
    v_mfma_f32_16x16x32_bf16 v[98:101], v[134:137], v[42:45], v[98:101]
    v_mfma_f32_16x16x32_bf16 v[102:105], v[138:141], v[38:41], v[102:105]
    v_mfma_f32_16x16x32_bf16 v[106:109], v[138:141], v[42:45], v[106:109]
    s_nop 7
    s_nop 7
    s_barrier
    s_lshl_b32 s34, s32, 1
    s_add_u32 s34, s34, 0
    s_cmp_lt_u32 s34, 5
    s_cselect_b64 s[38:39], -1, 0
    v_and_b32 v3, 15, v1
    s_lshl_b32 s34, s34, 4
    v_add_u32 v3, s34, v3
    v_mul_u32_u24 v3, 144, v3
    v_lshl_add_u32 v3, v4, 3, v3
    v_mov_b32 v112, v78
    v_mul_f32 v110, 0x3fb8aa3b, v78
    v_exp_f32 v110, v110
    v_add_f32 v111, 1.0, v78
    v_cmp_lt_f32 vcc, 0, v78
    s_nop 1
    v_cndmask_b32 v78, v110, v111, vcc
    v_add_f32 v78, 0x358637bd, v78
    v_cndmask_b32 v78, v112, v78, s[38:39]
    v_mov_b32 v112, v79
    v_mul_f32 v110, 0x3fb8aa3b, v79
    v_exp_f32 v110, v110
    v_add_f32 v111, 1.0, v79
    v_cmp_lt_f32 vcc, 0, v79
    s_nop 1
    v_cndmask_b32 v79, v110, v111, vcc
    v_add_f32 v79, 0x358637bd, v79
    v_cndmask_b32 v79, v112, v79, s[38:39]
    v_mov_b32 v112, v80
    v_mul_f32 v110, 0x3fb8aa3b, v80
    v_exp_f32 v110, v110
    v_add_f32 v111, 1.0, v80
    v_cmp_lt_f32 vcc, 0, v80
    s_nop 1
    v_cndmask_b32 v80, v110, v111, vcc
    v_add_f32 v80, 0x358637bd, v80
    v_cndmask_b32 v80, v112, v80, s[38:39]
    v_mov_b32 v112, v81
    v_mul_f32 v110, 0x3fb8aa3b, v81
    v_exp_f32 v110, v110
    v_add_f32 v111, 1.0, v81
    v_cmp_lt_f32 vcc, 0, v81
    s_nop 1
    v_cndmask_b32 v81, v110, v111, vcc
    v_add_f32 v81, 0x358637bd, v81
    v_cndmask_b32 v81, v112, v81, s[38:39]
    v_cvt_pk_bf16_f32 v78, v78, v79
    v_cvt_pk_bf16_f32 v79, v80, v81
    ds_write_b64 v3, v[78:79] offset:0
    v_mov_b32 v112, v86
    v_mul_f32 v110, 0x3fb8aa3b, v86
    v_exp_f32 v110, v110
    v_add_f32 v111, 1.0, v86
    v_cmp_lt_f32 vcc, 0, v86
    s_nop 1
    v_cndmask_b32 v86, v110, v111, vcc
    v_add_f32 v86, 0x358637bd, v86
    v_cndmask_b32 v86, v112, v86, s[38:39]
    v_mov_b32 v112, v87
    v_mul_f32 v110, 0x3fb8aa3b, v87
    v_exp_f32 v110, v110
    v_add_f32 v111, 1.0, v87
    v_cmp_lt_f32 vcc, 0, v87
    s_nop 1
    v_cndmask_b32 v87, v110, v111, vcc
    v_add_f32 v87, 0x358637bd, v87
    v_cndmask_b32 v87, v112, v87, s[38:39]
    v_mov_b32 v112, v88
    v_mul_f32 v110, 0x3fb8aa3b, v88
    v_exp_f32 v110, v110
    v_add_f32 v111, 1.0, v88
    v_cmp_lt_f32 vcc, 0, v88
    s_nop 1
    v_cndmask_b32 v88, v110, v111, vcc
    v_add_f32 v88, 0x358637bd, v88
    v_cndmask_b32 v88, v112, v88, s[38:39]
    v_mov_b32 v112, v89
    v_mul_f32 v110, 0x3fb8aa3b, v89
    v_exp_f32 v110, v110
    v_add_f32 v111, 1.0, v89
    v_cmp_lt_f32 vcc, 0, v89
    s_nop 1
    v_cndmask_b32 v89, v110, v111, vcc
    v_add_f32 v89, 0x358637bd, v89
    v_cndmask_b32 v89, v112, v89, s[38:39]
    v_cvt_pk_bf16_f32 v86, v86, v87
    v_cvt_pk_bf16_f32 v87, v88, v89
    ds_write_b64 v3, v[86:87] offset:32
    v_mov_b32 v112, v94
    v_mul_f32 v110, 0x3fb8aa3b, v94
    v_exp_f32 v110, v110
    v_add_f32 v111, 1.0, v94
    v_cmp_lt_f32 vcc, 0, v94
    s_nop 1
    v_cndmask_b32 v94, v110, v111, vcc
    v_add_f32 v94, 0x358637bd, v94
    v_cndmask_b32 v94, v112, v94, s[38:39]
    v_mov_b32 v112, v95
    v_mul_f32 v110, 0x3fb8aa3b, v95
    v_exp_f32 v110, v110
    v_add_f32 v111, 1.0, v95
    v_cmp_lt_f32 vcc, 0, v95
    s_nop 1
    v_cndmask_b32 v95, v110, v111, vcc
    v_add_f32 v95, 0x358637bd, v95
    v_cndmask_b32 v95, v112, v95, s[38:39]
    v_mov_b32 v112, v96
    v_mul_f32 v110, 0x3fb8aa3b, v96
    v_exp_f32 v110, v110
    v_add_f32 v111, 1.0, v96
    v_cmp_lt_f32 vcc, 0, v96
    s_nop 1
    v_cndmask_b32 v96, v110, v111, vcc
    v_add_f32 v96, 0x358637bd, v96
    v_cndmask_b32 v96, v112, v96, s[38:39]
    v_mov_b32 v112, v97
    v_mul_f32 v110, 0x3fb8aa3b, v97
    v_exp_f32 v110, v110
    v_add_f32 v111, 1.0, v97
    v_cmp_lt_f32 vcc, 0, v97
    s_nop 1
    v_cndmask_b32 v97, v110, v111, vcc
    v_add_f32 v97, 0x358637bd, v97
    v_cndmask_b32 v97, v112, v97, s[38:39]
    v_cvt_pk_bf16_f32 v94, v94, v95
    v_cvt_pk_bf16_f32 v95, v96, v97
    ds_write_b64 v3, v[94:95] offset:64
    v_mov_b32 v112, v102
    v_mul_f32 v110, 0x3fb8aa3b, v102
    v_exp_f32 v110, v110
    v_add_f32 v111, 1.0, v102
    v_cmp_lt_f32 vcc, 0, v102
    s_nop 1
    v_cndmask_b32 v102, v110, v111, vcc
    v_add_f32 v102, 0x358637bd, v102
    v_cndmask_b32 v102, v112, v102, s[38:39]
    v_mov_b32 v112, v103
    v_mul_f32 v110, 0x3fb8aa3b, v103
    v_exp_f32 v110, v110
    v_add_f32 v111, 1.0, v103
    v_cmp_lt_f32 vcc, 0, v103
    s_nop 1
    v_cndmask_b32 v103, v110, v111, vcc
    v_add_f32 v103, 0x358637bd, v103
    v_cndmask_b32 v103, v112, v103, s[38:39]
    v_mov_b32 v112, v104
    v_mul_f32 v110, 0x3fb8aa3b, v104
    v_exp_f32 v110, v110
    v_add_f32 v111, 1.0, v104
    v_cmp_lt_f32 vcc, 0, v104
    s_nop 1
    v_cndmask_b32 v104, v110, v111, vcc
    v_add_f32 v104, 0x358637bd, v104
    v_cndmask_b32 v104, v112, v104, s[38:39]
    v_mov_b32 v112, v105
    v_mul_f32 v110, 0x3fb8aa3b, v105
    v_exp_f32 v110, v110
    v_add_f32 v111, 1.0, v105
    v_cmp_lt_f32 vcc, 0, v105
    s_nop 1
    v_cndmask_b32 v105, v110, v111, vcc
    v_add_f32 v105, 0x358637bd, v105
    v_cndmask_b32 v105, v112, v105, s[38:39]
    v_cvt_pk_bf16_f32 v102, v102, v103
    v_cvt_pk_bf16_f32 v103, v104, v105
    ds_write_b64 v3, v[102:103] offset:96
    s_lshl_b32 s34, s32, 1
    s_add_u32 s34, s34, 1
    s_cmp_lt_u32 s34, 5
    s_cselect_b64 s[38:39], -1, 0
    v_and_b32 v3, 15, v1
    s_lshl_b32 s34, s34, 4
    v_add_u32 v3, s34, v3
    v_mul_u32_u24 v3, 144, v3
    v_lshl_add_u32 v3, v4, 3, v3
    v_mov_b32 v112, v82
    v_mul_f32 v110, 0x3fb8aa3b, v82
    v_exp_f32 v110, v110
    v_add_f32 v111, 1.0, v82
    v_cmp_lt_f32 vcc, 0, v82
    s_nop 1
    v_cndmask_b32 v82, v110, v111, vcc
    v_add_f32 v82, 0x358637bd, v82
    v_cndmask_b32 v82, v112, v82, s[38:39]
    v_mov_b32 v112, v83
    v_mul_f32 v110, 0x3fb8aa3b, v83
    v_exp_f32 v110, v110
    v_add_f32 v111, 1.0, v83
    v_cmp_lt_f32 vcc, 0, v83
    s_nop 1
    v_cndmask_b32 v83, v110, v111, vcc
    v_add_f32 v83, 0x358637bd, v83
    v_cndmask_b32 v83, v112, v83, s[38:39]
    v_mov_b32 v112, v84
    v_mul_f32 v110, 0x3fb8aa3b, v84
    v_exp_f32 v110, v110
    v_add_f32 v111, 1.0, v84
    v_cmp_lt_f32 vcc, 0, v84
    s_nop 1
    v_cndmask_b32 v84, v110, v111, vcc
    v_add_f32 v84, 0x358637bd, v84
    v_cndmask_b32 v84, v112, v84, s[38:39]
    v_mov_b32 v112, v85
    v_mul_f32 v110, 0x3fb8aa3b, v85
    v_exp_f32 v110, v110
    v_add_f32 v111, 1.0, v85
    v_cmp_lt_f32 vcc, 0, v85
    s_nop 1
    v_cndmask_b32 v85, v110, v111, vcc
    v_add_f32 v85, 0x358637bd, v85
    v_cndmask_b32 v85, v112, v85, s[38:39]
    v_cvt_pk_bf16_f32 v82, v82, v83
    v_cvt_pk_bf16_f32 v83, v84, v85
    ds_write_b64 v3, v[82:83] offset:0
    v_mov_b32 v112, v90
    v_mul_f32 v110, 0x3fb8aa3b, v90
    v_exp_f32 v110, v110
    v_add_f32 v111, 1.0, v90
    v_cmp_lt_f32 vcc, 0, v90
    s_nop 1
    v_cndmask_b32 v90, v110, v111, vcc
    v_add_f32 v90, 0x358637bd, v90
    v_cndmask_b32 v90, v112, v90, s[38:39]
    v_mov_b32 v112, v91
    v_mul_f32 v110, 0x3fb8aa3b, v91
    v_exp_f32 v110, v110
    v_add_f32 v111, 1.0, v91
    v_cmp_lt_f32 vcc, 0, v91
    s_nop 1
    v_cndmask_b32 v91, v110, v111, vcc
    v_add_f32 v91, 0x358637bd, v91
    v_cndmask_b32 v91, v112, v91, s[38:39]
    v_mov_b32 v112, v92
    v_mul_f32 v110, 0x3fb8aa3b, v92
    v_exp_f32 v110, v110
    v_add_f32 v111, 1.0, v92
    v_cmp_lt_f32 vcc, 0, v92
    s_nop 1
    v_cndmask_b32 v92, v110, v111, vcc
    v_add_f32 v92, 0x358637bd, v92
    v_cndmask_b32 v92, v112, v92, s[38:39]
    v_mov_b32 v112, v93
    v_mul_f32 v110, 0x3fb8aa3b, v93
    v_exp_f32 v110, v110
    v_add_f32 v111, 1.0, v93
    v_cmp_lt_f32 vcc, 0, v93
    s_nop 1
    v_cndmask_b32 v93, v110, v111, vcc
    v_add_f32 v93, 0x358637bd, v93
    v_cndmask_b32 v93, v112, v93, s[38:39]
    v_cvt_pk_bf16_f32 v90, v90, v91
    v_cvt_pk_bf16_f32 v91, v92, v93
    ds_write_b64 v3, v[90:91] offset:32
    v_mov_b32 v112, v98
    v_mul_f32 v110, 0x3fb8aa3b, v98
    v_exp_f32 v110, v110
    v_add_f32 v111, 1.0, v98
    v_cmp_lt_f32 vcc, 0, v98
    s_nop 1
    v_cndmask_b32 v98, v110, v111, vcc
    v_add_f32 v98, 0x358637bd, v98
    v_cndmask_b32 v98, v112, v98, s[38:39]
    v_mov_b32 v112, v99
    v_mul_f32 v110, 0x3fb8aa3b, v99
    v_exp_f32 v110, v110
    v_add_f32 v111, 1.0, v99
    v_cmp_lt_f32 vcc, 0, v99
    s_nop 1
    v_cndmask_b32 v99, v110, v111, vcc
    v_add_f32 v99, 0x358637bd, v99
    v_cndmask_b32 v99, v112, v99, s[38:39]
    v_mov_b32 v112, v100
    v_mul_f32 v110, 0x3fb8aa3b, v100
    v_exp_f32 v110, v110
    v_add_f32 v111, 1.0, v100
    v_cmp_lt_f32 vcc, 0, v100
    s_nop 1
    v_cndmask_b32 v100, v110, v111, vcc
    v_add_f32 v100, 0x358637bd, v100
    v_cndmask_b32 v100, v112, v100, s[38:39]
    v_mov_b32 v112, v101
    v_mul_f32 v110, 0x3fb8aa3b, v101
    v_exp_f32 v110, v110
    v_add_f32 v111, 1.0, v101
    v_cmp_lt_f32 vcc, 0, v101
    s_nop 1
    v_cndmask_b32 v101, v110, v111, vcc
    v_add_f32 v101, 0x358637bd, v101
    v_cndmask_b32 v101, v112, v101, s[38:39]
    v_cvt_pk_bf16_f32 v98, v98, v99
    v_cvt_pk_bf16_f32 v99, v100, v101
    ds_write_b64 v3, v[98:99] offset:64
    v_mov_b32 v112, v106
    v_mul_f32 v110, 0x3fb8aa3b, v106
    v_exp_f32 v110, v110
    v_add_f32 v111, 1.0, v106
    v_cmp_lt_f32 vcc, 0, v106
    s_nop 1
    v_cndmask_b32 v106, v110, v111, vcc
    v_add_f32 v106, 0x358637bd, v106
    v_cndmask_b32 v106, v112, v106, s[38:39]
    v_mov_b32 v112, v107
    v_mul_f32 v110, 0x3fb8aa3b, v107
    v_exp_f32 v110, v110
    v_add_f32 v111, 1.0, v107
    v_cmp_lt_f32 vcc, 0, v107
    s_nop 1
    v_cndmask_b32 v107, v110, v111, vcc
    v_add_f32 v107, 0x358637bd, v107
    v_cndmask_b32 v107, v112, v107, s[38:39]
    v_mov_b32 v112, v108
    v_mul_f32 v110, 0x3fb8aa3b, v108
    v_exp_f32 v110, v110
    v_add_f32 v111, 1.0, v108
    v_cmp_lt_f32 vcc, 0, v108
    s_nop 1
    v_cndmask_b32 v108, v110, v111, vcc
    v_add_f32 v108, 0x358637bd, v108
    v_cndmask_b32 v108, v112, v108, s[38:39]
    v_mov_b32 v112, v109
    v_mul_f32 v110, 0x3fb8aa3b, v109
    v_exp_f32 v110, v110
    v_add_f32 v111, 1.0, v109
    v_cmp_lt_f32 vcc, 0, v109
    s_nop 1
    v_cndmask_b32 v109, v110, v111, vcc
    v_add_f32 v109, 0x358637bd, v109
    v_cndmask_b32 v109, v112, v109, s[38:39]
    v_cvt_pk_bf16_f32 v106, v106, v107
    v_cvt_pk_bf16_f32 v107, v108, v109
    ds_write_b64 v3, v[106:107] offset:96
    s_waitcnt lgkmcnt(0)
    s_barrier
    v_and_b32 v3, 15, v1
    v_mul_u32_u24 v3, 144, v3
    v_lshl_add_u32 v3, v4, 4, v3
    s_mul_i32 s34, s32, 2304
    v_add_u32 v6, s34, v3
    ds_read_b128 v[110:113], v6
    ds_read_b128 v[114:117], v6 offset:64
    s_lshl_b32 s36, s30, 3
    s_add_u32 s36, s36, s31
    s_mul_i32 s36, s36, 25920
    s_add_u32 s36, s36, 28246016
    v_mov_b32 v78, 0
    v_mov_b32 v79, 0
    v_mov_b32 v80, 0
    v_mov_b32 v81, 0
    s_add_u32 s37, s32, 0
    s_max_u32 s37, s37, 1
    s_sub_u32 s37, s37, 1
    s_min_u32 s37, s37, 4
    s_add_u32 s34, s37, 5
    s_mul_i32 s34, s34, 2304
    v_add_u32 v7, s34, v3
    ds_read_b128 v[118:121], v7
    ds_read_b128 v[122:125], v7 offset:64
    s_waitcnt lgkmcnt(0)
    s_nop 1
    v_mfma_f32_16x16x32_bf16 v[78:81], v[110:113], v[118:121], v[78:81]
    v_mfma_f32_16x16x32_bf16 v[78:81], v[114:117], v[122:125], v[78:81]
    s_mul_i32 s34, s32, 5120
    v_mul_u32_u24 v7, 1280, v4
    v_add_u32 v7, s34, v7
    v_and_b32 v8, 15, v1
    v_lshl_add_u32 v7, v8, 2, v7
    s_lshl_b32 s34, s37, 6
    v_add_u32 v7, s34, v7
    s_nop 7
    s_nop 3
    buffer_store_dword v78, v7, s[8:11], s36 offen offset:0
    buffer_store_dword v79, v7, s[8:11], s36 offen offset:320
    buffer_store_dword v80, v7, s[8:11], s36 offen offset:640
    buffer_store_dword v81, v7, s[8:11], s36 offen offset:960
    v_mov_b32 v78, 0
    v_mov_b32 v79, 0
    v_mov_b32 v80, 0
    v_mov_b32 v81, 0
    s_add_u32 s37, s32, 1
    s_max_u32 s37, s37, 1
    s_sub_u32 s37, s37, 1
    s_min_u32 s37, s37, 4
    s_add_u32 s34, s37, 5
    s_mul_i32 s34, s34, 2304
    v_add_u32 v7, s34, v3
    ds_read_b128 v[118:121], v7
    ds_read_b128 v[122:125], v7 offset:64
    s_waitcnt lgkmcnt(0)
    s_nop 1
    v_mfma_f32_16x16x32_bf16 v[78:81], v[110:113], v[118:121], v[78:81]
    v_mfma_f32_16x16x32_bf16 v[78:81], v[114:117], v[122:125], v[78:81]
    s_mul_i32 s34, s32, 5120
    v_mul_u32_u24 v7, 1280, v4
    v_add_u32 v7, s34, v7
    v_and_b32 v8, 15, v1
    v_lshl_add_u32 v7, v8, 2, v7
    s_lshl_b32 s34, s37, 6
    v_add_u32 v7, s34, v7
    s_nop 7
    s_nop 3
    buffer_store_dword v78, v7, s[8:11], s36 offen offset:0
    buffer_store_dword v79, v7, s[8:11], s36 offen offset:320
    buffer_store_dword v80, v7, s[8:11], s36 offen offset:640
    buffer_store_dword v81, v7, s[8:11], s36 offen offset:960
    v_mov_b32 v78, 0
    v_mov_b32 v79, 0
    v_mov_b32 v80, 0
    v_mov_b32 v81, 0
    s_add_u32 s37, s32, 2
    s_max_u32 s37, s37, 1
    s_sub_u32 s37, s37, 1
    s_min_u32 s37, s37, 4
    s_add_u32 s34, s37, 5
    s_mul_i32 s34, s34, 2304
    v_add_u32 v7, s34, v3
    ds_read_b128 v[118:121], v7
    ds_read_b128 v[122:125], v7 offset:64
    s_waitcnt lgkmcnt(0)
    s_nop 1
    v_mfma_f32_16x16x32_bf16 v[78:81], v[110:113], v[118:121], v[78:81]
    v_mfma_f32_16x16x32_bf16 v[78:81], v[114:117], v[122:125], v[78:81]
    s_mul_i32 s34, s32, 5120
    v_mul_u32_u24 v7, 1280, v4
    v_add_u32 v7, s34, v7
    v_and_b32 v8, 15, v1
    v_lshl_add_u32 v7, v8, 2, v7
    s_lshl_b32 s34, s37, 6
    v_add_u32 v7, s34, v7
    s_nop 7
    s_nop 3
    buffer_store_dword v78, v7, s[8:11], s36 offen offset:0
    buffer_store_dword v79, v7, s[8:11], s36 offen offset:320
    buffer_store_dword v80, v7, s[8:11], s36 offen offset:640
    buffer_store_dword v81, v7, s[8:11], s36 offen offset:960
    v_mov_b32 v78, 0
    v_mov_b32 v79, 0
    v_mov_b32 v80, 0
    v_mov_b32 v81, 0
    v_mov_b32 v118, 0x3f803f80
    v_mov_b32 v119, 0x3f803f80
    v_mov_b32 v120, 0x3f803f80
    v_mov_b32 v121, 0x3f803f80
    v_mov_b32 v122, 0x3f803f80
    v_mov_b32 v123, 0x3f803f80
    v_mov_b32 v124, 0x3f803f80
    v_mov_b32 v125, 0x3f803f80
    s_waitcnt lgkmcnt(0)
    s_nop 1
    v_mfma_f32_16x16x32_bf16 v[78:81], v[110:113], v[118:121], v[78:81]
    v_mfma_f32_16x16x32_bf16 v[78:81], v[114:117], v[122:125], v[78:81]
    s_mul_i32 s34, s32, 5120
    v_mul_u32_u24 v7, 1280, v4
    v_add_u32 v7, s34, v7
    s_lshl_b32 s34, s32, 6
    v_lshlrev_b32 v7, 4, v4
    v_add_u32 v7, s34, v7
    v_add_u32 v7, 25600, v7
    s_nop 7
    s_nop 3
    buffer_store_dword v78, v7, s[8:11], s36 offen offset:0
    buffer_store_dword v79, v7, s[8:11], s36 offen offset:4
    buffer_store_dword v80, v7, s[8:11], s36 offen offset:8
    buffer_store_dword v81, v7, s[8:11], s36 offen offset:12
kv_k_done:
    s_endpgm
.globl red_kernel
.p2align 8
.type red_kernel,@function
red_kernel:
    s_cmp_ge_u32 s2, 32
    s_cbranch_scc1 red_done
    s_load_dwordx2 s[4:5], s[0:1], 80
    s_load_dwordx2 s[6:7], s[0:1], 16
    s_waitcnt lgkmcnt(0)
    s_mov_b32 s8, s4
    s_mov_b32 s9, s5
    s_and_b32 s9, s9, 0xffff
    s_mov_b32 s10, 268435456
    s_mov_b32 s11, 0x00020000
    s_mov_b32 s12, s6
    s_mov_b32 s13, s7
    s_and_b32 s13, s13, 0xffff
    s_mov_b32 s14, 819200
    s_mov_b32 s15, 0x00020000
    s_lshr_b32 s20, s2, 2
    s_and_b32 s21, s2, 3
    s_mul_i32 s22, s20, 25920
    s_add_u32 s22, s22, 28246016
    s_mov_b32 s23, 214748365
    v_mul_hi_u32 v1, v0, s23
    v_mul_u32_u24 v2, 20, v1
    v_sub_u32 v2, v0, v2
    s_mul_i32 s24, s21, 20
    v_add_u32 v3, s24, v1
    v_mul_u32_u24 v3, 80, v3
    v_add_u32 v3, v3, v2
    v_add_u32 v3, s24, v3
    v_lshlrev_b32 v3, 2, v3
    v_add_u32 v4, s24, v2
    v_lshlrev_b32 v4, 2, v4
    v_add_u32 v4, 25600, v4
    v_cmp_gt_u32 vcc, 400, v0
    s_nop 1
    v_cndmask_b32 v3, v4, v3, vcc
    v_mov_b32 v5, 0
    v_cmp_gt_u32 vcc, 420, v0
    s_and_saveexec_b64 s[26:27], vcc
    s_cbranch_execz red_l
    s_add_u32 s25, s22, 0
    buffer_load_dword v8, v3, s[8:11], s25 offen
    s_add_u32 s25, s22, 207360
    buffer_load_dword v9, v3, s[8:11], s25 offen
    s_add_u32 s25, s22, 414720
    buffer_load_dword v10, v3, s[8:11], s25 offen
    s_add_u32 s25, s22, 622080
    buffer_load_dword v11, v3, s[8:11], s25 offen
    s_add_u32 s25, s22, 829440
    buffer_load_dword v12, v3, s[8:11], s25 offen
    s_add_u32 s25, s22, 1036800
    buffer_load_dword v13, v3, s[8:11], s25 offen
    s_add_u32 s25, s22, 1244160
    buffer_load_dword v14, v3, s[8:11], s25 offen
    s_add_u32 s25, s22, 1451520
    buffer_load_dword v15, v3, s[8:11], s25 offen
    s_add_u32 s25, s22, 1658880
    buffer_load_dword v16, v3, s[8:11], s25 offen
    s_add_u32 s25, s22, 1866240
    buffer_load_dword v17, v3, s[8:11], s25 offen
    s_add_u32 s25, s22, 2073600
    buffer_load_dword v18, v3, s[8:11], s25 offen
    s_add_u32 s25, s22, 2280960
    buffer_load_dword v19, v3, s[8:11], s25 offen
    s_add_u32 s25, s22, 2488320
    buffer_load_dword v20, v3, s[8:11], s25 offen
    s_add_u32 s25, s22, 2695680
    buffer_load_dword v21, v3, s[8:11], s25 offen
    s_add_u32 s25, s22, 2903040
    buffer_load_dword v22, v3, s[8:11], s25 offen
    s_add_u32 s25, s22, 3110400
    buffer_load_dword v23, v3, s[8:11], s25 offen
    s_add_u32 s25, s22, 3317760
    buffer_load_dword v24, v3, s[8:11], s25 offen
    s_add_u32 s25, s22, 3525120
    buffer_load_dword v25, v3, s[8:11], s25 offen
    s_add_u32 s25, s22, 3732480
    buffer_load_dword v26, v3, s[8:11], s25 offen
    s_add_u32 s25, s22, 3939840
    buffer_load_dword v27, v3, s[8:11], s25 offen
    s_add_u32 s25, s22, 4147200
    buffer_load_dword v28, v3, s[8:11], s25 offen
    s_add_u32 s25, s22, 4354560
    buffer_load_dword v29, v3, s[8:11], s25 offen
    s_add_u32 s25, s22, 4561920
    buffer_load_dword v30, v3, s[8:11], s25 offen
    s_add_u32 s25, s22, 4769280
    buffer_load_dword v31, v3, s[8:11], s25 offen
    s_add_u32 s25, s22, 4976640
    buffer_load_dword v32, v3, s[8:11], s25 offen
    s_add_u32 s25, s22, 5184000
    buffer_load_dword v33, v3, s[8:11], s25 offen
    s_add_u32 s25, s22, 5391360
    buffer_load_dword v34, v3, s[8:11], s25 offen
    s_add_u32 s25, s22, 5598720
    buffer_load_dword v35, v3, s[8:11], s25 offen
    s_add_u32 s25, s22, 5806080
    buffer_load_dword v36, v3, s[8:11], s25 offen
    s_add_u32 s25, s22, 6013440
    buffer_load_dword v37, v3, s[8:11], s25 offen
    s_add_u32 s25, s22, 6220800
    buffer_load_dword v38, v3, s[8:11], s25 offen
    s_add_u32 s25, s22, 6428160
    buffer_load_dword v39, v3, s[8:11], s25 offen
    s_waitcnt vmcnt(0)
    v_add_f32 v5, v5, v8
    v_add_f32 v5, v5, v9
    v_add_f32 v5, v5, v10
    v_add_f32 v5, v5, v11
    v_add_f32 v5, v5, v12
    v_add_f32 v5, v5, v13
    v_add_f32 v5, v5, v14
    v_add_f32 v5, v5, v15
    v_add_f32 v5, v5, v16
    v_add_f32 v5, v5, v17
    v_add_f32 v5, v5, v18
    v_add_f32 v5, v5, v19
    v_add_f32 v5, v5, v20
    v_add_f32 v5, v5, v21
    v_add_f32 v5, v5, v22
    v_add_f32 v5, v5, v23
    v_add_f32 v5, v5, v24
    v_add_f32 v5, v5, v25
    v_add_f32 v5, v5, v26
    v_add_f32 v5, v5, v27
    v_add_f32 v5, v5, v28
    v_add_f32 v5, v5, v29
    v_add_f32 v5, v5, v30
    v_add_f32 v5, v5, v31
    v_add_f32 v5, v5, v32
    v_add_f32 v5, v5, v33
    v_add_f32 v5, v5, v34
    v_add_f32 v5, v5, v35
    v_add_f32 v5, v5, v36
    v_add_f32 v5, v5, v37
    v_add_f32 v5, v5, v38
    v_add_f32 v5, v5, v39
    v_lshlrev_b32 v6, 2, v0
    ds_write_b32 v6, v5
    v_cmp_le_u32 vcc, 400, v0
    s_and_saveexec_b64 s[28:29], vcc
    s_mul_i32 s25, s2, 80
    s_add_u32 s25, s25, 34879936
    buffer_store_dword v5, v6, s[8:11], s25 offen
    s_mov_b64 exec, s[28:29]
red_l:
    s_mov_b64 exec, s[26:27]
    s_waitcnt lgkmcnt(0)
    s_barrier
    s_mul_i32 s25, s2, 25600
    v_lshlrev_b32 v6, 1, v0
    s_add_u32 s26, s25, 0
    buffer_load_ushort v8, v6, s[12:15], s26 offen
    s_add_u32 s26, s25, 1280
    buffer_load_ushort v9, v6, s[12:15], s26 offen
    s_add_u32 s26, s25, 2560
    buffer_load_ushort v10, v6, s[12:15], s26 offen
    s_add_u32 s26, s25, 3840
    buffer_load_ushort v11, v6, s[12:15], s26 offen
    s_add_u32 s26, s25, 5120
    buffer_load_ushort v12, v6, s[12:15], s26 offen
    s_add_u32 s26, s25, 6400
    buffer_load_ushort v13, v6, s[12:15], s26 offen
    s_add_u32 s26, s25, 7680
    buffer_load_ushort v14, v6, s[12:15], s26 offen
    s_add_u32 s26, s25, 8960
    buffer_load_ushort v15, v6, s[12:15], s26 offen
    s_add_u32 s26, s25, 10240
    buffer_load_ushort v16, v6, s[12:15], s26 offen
    s_add_u32 s26, s25, 11520
    buffer_load_ushort v17, v6, s[12:15], s26 offen
    s_add_u32 s26, s25, 12800
    buffer_load_ushort v18, v6, s[12:15], s26 offen
    s_add_u32 s26, s25, 14080
    buffer_load_ushort v19, v6, s[12:15], s26 offen
    s_add_u32 s26, s25, 15360
    buffer_load_ushort v20, v6, s[12:15], s26 offen
    s_add_u32 s26, s25, 16640
    buffer_load_ushort v21, v6, s[12:15], s26 offen
    s_add_u32 s26, s25, 17920
    buffer_load_ushort v22, v6, s[12:15], s26 offen
    s_add_u32 s26, s25, 19200
    buffer_load_ushort v23, v6, s[12:15], s26 offen
    s_add_u32 s26, s25, 20480
    buffer_load_ushort v24, v6, s[12:15], s26 offen
    s_add_u32 s26, s25, 21760
    buffer_load_ushort v25, v6, s[12:15], s26 offen
    s_add_u32 s26, s25, 23040
    buffer_load_ushort v26, v6, s[12:15], s26 offen
    s_add_u32 s26, s25, 24320
    buffer_load_ushort v27, v6, s[12:15], s26 offen
    s_waitcnt vmcnt(0)
    v_lshlrev_b32 v8, 16, v8
    v_lshlrev_b32 v9, 16, v9
    v_lshlrev_b32 v10, 16, v10
    v_lshlrev_b32 v11, 16, v11
    v_lshlrev_b32 v12, 16, v12
    v_lshlrev_b32 v13, 16, v13
    v_lshlrev_b32 v14, 16, v14
    v_lshlrev_b32 v15, 16, v15
    v_lshlrev_b32 v16, 16, v16
    v_lshlrev_b32 v17, 16, v17
    v_lshlrev_b32 v18, 16, v18
    v_lshlrev_b32 v19, 16, v19
    v_lshlrev_b32 v20, 16, v20
    v_lshlrev_b32 v21, 16, v21
    v_lshlrev_b32 v22, 16, v22
    v_lshlrev_b32 v23, 16, v23
    v_lshlrev_b32 v24, 16, v24
    v_lshlrev_b32 v25, 16, v25
    v_lshlrev_b32 v26, 16, v26
    v_lshlrev_b32 v27, 16, v27
    v_lshrrev_b32 v1, 4, v0
    v_mul_u32_u24 v1, 20480, v1
    v_and_b32 v2, 15, v0
    v_lshl_add_u32 v1, v2, 4, v1
    v_mov_b32 v7, 0
    v_mov_b32 v30, 0
    ds_read_b128 v[32:35], v7 offset:0
    ds_read_b128 v[36:39], v7 offset:16
    ds_read_b128 v[40:43], v7 offset:32
    ds_read_b128 v[44:47], v7 offset:48
    ds_read_b128 v[48:51], v7 offset:64
    s_waitcnt lgkmcnt(0)
    v_fmac_f32 v30, v32, v8
    v_fmac_f32 v30, v33, v9
    v_fmac_f32 v30, v34, v10
    v_fmac_f32 v30, v35, v11
    v_fmac_f32 v30, v36, v12
    v_fmac_f32 v30, v37, v13
    v_fmac_f32 v30, v38, v14
    v_fmac_f32 v30, v39, v15
    v_fmac_f32 v30, v40, v16
    v_fmac_f32 v30, v41, v17
    v_fmac_f32 v30, v42, v18
    v_fmac_f32 v30, v43, v19
    v_fmac_f32 v30, v44, v20
    v_fmac_f32 v30, v45, v21
    v_fmac_f32 v30, v46, v22
    v_fmac_f32 v30, v47, v23
    v_fmac_f32 v30, v48, v24
    v_fmac_f32 v30, v49, v25
    v_fmac_f32 v30, v50, v26
    v_fmac_f32 v30, v51, v27
    v_cvt_pk_bf16_f32 v30, v30, v30
    s_mul_i32 s25, s2, 20
    s_add_u32 s25, s25, 0
    s_lshr_b32 s26, s25, 5
    s_lshl_b32 s26, s26, 10
    s_bfe_u32 s27, s25, 0x20003
    s_lshl_b32 s27, s27, 8
    s_add_u32 s26, s26, s27
    s_and_b32 s27, s25, 7
    s_lshl_b32 s27, s27, 1
    s_add_u32 s26, s26, s27
    s_add_u32 s26, s26, 8028160
    buffer_store_short v30, v1, s[8:11], s26 offen
    v_mov_b32 v30, 0
    ds_read_b128 v[32:35], v7 offset:80
    ds_read_b128 v[36:39], v7 offset:96
    ds_read_b128 v[40:43], v7 offset:112
    ds_read_b128 v[44:47], v7 offset:128
    ds_read_b128 v[48:51], v7 offset:144
    s_waitcnt lgkmcnt(0)
    v_fmac_f32 v30, v32, v8
    v_fmac_f32 v30, v33, v9
    v_fmac_f32 v30, v34, v10
    v_fmac_f32 v30, v35, v11
    v_fmac_f32 v30, v36, v12
    v_fmac_f32 v30, v37, v13
    v_fmac_f32 v30, v38, v14
    v_fmac_f32 v30, v39, v15
    v_fmac_f32 v30, v40, v16
    v_fmac_f32 v30, v41, v17
    v_fmac_f32 v30, v42, v18
    v_fmac_f32 v30, v43, v19
    v_fmac_f32 v30, v44, v20
    v_fmac_f32 v30, v45, v21
    v_fmac_f32 v30, v46, v22
    v_fmac_f32 v30, v47, v23
    v_fmac_f32 v30, v48, v24
    v_fmac_f32 v30, v49, v25
    v_fmac_f32 v30, v50, v26
    v_fmac_f32 v30, v51, v27
    v_cvt_pk_bf16_f32 v30, v30, v30
    s_mul_i32 s25, s2, 20
    s_add_u32 s25, s25, 1
    s_lshr_b32 s26, s25, 5
    s_lshl_b32 s26, s26, 10
    s_bfe_u32 s27, s25, 0x20003
    s_lshl_b32 s27, s27, 8
    s_add_u32 s26, s26, s27
    s_and_b32 s27, s25, 7
    s_lshl_b32 s27, s27, 1
    s_add_u32 s26, s26, s27
    s_add_u32 s26, s26, 8028160
    buffer_store_short v30, v1, s[8:11], s26 offen
    v_mov_b32 v30, 0
    ds_read_b128 v[32:35], v7 offset:160
    ds_read_b128 v[36:39], v7 offset:176
    ds_read_b128 v[40:43], v7 offset:192
    ds_read_b128 v[44:47], v7 offset:208
    ds_read_b128 v[48:51], v7 offset:224
    s_waitcnt lgkmcnt(0)
    v_fmac_f32 v30, v32, v8
    v_fmac_f32 v30, v33, v9
    v_fmac_f32 v30, v34, v10
    v_fmac_f32 v30, v35, v11
    v_fmac_f32 v30, v36, v12
    v_fmac_f32 v30, v37, v13
    v_fmac_f32 v30, v38, v14
    v_fmac_f32 v30, v39, v15
    v_fmac_f32 v30, v40, v16
    v_fmac_f32 v30, v41, v17
    v_fmac_f32 v30, v42, v18
    v_fmac_f32 v30, v43, v19
    v_fmac_f32 v30, v44, v20
    v_fmac_f32 v30, v45, v21
    v_fmac_f32 v30, v46, v22
    v_fmac_f32 v30, v47, v23
    v_fmac_f32 v30, v48, v24
    v_fmac_f32 v30, v49, v25
    v_fmac_f32 v30, v50, v26
    v_fmac_f32 v30, v51, v27
    v_cvt_pk_bf16_f32 v30, v30, v30
    s_mul_i32 s25, s2, 20
    s_add_u32 s25, s25, 2
    s_lshr_b32 s26, s25, 5
    s_lshl_b32 s26, s26, 10
    s_bfe_u32 s27, s25, 0x20003
    s_lshl_b32 s27, s27, 8
    s_add_u32 s26, s26, s27
    s_and_b32 s27, s25, 7
    s_lshl_b32 s27, s27, 1
    s_add_u32 s26, s26, s27
    s_add_u32 s26, s26, 8028160
    buffer_store_short v30, v1, s[8:11], s26 offen
    v_mov_b32 v30, 0
    ds_read_b128 v[32:35], v7 offset:240
    ds_read_b128 v[36:39], v7 offset:256
    ds_read_b128 v[40:43], v7 offset:272
    ds_read_b128 v[44:47], v7 offset:288
    ds_read_b128 v[48:51], v7 offset:304
    s_waitcnt lgkmcnt(0)
    v_fmac_f32 v30, v32, v8
    v_fmac_f32 v30, v33, v9
    v_fmac_f32 v30, v34, v10
    v_fmac_f32 v30, v35, v11
    v_fmac_f32 v30, v36, v12
    v_fmac_f32 v30, v37, v13
    v_fmac_f32 v30, v38, v14
    v_fmac_f32 v30, v39, v15
    v_fmac_f32 v30, v40, v16
    v_fmac_f32 v30, v41, v17
    v_fmac_f32 v30, v42, v18
    v_fmac_f32 v30, v43, v19
    v_fmac_f32 v30, v44, v20
    v_fmac_f32 v30, v45, v21
    v_fmac_f32 v30, v46, v22
    v_fmac_f32 v30, v47, v23
    v_fmac_f32 v30, v48, v24
    v_fmac_f32 v30, v49, v25
    v_fmac_f32 v30, v50, v26
    v_fmac_f32 v30, v51, v27
    v_cvt_pk_bf16_f32 v30, v30, v30
    s_mul_i32 s25, s2, 20
    s_add_u32 s25, s25, 3
    s_lshr_b32 s26, s25, 5
    s_lshl_b32 s26, s26, 10
    s_bfe_u32 s27, s25, 0x20003
    s_lshl_b32 s27, s27, 8
    s_add_u32 s26, s26, s27
    s_and_b32 s27, s25, 7
    s_lshl_b32 s27, s27, 1
    s_add_u32 s26, s26, s27
    s_add_u32 s26, s26, 8028160
    buffer_store_short v30, v1, s[8:11], s26 offen
    v_mov_b32 v30, 0
    ds_read_b128 v[32:35], v7 offset:320
    ds_read_b128 v[36:39], v7 offset:336
    ds_read_b128 v[40:43], v7 offset:352
    ds_read_b128 v[44:47], v7 offset:368
    ds_read_b128 v[48:51], v7 offset:384
    s_waitcnt lgkmcnt(0)
    v_fmac_f32 v30, v32, v8
    v_fmac_f32 v30, v33, v9
    v_fmac_f32 v30, v34, v10
    v_fmac_f32 v30, v35, v11
    v_fmac_f32 v30, v36, v12
    v_fmac_f32 v30, v37, v13
    v_fmac_f32 v30, v38, v14
    v_fmac_f32 v30, v39, v15
    v_fmac_f32 v30, v40, v16
    v_fmac_f32 v30, v41, v17
    v_fmac_f32 v30, v42, v18
    v_fmac_f32 v30, v43, v19
    v_fmac_f32 v30, v44, v20
    v_fmac_f32 v30, v45, v21
    v_fmac_f32 v30, v46, v22
    v_fmac_f32 v30, v47, v23
    v_fmac_f32 v30, v48, v24
    v_fmac_f32 v30, v49, v25
    v_fmac_f32 v30, v50, v26
    v_fmac_f32 v30, v51, v27
    v_cvt_pk_bf16_f32 v30, v30, v30
    s_mul_i32 s25, s2, 20
    s_add_u32 s25, s25, 4
    s_lshr_b32 s26, s25, 5
    s_lshl_b32 s26, s26, 10
    s_bfe_u32 s27, s25, 0x20003
    s_lshl_b32 s27, s27, 8
    s_add_u32 s26, s26, s27
    s_and_b32 s27, s25, 7
    s_lshl_b32 s27, s27, 1
    s_add_u32 s26, s26, s27
    s_add_u32 s26, s26, 8028160
    buffer_store_short v30, v1, s[8:11], s26 offen
    v_mov_b32 v30, 0
    ds_read_b128 v[32:35], v7 offset:400
    ds_read_b128 v[36:39], v7 offset:416
    ds_read_b128 v[40:43], v7 offset:432
    ds_read_b128 v[44:47], v7 offset:448
    ds_read_b128 v[48:51], v7 offset:464
    s_waitcnt lgkmcnt(0)
    v_fmac_f32 v30, v32, v8
    v_fmac_f32 v30, v33, v9
    v_fmac_f32 v30, v34, v10
    v_fmac_f32 v30, v35, v11
    v_fmac_f32 v30, v36, v12
    v_fmac_f32 v30, v37, v13
    v_fmac_f32 v30, v38, v14
    v_fmac_f32 v30, v39, v15
    v_fmac_f32 v30, v40, v16
    v_fmac_f32 v30, v41, v17
    v_fmac_f32 v30, v42, v18
    v_fmac_f32 v30, v43, v19
    v_fmac_f32 v30, v44, v20
    v_fmac_f32 v30, v45, v21
    v_fmac_f32 v30, v46, v22
    v_fmac_f32 v30, v47, v23
    v_fmac_f32 v30, v48, v24
    v_fmac_f32 v30, v49, v25
    v_fmac_f32 v30, v50, v26
    v_fmac_f32 v30, v51, v27
    v_cvt_pk_bf16_f32 v30, v30, v30
    s_mul_i32 s25, s2, 20
    s_add_u32 s25, s25, 5
    s_lshr_b32 s26, s25, 5
    s_lshl_b32 s26, s26, 10
    s_bfe_u32 s27, s25, 0x20003
    s_lshl_b32 s27, s27, 8
    s_add_u32 s26, s26, s27
    s_and_b32 s27, s25, 7
    s_lshl_b32 s27, s27, 1
    s_add_u32 s26, s26, s27
    s_add_u32 s26, s26, 8028160
    buffer_store_short v30, v1, s[8:11], s26 offen
    v_mov_b32 v30, 0
    ds_read_b128 v[32:35], v7 offset:480
    ds_read_b128 v[36:39], v7 offset:496
    ds_read_b128 v[40:43], v7 offset:512
    ds_read_b128 v[44:47], v7 offset:528
    ds_read_b128 v[48:51], v7 offset:544
    s_waitcnt lgkmcnt(0)
    v_fmac_f32 v30, v32, v8
    v_fmac_f32 v30, v33, v9
    v_fmac_f32 v30, v34, v10
    v_fmac_f32 v30, v35, v11
    v_fmac_f32 v30, v36, v12
    v_fmac_f32 v30, v37, v13
    v_fmac_f32 v30, v38, v14
    v_fmac_f32 v30, v39, v15
    v_fmac_f32 v30, v40, v16
    v_fmac_f32 v30, v41, v17
    v_fmac_f32 v30, v42, v18
    v_fmac_f32 v30, v43, v19
    v_fmac_f32 v30, v44, v20
    v_fmac_f32 v30, v45, v21
    v_fmac_f32 v30, v46, v22
    v_fmac_f32 v30, v47, v23
    v_fmac_f32 v30, v48, v24
    v_fmac_f32 v30, v49, v25
    v_fmac_f32 v30, v50, v26
    v_fmac_f32 v30, v51, v27
    v_cvt_pk_bf16_f32 v30, v30, v30
    s_mul_i32 s25, s2, 20
    s_add_u32 s25, s25, 6
    s_lshr_b32 s26, s25, 5
    s_lshl_b32 s26, s26, 10
    s_bfe_u32 s27, s25, 0x20003
    s_lshl_b32 s27, s27, 8
    s_add_u32 s26, s26, s27
    s_and_b32 s27, s25, 7
    s_lshl_b32 s27, s27, 1
    s_add_u32 s26, s26, s27
    s_add_u32 s26, s26, 8028160
    buffer_store_short v30, v1, s[8:11], s26 offen
    v_mov_b32 v30, 0
    ds_read_b128 v[32:35], v7 offset:560
    ds_read_b128 v[36:39], v7 offset:576
    ds_read_b128 v[40:43], v7 offset:592
    ds_read_b128 v[44:47], v7 offset:608
    ds_read_b128 v[48:51], v7 offset:624
    s_waitcnt lgkmcnt(0)
    v_fmac_f32 v30, v32, v8
    v_fmac_f32 v30, v33, v9
    v_fmac_f32 v30, v34, v10
    v_fmac_f32 v30, v35, v11
    v_fmac_f32 v30, v36, v12
    v_fmac_f32 v30, v37, v13
    v_fmac_f32 v30, v38, v14
    v_fmac_f32 v30, v39, v15
    v_fmac_f32 v30, v40, v16
    v_fmac_f32 v30, v41, v17
    v_fmac_f32 v30, v42, v18
    v_fmac_f32 v30, v43, v19
    v_fmac_f32 v30, v44, v20
    v_fmac_f32 v30, v45, v21
    v_fmac_f32 v30, v46, v22
    v_fmac_f32 v30, v47, v23
    v_fmac_f32 v30, v48, v24
    v_fmac_f32 v30, v49, v25
    v_fmac_f32 v30, v50, v26
    v_fmac_f32 v30, v51, v27
    v_cvt_pk_bf16_f32 v30, v30, v30
    s_mul_i32 s25, s2, 20
    s_add_u32 s25, s25, 7
    s_lshr_b32 s26, s25, 5
    s_lshl_b32 s26, s26, 10
    s_bfe_u32 s27, s25, 0x20003
    s_lshl_b32 s27, s27, 8
    s_add_u32 s26, s26, s27
    s_and_b32 s27, s25, 7
    s_lshl_b32 s27, s27, 1
    s_add_u32 s26, s26, s27
    s_add_u32 s26, s26, 8028160
    buffer_store_short v30, v1, s[8:11], s26 offen
    v_mov_b32 v30, 0
    ds_read_b128 v[32:35], v7 offset:640
    ds_read_b128 v[36:39], v7 offset:656
    ds_read_b128 v[40:43], v7 offset:672
    ds_read_b128 v[44:47], v7 offset:688
    ds_read_b128 v[48:51], v7 offset:704
    s_waitcnt lgkmcnt(0)
    v_fmac_f32 v30, v32, v8
    v_fmac_f32 v30, v33, v9
    v_fmac_f32 v30, v34, v10
    v_fmac_f32 v30, v35, v11
    v_fmac_f32 v30, v36, v12
    v_fmac_f32 v30, v37, v13
    v_fmac_f32 v30, v38, v14
    v_fmac_f32 v30, v39, v15
    v_fmac_f32 v30, v40, v16
    v_fmac_f32 v30, v41, v17
    v_fmac_f32 v30, v42, v18
    v_fmac_f32 v30, v43, v19
    v_fmac_f32 v30, v44, v20
    v_fmac_f32 v30, v45, v21
    v_fmac_f32 v30, v46, v22
    v_fmac_f32 v30, v47, v23
    v_fmac_f32 v30, v48, v24
    v_fmac_f32 v30, v49, v25
    v_fmac_f32 v30, v50, v26
    v_fmac_f32 v30, v51, v27
    v_cvt_pk_bf16_f32 v30, v30, v30
    s_mul_i32 s25, s2, 20
    s_add_u32 s25, s25, 8
    s_lshr_b32 s26, s25, 5
    s_lshl_b32 s26, s26, 10
    s_bfe_u32 s27, s25, 0x20003
    s_lshl_b32 s27, s27, 8
    s_add_u32 s26, s26, s27
    s_and_b32 s27, s25, 7
    s_lshl_b32 s27, s27, 1
    s_add_u32 s26, s26, s27
    s_add_u32 s26, s26, 8028160
    buffer_store_short v30, v1, s[8:11], s26 offen
    v_mov_b32 v30, 0
    ds_read_b128 v[32:35], v7 offset:720
    ds_read_b128 v[36:39], v7 offset:736
    ds_read_b128 v[40:43], v7 offset:752
    ds_read_b128 v[44:47], v7 offset:768
    ds_read_b128 v[48:51], v7 offset:784
    s_waitcnt lgkmcnt(0)
    v_fmac_f32 v30, v32, v8
    v_fmac_f32 v30, v33, v9
    v_fmac_f32 v30, v34, v10
    v_fmac_f32 v30, v35, v11
    v_fmac_f32 v30, v36, v12
    v_fmac_f32 v30, v37, v13
    v_fmac_f32 v30, v38, v14
    v_fmac_f32 v30, v39, v15
    v_fmac_f32 v30, v40, v16
    v_fmac_f32 v30, v41, v17
    v_fmac_f32 v30, v42, v18
    v_fmac_f32 v30, v43, v19
    v_fmac_f32 v30, v44, v20
    v_fmac_f32 v30, v45, v21
    v_fmac_f32 v30, v46, v22
    v_fmac_f32 v30, v47, v23
    v_fmac_f32 v30, v48, v24
    v_fmac_f32 v30, v49, v25
    v_fmac_f32 v30, v50, v26
    v_fmac_f32 v30, v51, v27
    v_cvt_pk_bf16_f32 v30, v30, v30
    s_mul_i32 s25, s2, 20
    s_add_u32 s25, s25, 9
    s_lshr_b32 s26, s25, 5
    s_lshl_b32 s26, s26, 10
    s_bfe_u32 s27, s25, 0x20003
    s_lshl_b32 s27, s27, 8
    s_add_u32 s26, s26, s27
    s_and_b32 s27, s25, 7
    s_lshl_b32 s27, s27, 1
    s_add_u32 s26, s26, s27
    s_add_u32 s26, s26, 8028160
    buffer_store_short v30, v1, s[8:11], s26 offen
    v_mov_b32 v30, 0
    ds_read_b128 v[32:35], v7 offset:800
    ds_read_b128 v[36:39], v7 offset:816
    ds_read_b128 v[40:43], v7 offset:832
    ds_read_b128 v[44:47], v7 offset:848
    ds_read_b128 v[48:51], v7 offset:864
    s_waitcnt lgkmcnt(0)
    v_fmac_f32 v30, v32, v8
    v_fmac_f32 v30, v33, v9
    v_fmac_f32 v30, v34, v10
    v_fmac_f32 v30, v35, v11
    v_fmac_f32 v30, v36, v12
    v_fmac_f32 v30, v37, v13
    v_fmac_f32 v30, v38, v14
    v_fmac_f32 v30, v39, v15
    v_fmac_f32 v30, v40, v16
    v_fmac_f32 v30, v41, v17
    v_fmac_f32 v30, v42, v18
    v_fmac_f32 v30, v43, v19
    v_fmac_f32 v30, v44, v20
    v_fmac_f32 v30, v45, v21
    v_fmac_f32 v30, v46, v22
    v_fmac_f32 v30, v47, v23
    v_fmac_f32 v30, v48, v24
    v_fmac_f32 v30, v49, v25
    v_fmac_f32 v30, v50, v26
    v_fmac_f32 v30, v51, v27
    v_cvt_pk_bf16_f32 v30, v30, v30
    s_mul_i32 s25, s2, 20
    s_add_u32 s25, s25, 10
    s_lshr_b32 s26, s25, 5
    s_lshl_b32 s26, s26, 10
    s_bfe_u32 s27, s25, 0x20003
    s_lshl_b32 s27, s27, 8
    s_add_u32 s26, s26, s27
    s_and_b32 s27, s25, 7
    s_lshl_b32 s27, s27, 1
    s_add_u32 s26, s26, s27
    s_add_u32 s26, s26, 8028160
    buffer_store_short v30, v1, s[8:11], s26 offen
    v_mov_b32 v30, 0
    ds_read_b128 v[32:35], v7 offset:880
    ds_read_b128 v[36:39], v7 offset:896
    ds_read_b128 v[40:43], v7 offset:912
    ds_read_b128 v[44:47], v7 offset:928
    ds_read_b128 v[48:51], v7 offset:944
    s_waitcnt lgkmcnt(0)
    v_fmac_f32 v30, v32, v8
    v_fmac_f32 v30, v33, v9
    v_fmac_f32 v30, v34, v10
    v_fmac_f32 v30, v35, v11
    v_fmac_f32 v30, v36, v12
    v_fmac_f32 v30, v37, v13
    v_fmac_f32 v30, v38, v14
    v_fmac_f32 v30, v39, v15
    v_fmac_f32 v30, v40, v16
    v_fmac_f32 v30, v41, v17
    v_fmac_f32 v30, v42, v18
    v_fmac_f32 v30, v43, v19
    v_fmac_f32 v30, v44, v20
    v_fmac_f32 v30, v45, v21
    v_fmac_f32 v30, v46, v22
    v_fmac_f32 v30, v47, v23
    v_fmac_f32 v30, v48, v24
    v_fmac_f32 v30, v49, v25
    v_fmac_f32 v30, v50, v26
    v_fmac_f32 v30, v51, v27
    v_cvt_pk_bf16_f32 v30, v30, v30
    s_mul_i32 s25, s2, 20
    s_add_u32 s25, s25, 11
    s_lshr_b32 s26, s25, 5
    s_lshl_b32 s26, s26, 10
    s_bfe_u32 s27, s25, 0x20003
    s_lshl_b32 s27, s27, 8
    s_add_u32 s26, s26, s27
    s_and_b32 s27, s25, 7
    s_lshl_b32 s27, s27, 1
    s_add_u32 s26, s26, s27
    s_add_u32 s26, s26, 8028160
    buffer_store_short v30, v1, s[8:11], s26 offen
    v_mov_b32 v30, 0
    ds_read_b128 v[32:35], v7 offset:960
    ds_read_b128 v[36:39], v7 offset:976
    ds_read_b128 v[40:43], v7 offset:992
    ds_read_b128 v[44:47], v7 offset:1008
    ds_read_b128 v[48:51], v7 offset:1024
    s_waitcnt lgkmcnt(0)
    v_fmac_f32 v30, v32, v8
    v_fmac_f32 v30, v33, v9
    v_fmac_f32 v30, v34, v10
    v_fmac_f32 v30, v35, v11
    v_fmac_f32 v30, v36, v12
    v_fmac_f32 v30, v37, v13
    v_fmac_f32 v30, v38, v14
    v_fmac_f32 v30, v39, v15
    v_fmac_f32 v30, v40, v16
    v_fmac_f32 v30, v41, v17
    v_fmac_f32 v30, v42, v18
    v_fmac_f32 v30, v43, v19
    v_fmac_f32 v30, v44, v20
    v_fmac_f32 v30, v45, v21
    v_fmac_f32 v30, v46, v22
    v_fmac_f32 v30, v47, v23
    v_fmac_f32 v30, v48, v24
    v_fmac_f32 v30, v49, v25
    v_fmac_f32 v30, v50, v26
    v_fmac_f32 v30, v51, v27
    v_cvt_pk_bf16_f32 v30, v30, v30
    s_mul_i32 s25, s2, 20
    s_add_u32 s25, s25, 12
    s_lshr_b32 s26, s25, 5
    s_lshl_b32 s26, s26, 10
    s_bfe_u32 s27, s25, 0x20003
    s_lshl_b32 s27, s27, 8
    s_add_u32 s26, s26, s27
    s_and_b32 s27, s25, 7
    s_lshl_b32 s27, s27, 1
    s_add_u32 s26, s26, s27
    s_add_u32 s26, s26, 8028160
    buffer_store_short v30, v1, s[8:11], s26 offen
    v_mov_b32 v30, 0
    ds_read_b128 v[32:35], v7 offset:1040
    ds_read_b128 v[36:39], v7 offset:1056
    ds_read_b128 v[40:43], v7 offset:1072
    ds_read_b128 v[44:47], v7 offset:1088
    ds_read_b128 v[48:51], v7 offset:1104
    s_waitcnt lgkmcnt(0)
    v_fmac_f32 v30, v32, v8
    v_fmac_f32 v30, v33, v9
    v_fmac_f32 v30, v34, v10
    v_fmac_f32 v30, v35, v11
    v_fmac_f32 v30, v36, v12
    v_fmac_f32 v30, v37, v13
    v_fmac_f32 v30, v38, v14
    v_fmac_f32 v30, v39, v15
    v_fmac_f32 v30, v40, v16
    v_fmac_f32 v30, v41, v17
    v_fmac_f32 v30, v42, v18
    v_fmac_f32 v30, v43, v19
    v_fmac_f32 v30, v44, v20
    v_fmac_f32 v30, v45, v21
    v_fmac_f32 v30, v46, v22
    v_fmac_f32 v30, v47, v23
    v_fmac_f32 v30, v48, v24
    v_fmac_f32 v30, v49, v25
    v_fmac_f32 v30, v50, v26
    v_fmac_f32 v30, v51, v27
    v_cvt_pk_bf16_f32 v30, v30, v30
    s_mul_i32 s25, s2, 20
    s_add_u32 s25, s25, 13
    s_lshr_b32 s26, s25, 5
    s_lshl_b32 s26, s26, 10
    s_bfe_u32 s27, s25, 0x20003
    s_lshl_b32 s27, s27, 8
    s_add_u32 s26, s26, s27
    s_and_b32 s27, s25, 7
    s_lshl_b32 s27, s27, 1
    s_add_u32 s26, s26, s27
    s_add_u32 s26, s26, 8028160
    buffer_store_short v30, v1, s[8:11], s26 offen
    v_mov_b32 v30, 0
    ds_read_b128 v[32:35], v7 offset:1120
    ds_read_b128 v[36:39], v7 offset:1136
    ds_read_b128 v[40:43], v7 offset:1152
    ds_read_b128 v[44:47], v7 offset:1168
    ds_read_b128 v[48:51], v7 offset:1184
    s_waitcnt lgkmcnt(0)
    v_fmac_f32 v30, v32, v8
    v_fmac_f32 v30, v33, v9
    v_fmac_f32 v30, v34, v10
    v_fmac_f32 v30, v35, v11
    v_fmac_f32 v30, v36, v12
    v_fmac_f32 v30, v37, v13
    v_fmac_f32 v30, v38, v14
    v_fmac_f32 v30, v39, v15
    v_fmac_f32 v30, v40, v16
    v_fmac_f32 v30, v41, v17
    v_fmac_f32 v30, v42, v18
    v_fmac_f32 v30, v43, v19
    v_fmac_f32 v30, v44, v20
    v_fmac_f32 v30, v45, v21
    v_fmac_f32 v30, v46, v22
    v_fmac_f32 v30, v47, v23
    v_fmac_f32 v30, v48, v24
    v_fmac_f32 v30, v49, v25
    v_fmac_f32 v30, v50, v26
    v_fmac_f32 v30, v51, v27
    v_cvt_pk_bf16_f32 v30, v30, v30
    s_mul_i32 s25, s2, 20
    s_add_u32 s25, s25, 14
    s_lshr_b32 s26, s25, 5
    s_lshl_b32 s26, s26, 10
    s_bfe_u32 s27, s25, 0x20003
    s_lshl_b32 s27, s27, 8
    s_add_u32 s26, s26, s27
    s_and_b32 s27, s25, 7
    s_lshl_b32 s27, s27, 1
    s_add_u32 s26, s26, s27
    s_add_u32 s26, s26, 8028160
    buffer_store_short v30, v1, s[8:11], s26 offen
    v_mov_b32 v30, 0
    ds_read_b128 v[32:35], v7 offset:1200
    ds_read_b128 v[36:39], v7 offset:1216
    ds_read_b128 v[40:43], v7 offset:1232
    ds_read_b128 v[44:47], v7 offset:1248
    ds_read_b128 v[48:51], v7 offset:1264
    s_waitcnt lgkmcnt(0)
    v_fmac_f32 v30, v32, v8
    v_fmac_f32 v30, v33, v9
    v_fmac_f32 v30, v34, v10
    v_fmac_f32 v30, v35, v11
    v_fmac_f32 v30, v36, v12
    v_fmac_f32 v30, v37, v13
    v_fmac_f32 v30, v38, v14
    v_fmac_f32 v30, v39, v15
    v_fmac_f32 v30, v40, v16
    v_fmac_f32 v30, v41, v17
    v_fmac_f32 v30, v42, v18
    v_fmac_f32 v30, v43, v19
    v_fmac_f32 v30, v44, v20
    v_fmac_f32 v30, v45, v21
    v_fmac_f32 v30, v46, v22
    v_fmac_f32 v30, v47, v23
    v_fmac_f32 v30, v48, v24
    v_fmac_f32 v30, v49, v25
    v_fmac_f32 v30, v50, v26
    v_fmac_f32 v30, v51, v27
    v_cvt_pk_bf16_f32 v30, v30, v30
    s_mul_i32 s25, s2, 20
    s_add_u32 s25, s25, 15
    s_lshr_b32 s26, s25, 5
    s_lshl_b32 s26, s26, 10
    s_bfe_u32 s27, s25, 0x20003
    s_lshl_b32 s27, s27, 8
    s_add_u32 s26, s26, s27
    s_and_b32 s27, s25, 7
    s_lshl_b32 s27, s27, 1
    s_add_u32 s26, s26, s27
    s_add_u32 s26, s26, 8028160
    buffer_store_short v30, v1, s[8:11], s26 offen
    v_mov_b32 v30, 0
    ds_read_b128 v[32:35], v7 offset:1280
    ds_read_b128 v[36:39], v7 offset:1296
    ds_read_b128 v[40:43], v7 offset:1312
    ds_read_b128 v[44:47], v7 offset:1328
    ds_read_b128 v[48:51], v7 offset:1344
    s_waitcnt lgkmcnt(0)
    v_fmac_f32 v30, v32, v8
    v_fmac_f32 v30, v33, v9
    v_fmac_f32 v30, v34, v10
    v_fmac_f32 v30, v35, v11
    v_fmac_f32 v30, v36, v12
    v_fmac_f32 v30, v37, v13
    v_fmac_f32 v30, v38, v14
    v_fmac_f32 v30, v39, v15
    v_fmac_f32 v30, v40, v16
    v_fmac_f32 v30, v41, v17
    v_fmac_f32 v30, v42, v18
    v_fmac_f32 v30, v43, v19
    v_fmac_f32 v30, v44, v20
    v_fmac_f32 v30, v45, v21
    v_fmac_f32 v30, v46, v22
    v_fmac_f32 v30, v47, v23
    v_fmac_f32 v30, v48, v24
    v_fmac_f32 v30, v49, v25
    v_fmac_f32 v30, v50, v26
    v_fmac_f32 v30, v51, v27
    v_cvt_pk_bf16_f32 v30, v30, v30
    s_mul_i32 s25, s2, 20
    s_add_u32 s25, s25, 16
    s_lshr_b32 s26, s25, 5
    s_lshl_b32 s26, s26, 10
    s_bfe_u32 s27, s25, 0x20003
    s_lshl_b32 s27, s27, 8
    s_add_u32 s26, s26, s27
    s_and_b32 s27, s25, 7
    s_lshl_b32 s27, s27, 1
    s_add_u32 s26, s26, s27
    s_add_u32 s26, s26, 8028160
    buffer_store_short v30, v1, s[8:11], s26 offen
    v_mov_b32 v30, 0
    ds_read_b128 v[32:35], v7 offset:1360
    ds_read_b128 v[36:39], v7 offset:1376
    ds_read_b128 v[40:43], v7 offset:1392
    ds_read_b128 v[44:47], v7 offset:1408
    ds_read_b128 v[48:51], v7 offset:1424
    s_waitcnt lgkmcnt(0)
    v_fmac_f32 v30, v32, v8
    v_fmac_f32 v30, v33, v9
    v_fmac_f32 v30, v34, v10
    v_fmac_f32 v30, v35, v11
    v_fmac_f32 v30, v36, v12
    v_fmac_f32 v30, v37, v13
    v_fmac_f32 v30, v38, v14
    v_fmac_f32 v30, v39, v15
    v_fmac_f32 v30, v40, v16
    v_fmac_f32 v30, v41, v17
    v_fmac_f32 v30, v42, v18
    v_fmac_f32 v30, v43, v19
    v_fmac_f32 v30, v44, v20
    v_fmac_f32 v30, v45, v21
    v_fmac_f32 v30, v46, v22
    v_fmac_f32 v30, v47, v23
    v_fmac_f32 v30, v48, v24
    v_fmac_f32 v30, v49, v25
    v_fmac_f32 v30, v50, v26
    v_fmac_f32 v30, v51, v27
    v_cvt_pk_bf16_f32 v30, v30, v30
    s_mul_i32 s25, s2, 20
    s_add_u32 s25, s25, 17
    s_lshr_b32 s26, s25, 5
    s_lshl_b32 s26, s26, 10
    s_bfe_u32 s27, s25, 0x20003
    s_lshl_b32 s27, s27, 8
    s_add_u32 s26, s26, s27
    s_and_b32 s27, s25, 7
    s_lshl_b32 s27, s27, 1
    s_add_u32 s26, s26, s27
    s_add_u32 s26, s26, 8028160
    buffer_store_short v30, v1, s[8:11], s26 offen
    v_mov_b32 v30, 0
    ds_read_b128 v[32:35], v7 offset:1440
    ds_read_b128 v[36:39], v7 offset:1456
    ds_read_b128 v[40:43], v7 offset:1472
    ds_read_b128 v[44:47], v7 offset:1488
    ds_read_b128 v[48:51], v7 offset:1504
    s_waitcnt lgkmcnt(0)
    v_fmac_f32 v30, v32, v8
    v_fmac_f32 v30, v33, v9
    v_fmac_f32 v30, v34, v10
    v_fmac_f32 v30, v35, v11
    v_fmac_f32 v30, v36, v12
    v_fmac_f32 v30, v37, v13
    v_fmac_f32 v30, v38, v14
    v_fmac_f32 v30, v39, v15
    v_fmac_f32 v30, v40, v16
    v_fmac_f32 v30, v41, v17
    v_fmac_f32 v30, v42, v18
    v_fmac_f32 v30, v43, v19
    v_fmac_f32 v30, v44, v20
    v_fmac_f32 v30, v45, v21
    v_fmac_f32 v30, v46, v22
    v_fmac_f32 v30, v47, v23
    v_fmac_f32 v30, v48, v24
    v_fmac_f32 v30, v49, v25
    v_fmac_f32 v30, v50, v26
    v_fmac_f32 v30, v51, v27
    v_cvt_pk_bf16_f32 v30, v30, v30
    s_mul_i32 s25, s2, 20
    s_add_u32 s25, s25, 18
    s_lshr_b32 s26, s25, 5
    s_lshl_b32 s26, s26, 10
    s_bfe_u32 s27, s25, 0x20003
    s_lshl_b32 s27, s27, 8
    s_add_u32 s26, s26, s27
    s_and_b32 s27, s25, 7
    s_lshl_b32 s27, s27, 1
    s_add_u32 s26, s26, s27
    s_add_u32 s26, s26, 8028160
    buffer_store_short v30, v1, s[8:11], s26 offen
    v_mov_b32 v30, 0
    ds_read_b128 v[32:35], v7 offset:1520
    ds_read_b128 v[36:39], v7 offset:1536
    ds_read_b128 v[40:43], v7 offset:1552
    ds_read_b128 v[44:47], v7 offset:1568
    ds_read_b128 v[48:51], v7 offset:1584
    s_waitcnt lgkmcnt(0)
    v_fmac_f32 v30, v32, v8
    v_fmac_f32 v30, v33, v9
    v_fmac_f32 v30, v34, v10
    v_fmac_f32 v30, v35, v11
    v_fmac_f32 v30, v36, v12
    v_fmac_f32 v30, v37, v13
    v_fmac_f32 v30, v38, v14
    v_fmac_f32 v30, v39, v15
    v_fmac_f32 v30, v40, v16
    v_fmac_f32 v30, v41, v17
    v_fmac_f32 v30, v42, v18
    v_fmac_f32 v30, v43, v19
    v_fmac_f32 v30, v44, v20
    v_fmac_f32 v30, v45, v21
    v_fmac_f32 v30, v46, v22
    v_fmac_f32 v30, v47, v23
    v_fmac_f32 v30, v48, v24
    v_fmac_f32 v30, v49, v25
    v_fmac_f32 v30, v50, v26
    v_fmac_f32 v30, v51, v27
    v_cvt_pk_bf16_f32 v30, v30, v30
    s_mul_i32 s25, s2, 20
    s_add_u32 s25, s25, 19
    s_lshr_b32 s26, s25, 5
    s_lshl_b32 s26, s26, 10
    s_bfe_u32 s27, s25, 0x20003
    s_lshl_b32 s27, s27, 8
    s_add_u32 s26, s26, s27
    s_and_b32 s27, s25, 7
    s_lshl_b32 s27, s27, 1
    s_add_u32 s26, s26, s27
    s_add_u32 s26, s26, 8028160
    buffer_store_short v30, v1, s[8:11], s26 offen
red_done:
    s_endpgm
.globl attn_kernel
.p2align 8
.type attn_kernel,@function
attn_kernel:
    s_cmp_ge_u32 s2, 256
    s_cbranch_scc1 attn_done
    s_load_dwordx2 s[4:5], s[0:1], 80
    s_load_dwordx2 s[6:7], s[0:1], 0
    s_load_dwordx2 s[28:29], s[0:1], 64
    s_mul_hi_u32 s30, s2, 536870913
    s_mul_i32 s31, s30, 8
    s_sub_u32 s31, s2, s31
    v_lshrrev_b32 v1, 6, v0
    s_nop 0
    v_readfirstlane_b32 s32, v1
    v_and_b32 v1, 63, v0
    s_waitcnt lgkmcnt(0)
    s_mov_b32 s8, s4
    s_mov_b32 s9, s5
    s_and_b32 s9, s9, 0xffff
    s_mov_b32 s10, 268435456
    s_mov_b32 s11, 0x00020000
    s_mov_b32 s12, s6
    s_mov_b32 s13, s7
    s_and_b32 s13, s13, 0xffff
    s_mov_b32 s14, 2621440
    s_mov_b32 s15, 0x00020000
    s_mov_b32 s16, s28
    s_mov_b32 s17, s29
    s_and_b32 s17, s17, 0xffff
    s_mov_b32 s18, 2621440
    s_mov_b32 s19, 0x00020000
    s_mul_i32 s33, s31, 5
    s_add_u32 s33, s33, s32
    s_mul_i32 s33, s33, 20480
    s_add_u32 s33, s33, 8028160
    v_lshlrev_b32 v2, 4, v1
    s_add_u32 s34, s33, 0
    buffer_load_dwordx4 v[14:17], v2, s[8:11], s34 offen
    s_add_u32 s34, s33, 1024
    buffer_load_dwordx4 v[18:21], v2, s[8:11], s34 offen
    s_add_u32 s34, s33, 2048
    buffer_load_dwordx4 v[22:25], v2, s[8:11], s34 offen
    s_add_u32 s34, s33, 3072
    buffer_load_dwordx4 v[26:29], v2, s[8:11], s34 offen
    s_add_u32 s34, s33, 4096
    buffer_load_dwordx4 v[30:33], v2, s[8:11], s34 offen
    s_add_u32 s34, s33, 5120
    buffer_load_dwordx4 v[34:37], v2, s[8:11], s34 offen
    s_add_u32 s34, s33, 6144
    buffer_load_dwordx4 v[38:41], v2, s[8:11], s34 offen
    s_add_u32 s34, s33, 7168
    buffer_load_dwordx4 v[42:45], v2, s[8:11], s34 offen
    s_add_u32 s34, s33, 8192
    buffer_load_dwordx4 v[46:49], v2, s[8:11], s34 offen
    s_add_u32 s34, s33, 9216
    buffer_load_dwordx4 v[50:53], v2, s[8:11], s34 offen
    s_add_u32 s34, s33, 10240
    buffer_load_dwordx4 v[54:57], v2, s[8:11], s34 offen
    s_add_u32 s34, s33, 11264
    buffer_load_dwordx4 v[58:61], v2, s[8:11], s34 offen
    s_add_u32 s34, s33, 12288
    buffer_load_dwordx4 v[62:65], v2, s[8:11], s34 offen
    s_add_u32 s34, s33, 13312
    buffer_load_dwordx4 v[66:69], v2, s[8:11], s34 offen
    s_add_u32 s34, s33, 14336
    buffer_load_dwordx4 v[70:73], v2, s[8:11], s34 offen
    s_add_u32 s34, s33, 15360
    buffer_load_dwordx4 v[74:77], v2, s[8:11], s34 offen
    s_add_u32 s34, s33, 16384
    buffer_load_dwordx4 v[78:81], v2, s[8:11], s34 offen
    s_add_u32 s34, s33, 17408
    buffer_load_dwordx4 v[82:85], v2, s[8:11], s34 offen
    s_add_u32 s34, s33, 18432
    buffer_load_dwordx4 v[86:89], v2, s[8:11], s34 offen
    s_add_u32 s34, s33, 19456
    buffer_load_dwordx4 v[90:93], v2, s[8:11], s34 offen
    v_and_b32 v3, 15, v1
    v_lshrrev_b32 v4, 4, v1
    s_lshl_b32 s35, s30, 6
    v_add_u32 v5, s35, v3
    s_mov_b32 s36, 1280
    v_mul_lo_u32 v5, v5, s36
    s_mul_i32 s36, s31, 160
    s_mul_i32 s37, s32, 32
    s_add_u32 s36, s36, s37
    v_lshl_add_u32 v5, v4, 3, v5
    v_add_u32 v5, s36, v5
    s_mov_b32 s34, 0
    buffer_load_dwordx2 v[110:111], v5, s[12:15], s34 offen
    s_mov_b32 s34, 20480
    buffer_load_dwordx2 v[112:113], v5, s[12:15], s34 offen
    s_mov_b32 s34, 40960
    buffer_load_dwordx2 v[114:115], v5, s[12:15], s34 offen
    s_mov_b32 s34, 61440
    buffer_load_dwordx2 v[116:117], v5, s[12:15], s34 offen
    v_and_b32 v6, 7, v1
    v_xor_b32 v7, v4, v6
    v_or_b32 v6, 4, v4
    v_and_b32 v3, 7, v1
    v_xor_b32 v6, v6, v3
    v_and_b32 v3, 15, v1
    v_mul_u32_u24 v3, 1280, v3
    v_lshl_add_u32 v7, v7, 4, v3
    v_lshl_add_u32 v6, v6, 4, v3
    v_mov_b32 v94, 0
    v_mov_b32 v95, 0
    v_mov_b32 v96, 0
    v_mov_b32 v97, 0
    v_mov_b32 v98, 0
    v_mov_b32 v99, 0
    v_mov_b32 v100, 0
    v_mov_b32 v101, 0
    v_mov_b32 v102, 0
    v_mov_b32 v103, 0
    v_mov_b32 v104, 0
    v_mov_b32 v105, 0
    v_mov_b32 v106, 0
    v_mov_b32 v107, 0
    v_mov_b32 v108, 0
    v_mov_b32 v109, 0
    s_cmp_ge_u32 s32, 4
    s_cbranch_scc1 attn_psk0
    v_and_b32 v3, 31, v0
    v_lshrrev_b32 v9, 5, v0
    v_mul_u32_u24 v8, 80, v3
    s_mov_b32 s34, 34881536
    buffer_load_dwordx4 v[118:121], v8, s[8:11], s34 offen
    s_mov_b32 s34, 34881552
    buffer_load_dwordx4 v[122:125], v8, s[8:11], s34 offen
    s_mov_b32 s34, 34881568
    buffer_load_dwordx4 v[126:129], v8, s[8:11], s34 offen
    s_mov_b32 s34, 34881584
    buffer_load_dwordx4 v[130:133], v8, s[8:11], s34 offen
    s_mov_b32 s34, 34881600
    buffer_load_dwordx4 v[134:137], v8, s[8:11], s34 offen
    v_add_u32 v8, s35, v9
    v_mul_u32_u24 v8, 1280, v8
    v_mul_u32_u24 v10, 40, v3
    v_add_u32 v8, v8, v10
    s_mov_b32 s34, 8847360
    buffer_load_dwordx2 v[138:139], v8, s[8:11], s34 offen
    s_mov_b32 s34, 8847368
    buffer_load_dwordx2 v[140:141], v8, s[8:11], s34 offen
    s_mov_b32 s34, 8847376
    buffer_load_dwordx2 v[142:143], v8, s[8:11], s34 offen
    s_mov_b32 s34, 8847384
    buffer_load_dwordx2 v[144:145], v8, s[8:11], s34 offen
    s_mov_b32 s34, 8847392
    buffer_load_dwordx2 v[146:147], v8, s[8:11], s34 offen
    s_mov_b32 s34, 8857600
    buffer_load_dwordx2 v[148:149], v8, s[8:11], s34 offen
    s_mov_b32 s34, 8857608
    buffer_load_dwordx2 v[150:151], v8, s[8:11], s34 offen
    s_mov_b32 s34, 8857616
    buffer_load_dwordx2 v[152:153], v8, s[8:11], s34 offen
    s_mov_b32 s34, 8857624
    buffer_load_dwordx2 v[154:155], v8, s[8:11], s34 offen
    s_mov_b32 s34, 8857632
    buffer_load_dwordx2 v[156:157], v8, s[8:11], s34 offen
    s_mov_b32 s34, 8867840
    buffer_load_dwordx2 v[158:159], v8, s[8:11], s34 offen
    s_mov_b32 s34, 8867848
    buffer_load_dwordx2 v[160:161], v8, s[8:11], s34 offen
    s_mov_b32 s34, 8867856
    buffer_load_dwordx2 v[162:163], v8, s[8:11], s34 offen
    s_mov_b32 s34, 8867864
    buffer_load_dwordx2 v[164:165], v8, s[8:11], s34 offen
    s_mov_b32 s34, 8867872
    buffer_load_dwordx2 v[166:167], v8, s[8:11], s34 offen
    s_mov_b32 s34, 8878080
    buffer_load_dwordx2 v[168:169], v8, s[8:11], s34 offen
    s_mov_b32 s34, 8878088
    buffer_load_dwordx2 v[170:171], v8, s[8:11], s34 offen
    s_mov_b32 s34, 8878096
    buffer_load_dwordx2 v[172:173], v8, s[8:11], s34 offen
    s_mov_b32 s34, 8878104
    buffer_load_dwordx2 v[174:175], v8, s[8:11], s34 offen
    s_mov_b32 s34, 8878112
    buffer_load_dwordx2 v[176:177], v8, s[8:11], s34 offen
    s_mov_b32 s34, 8888320
    buffer_load_dwordx2 v[178:179], v8, s[8:11], s34 offen
    s_mov_b32 s34, 8888328
    buffer_load_dwordx2 v[180:181], v8, s[8:11], s34 offen
    s_mov_b32 s34, 8888336
    buffer_load_dwordx2 v[182:183], v8, s[8:11], s34 offen
    s_mov_b32 s34, 8888344
    buffer_load_dwordx2 v[184:185], v8, s[8:11], s34 offen
    s_mov_b32 s34, 8888352
    buffer_load_dwordx2 v[186:187], v8, s[8:11], s34 offen
    s_mov_b32 s34, 8898560
    buffer_load_dwordx2 v[188:189], v8, s[8:11], s34 offen
    s_mov_b32 s34, 8898568
    buffer_load_dwordx2 v[190:191], v8, s[8:11], s34 offen
    s_mov_b32 s34, 8898576
    buffer_load_dwordx2 v[192:193], v8, s[8:11], s34 offen
    s_mov_b32 s34, 8898584
    buffer_load_dwordx2 v[194:195], v8, s[8:11], s34 offen
    s_mov_b32 s34, 8898592
    buffer_load_dwordx2 v[196:197], v8, s[8:11], s34 offen
    s_mov_b32 s34, 8908800
    buffer_load_dwordx2 v[198:199], v8, s[8:11], s34 offen
    s_mov_b32 s34, 8908808
    buffer_load_dwordx2 v[200:201], v8, s[8:11], s34 offen
    s_mov_b32 s34, 8908816
    buffer_load_dwordx2 v[202:203], v8, s[8:11], s34 offen
    s_mov_b32 s34, 8908824
    buffer_load_dwordx2 v[204:205], v8, s[8:11], s34 offen
    s_mov_b32 s34, 8908832
    buffer_load_dwordx2 v[206:207], v8, s[8:11], s34 offen
    s_mov_b32 s34, 8919040
    buffer_load_dwordx2 v[208:209], v8, s[8:11], s34 offen
    s_mov_b32 s34, 8919048
    buffer_load_dwordx2 v[210:211], v8, s[8:11], s34 offen
    s_mov_b32 s34, 8919056
    buffer_load_dwordx2 v[212:213], v8, s[8:11], s34 offen
    s_mov_b32 s34, 8919064
    buffer_load_dwordx2 v[214:215], v8, s[8:11], s34 offen
    s_mov_b32 s34, 8919072
    buffer_load_dwordx2 v[216:217], v8, s[8:11], s34 offen
    v_add_u32 v11, 0, v10
    v_lshrrev_b32 v12, 4, v11
    v_xor_b32 v12, v12, v9
    v_and_b32 v11, 8, v11
    v_lshl_add_u32 v218, v12, 4, v11
    v_mul_u32_u24 v12, 1280, v9
    v_add_u32 v218, v218, v12
    v_add_u32 v11, 8, v10
    v_lshrrev_b32 v12, 4, v11
    v_xor_b32 v12, v12, v9
    v_and_b32 v11, 8, v11
    v_lshl_add_u32 v219, v12, 4, v11
    v_mul_u32_u24 v12, 1280, v9
    v_add_u32 v219, v219, v12
    v_add_u32 v11, 16, v10
    v_lshrrev_b32 v12, 4, v11
    v_xor_b32 v12, v12, v9
    v_and_b32 v11, 8, v11
    v_lshl_add_u32 v220, v12, 4, v11
    v_mul_u32_u24 v12, 1280, v9
    v_add_u32 v220, v220, v12
    v_add_u32 v11, 24, v10
    v_lshrrev_b32 v12, 4, v11
    v_xor_b32 v12, v12, v9
    v_and_b32 v11, 8, v11
    v_lshl_add_u32 v221, v12, 4, v11
    v_mul_u32_u24 v12, 1280, v9
    v_add_u32 v221, v221, v12
    v_add_u32 v11, 32, v10
    v_lshrrev_b32 v12, 4, v11
    v_xor_b32 v12, v12, v9
    v_and_b32 v11, 8, v11
    v_lshl_add_u32 v222, v12, 4, v11
    v_mul_u32_u24 v12, 1280, v9
    v_add_u32 v222, v222, v12
    s_waitcnt vmcnt(0)
    v_lshlrev_b32 v226, 16, v138
    v_and_b32 v227, 0xffff0000, v138
    v_lshlrev_b32 v228, 16, v139
    v_and_b32 v229, 0xffff0000, v139
    v_lshlrev_b32 v230, 16, v140
    v_and_b32 v231, 0xffff0000, v140
    v_lshlrev_b32 v232, 16, v141
    v_and_b32 v233, 0xffff0000, v141
    v_lshlrev_b32 v234, 16, v142
    v_and_b32 v235, 0xffff0000, v142
    v_lshlrev_b32 v236, 16, v143
    v_and_b32 v237, 0xffff0000, v143
    v_lshlrev_b32 v238, 16, v144
    v_and_b32 v239, 0xffff0000, v144
    v_lshlrev_b32 v240, 16, v145
    v_and_b32 v241, 0xffff0000, v145
    v_lshlrev_b32 v242, 16, v146
    v_and_b32 v243, 0xffff0000, v146
    v_lshlrev_b32 v244, 16, v147
    v_and_b32 v245, 0xffff0000, v147
    v_mov_b32 v246, 0x358637bd
    v_fmac_f32 v246, v226, v118
    v_fmac_f32 v246, v227, v119
    v_fmac_f32 v246, v228, v120
    v_fmac_f32 v246, v229, v121
    v_fmac_f32 v246, v230, v122
    v_fmac_f32 v246, v231, v123
    v_fmac_f32 v246, v232, v124
    v_fmac_f32 v246, v233, v125
    v_fmac_f32 v246, v234, v126
    v_fmac_f32 v246, v235, v127
    v_fmac_f32 v246, v236, v128
    v_fmac_f32 v246, v237, v129
    v_fmac_f32 v246, v238, v130
    v_fmac_f32 v246, v239, v131
    v_fmac_f32 v246, v240, v132
    v_fmac_f32 v246, v241, v133
    v_fmac_f32 v246, v242, v134
    v_fmac_f32 v246, v243, v135
    v_fmac_f32 v246, v244, v136
    v_fmac_f32 v246, v245, v137
    v_rcp_f32 v246, v246
    s_nop 0
    v_mul_f32 v226, v226, v246
    v_mul_f32 v227, v227, v246
    v_mul_f32 v228, v228, v246
    v_mul_f32 v229, v229, v246
    v_mul_f32 v230, v230, v246
    v_mul_f32 v231, v231, v246
    v_mul_f32 v232, v232, v246
    v_mul_f32 v233, v233, v246
    v_mul_f32 v234, v234, v246
    v_mul_f32 v235, v235, v246
    v_mul_f32 v236, v236, v246
    v_mul_f32 v237, v237, v246
    v_mul_f32 v238, v238, v246
    v_mul_f32 v239, v239, v246
    v_mul_f32 v240, v240, v246
    v_mul_f32 v241, v241, v246
    v_mul_f32 v242, v242, v246
    v_mul_f32 v243, v243, v246
    v_mul_f32 v244, v244, v246
    v_mul_f32 v245, v245, v246
    v_cvt_pk_bf16_f32 v226, v226, v227
    v_cvt_pk_bf16_f32 v227, v228, v229
    ds_write_b64 v218, v[226:227] offset:0
    v_cvt_pk_bf16_f32 v230, v230, v231
    v_cvt_pk_bf16_f32 v231, v232, v233
    ds_write_b64 v219, v[230:231] offset:0
    v_cvt_pk_bf16_f32 v234, v234, v235
    v_cvt_pk_bf16_f32 v235, v236, v237
    ds_write_b64 v220, v[234:235] offset:0
    v_cvt_pk_bf16_f32 v238, v238, v239
    v_cvt_pk_bf16_f32 v239, v240, v241
    ds_write_b64 v221, v[238:239] offset:0
    v_cvt_pk_bf16_f32 v242, v242, v243
    v_cvt_pk_bf16_f32 v243, v244, v245
    ds_write_b64 v222, v[242:243] offset:0
    v_lshlrev_b32 v226, 16, v148
    v_and_b32 v227, 0xffff0000, v148
    v_lshlrev_b32 v228, 16, v149
    v_and_b32 v229, 0xffff0000, v149
    v_lshlrev_b32 v230, 16, v150
    v_and_b32 v231, 0xffff0000, v150
    v_lshlrev_b32 v232, 16, v151
    v_and_b32 v233, 0xffff0000, v151
    v_lshlrev_b32 v234, 16, v152
    v_and_b32 v235, 0xffff0000, v152
    v_lshlrev_b32 v236, 16, v153
    v_and_b32 v237, 0xffff0000, v153
    v_lshlrev_b32 v238, 16, v154
    v_and_b32 v239, 0xffff0000, v154
    v_lshlrev_b32 v240, 16, v155
    v_and_b32 v241, 0xffff0000, v155
    v_lshlrev_b32 v242, 16, v156
    v_and_b32 v243, 0xffff0000, v156
    v_lshlrev_b32 v244, 16, v157
    v_and_b32 v245, 0xffff0000, v157
    v_mov_b32 v246, 0x358637bd
    v_fmac_f32 v246, v226, v118
    v_fmac_f32 v246, v227, v119
    v_fmac_f32 v246, v228, v120
    v_fmac_f32 v246, v229, v121
    v_fmac_f32 v246, v230, v122
    v_fmac_f32 v246, v231, v123
    v_fmac_f32 v246, v232, v124
    v_fmac_f32 v246, v233, v125
    v_fmac_f32 v246, v234, v126
    v_fmac_f32 v246, v235, v127
    v_fmac_f32 v246, v236, v128
    v_fmac_f32 v246, v237, v129
    v_fmac_f32 v246, v238, v130
    v_fmac_f32 v246, v239, v131
    v_fmac_f32 v246, v240, v132
    v_fmac_f32 v246, v241, v133
    v_fmac_f32 v246, v242, v134
    v_fmac_f32 v246, v243, v135
    v_fmac_f32 v246, v244, v136
    v_fmac_f32 v246, v245, v137
    v_rcp_f32 v246, v246
    s_nop 0
    v_mul_f32 v226, v226, v246
    v_mul_f32 v227, v227, v246
    v_mul_f32 v228, v228, v246
    v_mul_f32 v229, v229, v246
    v_mul_f32 v230, v230, v246
    v_mul_f32 v231, v231, v246
    v_mul_f32 v232, v232, v246
    v_mul_f32 v233, v233, v246
    v_mul_f32 v234, v234, v246
    v_mul_f32 v235, v235, v246
    v_mul_f32 v236, v236, v246
    v_mul_f32 v237, v237, v246
    v_mul_f32 v238, v238, v246
    v_mul_f32 v239, v239, v246
    v_mul_f32 v240, v240, v246
    v_mul_f32 v241, v241, v246
    v_mul_f32 v242, v242, v246
    v_mul_f32 v243, v243, v246
    v_mul_f32 v244, v244, v246
    v_mul_f32 v245, v245, v246
    v_cvt_pk_bf16_f32 v226, v226, v227
    v_cvt_pk_bf16_f32 v227, v228, v229
    ds_write_b64 v218, v[226:227] offset:10240
    v_cvt_pk_bf16_f32 v230, v230, v231
    v_cvt_pk_bf16_f32 v231, v232, v233
    ds_write_b64 v219, v[230:231] offset:10240
    v_cvt_pk_bf16_f32 v234, v234, v235
    v_cvt_pk_bf16_f32 v235, v236, v237
    ds_write_b64 v220, v[234:235] offset:10240
    v_cvt_pk_bf16_f32 v238, v238, v239
    v_cvt_pk_bf16_f32 v239, v240, v241
    ds_write_b64 v221, v[238:239] offset:10240
    v_cvt_pk_bf16_f32 v242, v242, v243
    v_cvt_pk_bf16_f32 v243, v244, v245
    ds_write_b64 v222, v[242:243] offset:10240
    v_lshlrev_b32 v226, 16, v158
    v_and_b32 v227, 0xffff0000, v158
    v_lshlrev_b32 v228, 16, v159
    v_and_b32 v229, 0xffff0000, v159
    v_lshlrev_b32 v230, 16, v160
    v_and_b32 v231, 0xffff0000, v160
    v_lshlrev_b32 v232, 16, v161
    v_and_b32 v233, 0xffff0000, v161
    v_lshlrev_b32 v234, 16, v162
    v_and_b32 v235, 0xffff0000, v162
    v_lshlrev_b32 v236, 16, v163
    v_and_b32 v237, 0xffff0000, v163
    v_lshlrev_b32 v238, 16, v164
    v_and_b32 v239, 0xffff0000, v164
    v_lshlrev_b32 v240, 16, v165
    v_and_b32 v241, 0xffff0000, v165
    v_lshlrev_b32 v242, 16, v166
    v_and_b32 v243, 0xffff0000, v166
    v_lshlrev_b32 v244, 16, v167
    v_and_b32 v245, 0xffff0000, v167
    v_mov_b32 v246, 0x358637bd
    v_fmac_f32 v246, v226, v118
    v_fmac_f32 v246, v227, v119
    v_fmac_f32 v246, v228, v120
    v_fmac_f32 v246, v229, v121
    v_fmac_f32 v246, v230, v122
    v_fmac_f32 v246, v231, v123
    v_fmac_f32 v246, v232, v124
    v_fmac_f32 v246, v233, v125
    v_fmac_f32 v246, v234, v126
    v_fmac_f32 v246, v235, v127
    v_fmac_f32 v246, v236, v128
    v_fmac_f32 v246, v237, v129
    v_fmac_f32 v246, v238, v130
    v_fmac_f32 v246, v239, v131
    v_fmac_f32 v246, v240, v132
    v_fmac_f32 v246, v241, v133
    v_fmac_f32 v246, v242, v134
    v_fmac_f32 v246, v243, v135
    v_fmac_f32 v246, v244, v136
    v_fmac_f32 v246, v245, v137
    v_rcp_f32 v246, v246
    s_nop 0
    v_mul_f32 v226, v226, v246
    v_mul_f32 v227, v227, v246
    v_mul_f32 v228, v228, v246
    v_mul_f32 v229, v229, v246
    v_mul_f32 v230, v230, v246
    v_mul_f32 v231, v231, v246
    v_mul_f32 v232, v232, v246
    v_mul_f32 v233, v233, v246
    v_mul_f32 v234, v234, v246
    v_mul_f32 v235, v235, v246
    v_mul_f32 v236, v236, v246
    v_mul_f32 v237, v237, v246
    v_mul_f32 v238, v238, v246
    v_mul_f32 v239, v239, v246
    v_mul_f32 v240, v240, v246
    v_mul_f32 v241, v241, v246
    v_mul_f32 v242, v242, v246
    v_mul_f32 v243, v243, v246
    v_mul_f32 v244, v244, v246
    v_mul_f32 v245, v245, v246
    v_cvt_pk_bf16_f32 v226, v226, v227
    v_cvt_pk_bf16_f32 v227, v228, v229
    ds_write_b64 v218, v[226:227] offset:20480
    v_cvt_pk_bf16_f32 v230, v230, v231
    v_cvt_pk_bf16_f32 v231, v232, v233
    ds_write_b64 v219, v[230:231] offset:20480
    v_cvt_pk_bf16_f32 v234, v234, v235
    v_cvt_pk_bf16_f32 v235, v236, v237
    ds_write_b64 v220, v[234:235] offset:20480
    v_cvt_pk_bf16_f32 v238, v238, v239
    v_cvt_pk_bf16_f32 v239, v240, v241
    ds_write_b64 v221, v[238:239] offset:20480
    v_cvt_pk_bf16_f32 v242, v242, v243
    v_cvt_pk_bf16_f32 v243, v244, v245
    ds_write_b64 v222, v[242:243] offset:20480
    v_lshlrev_b32 v226, 16, v168
    v_and_b32 v227, 0xffff0000, v168
    v_lshlrev_b32 v228, 16, v169
    v_and_b32 v229, 0xffff0000, v169
    v_lshlrev_b32 v230, 16, v170
    v_and_b32 v231, 0xffff0000, v170
    v_lshlrev_b32 v232, 16, v171
    v_and_b32 v233, 0xffff0000, v171
    v_lshlrev_b32 v234, 16, v172
    v_and_b32 v235, 0xffff0000, v172
    v_lshlrev_b32 v236, 16, v173
    v_and_b32 v237, 0xffff0000, v173
    v_lshlrev_b32 v238, 16, v174
    v_and_b32 v239, 0xffff0000, v174
    v_lshlrev_b32 v240, 16, v175
    v_and_b32 v241, 0xffff0000, v175
    v_lshlrev_b32 v242, 16, v176
    v_and_b32 v243, 0xffff0000, v176
    v_lshlrev_b32 v244, 16, v177
    v_and_b32 v245, 0xffff0000, v177
    v_mov_b32 v246, 0x358637bd
    v_fmac_f32 v246, v226, v118
    v_fmac_f32 v246, v227, v119
    v_fmac_f32 v246, v228, v120
    v_fmac_f32 v246, v229, v121
    v_fmac_f32 v246, v230, v122
    v_fmac_f32 v246, v231, v123
    v_fmac_f32 v246, v232, v124
    v_fmac_f32 v246, v233, v125
    v_fmac_f32 v246, v234, v126
    v_fmac_f32 v246, v235, v127
    v_fmac_f32 v246, v236, v128
    v_fmac_f32 v246, v237, v129
    v_fmac_f32 v246, v238, v130
    v_fmac_f32 v246, v239, v131
    v_fmac_f32 v246, v240, v132
    v_fmac_f32 v246, v241, v133
    v_fmac_f32 v246, v242, v134
    v_fmac_f32 v246, v243, v135
    v_fmac_f32 v246, v244, v136
    v_fmac_f32 v246, v245, v137
    v_rcp_f32 v246, v246
    s_nop 0
    v_mul_f32 v226, v226, v246
    v_mul_f32 v227, v227, v246
    v_mul_f32 v228, v228, v246
    v_mul_f32 v229, v229, v246
    v_mul_f32 v230, v230, v246
    v_mul_f32 v231, v231, v246
    v_mul_f32 v232, v232, v246
    v_mul_f32 v233, v233, v246
    v_mul_f32 v234, v234, v246
    v_mul_f32 v235, v235, v246
    v_mul_f32 v236, v236, v246
    v_mul_f32 v237, v237, v246
    v_mul_f32 v238, v238, v246
    v_mul_f32 v239, v239, v246
    v_mul_f32 v240, v240, v246
    v_mul_f32 v241, v241, v246
    v_mul_f32 v242, v242, v246
    v_mul_f32 v243, v243, v246
    v_mul_f32 v244, v244, v246
    v_mul_f32 v245, v245, v246
    v_cvt_pk_bf16_f32 v226, v226, v227
    v_cvt_pk_bf16_f32 v227, v228, v229
    ds_write_b64 v218, v[226:227] offset:30720
    v_cvt_pk_bf16_f32 v230, v230, v231
    v_cvt_pk_bf16_f32 v231, v232, v233
    ds_write_b64 v219, v[230:231] offset:30720
    v_cvt_pk_bf16_f32 v234, v234, v235
    v_cvt_pk_bf16_f32 v235, v236, v237
    ds_write_b64 v220, v[234:235] offset:30720
    v_cvt_pk_bf16_f32 v238, v238, v239
    v_cvt_pk_bf16_f32 v239, v240, v241
    ds_write_b64 v221, v[238:239] offset:30720
    v_cvt_pk_bf16_f32 v242, v242, v243
    v_cvt_pk_bf16_f32 v243, v244, v245
    ds_write_b64 v222, v[242:243] offset:30720
    v_lshlrev_b32 v226, 16, v178
    v_and_b32 v227, 0xffff0000, v178
    v_lshlrev_b32 v228, 16, v179
    v_and_b32 v229, 0xffff0000, v179
    v_lshlrev_b32 v230, 16, v180
    v_and_b32 v231, 0xffff0000, v180
    v_lshlrev_b32 v232, 16, v181
    v_and_b32 v233, 0xffff0000, v181
    v_lshlrev_b32 v234, 16, v182
    v_and_b32 v235, 0xffff0000, v182
    v_lshlrev_b32 v236, 16, v183
    v_and_b32 v237, 0xffff0000, v183
    v_lshlrev_b32 v238, 16, v184
    v_and_b32 v239, 0xffff0000, v184
    v_lshlrev_b32 v240, 16, v185
    v_and_b32 v241, 0xffff0000, v185
    v_lshlrev_b32 v242, 16, v186
    v_and_b32 v243, 0xffff0000, v186
    v_lshlrev_b32 v244, 16, v187
    v_and_b32 v245, 0xffff0000, v187
    v_mov_b32 v246, 0x358637bd
    v_fmac_f32 v246, v226, v118
    v_fmac_f32 v246, v227, v119
    v_fmac_f32 v246, v228, v120
    v_fmac_f32 v246, v229, v121
    v_fmac_f32 v246, v230, v122
    v_fmac_f32 v246, v231, v123
    v_fmac_f32 v246, v232, v124
    v_fmac_f32 v246, v233, v125
    v_fmac_f32 v246, v234, v126
    v_fmac_f32 v246, v235, v127
    v_fmac_f32 v246, v236, v128
    v_fmac_f32 v246, v237, v129
    v_fmac_f32 v246, v238, v130
    v_fmac_f32 v246, v239, v131
    v_fmac_f32 v246, v240, v132
    v_fmac_f32 v246, v241, v133
    v_fmac_f32 v246, v242, v134
    v_fmac_f32 v246, v243, v135
    v_fmac_f32 v246, v244, v136
    v_fmac_f32 v246, v245, v137
    v_rcp_f32 v246, v246
    s_nop 0
    v_mul_f32 v226, v226, v246
    v_mul_f32 v227, v227, v246
    v_mul_f32 v228, v228, v246
    v_mul_f32 v229, v229, v246
    v_mul_f32 v230, v230, v246
    v_mul_f32 v231, v231, v246
    v_mul_f32 v232, v232, v246
    v_mul_f32 v233, v233, v246
    v_mul_f32 v234, v234, v246
    v_mul_f32 v235, v235, v246
    v_mul_f32 v236, v236, v246
    v_mul_f32 v237, v237, v246
    v_mul_f32 v238, v238, v246
    v_mul_f32 v239, v239, v246
    v_mul_f32 v240, v240, v246
    v_mul_f32 v241, v241, v246
    v_mul_f32 v242, v242, v246
    v_mul_f32 v243, v243, v246
    v_mul_f32 v244, v244, v246
    v_mul_f32 v245, v245, v246
    v_cvt_pk_bf16_f32 v226, v226, v227
    v_cvt_pk_bf16_f32 v227, v228, v229
    v_add_u32 v12, 40960, v218
    ds_write_b64 v12, v[226:227] offset:0
    v_cvt_pk_bf16_f32 v230, v230, v231
    v_cvt_pk_bf16_f32 v231, v232, v233
    v_add_u32 v12, 40960, v219
    ds_write_b64 v12, v[230:231] offset:0
    v_cvt_pk_bf16_f32 v234, v234, v235
    v_cvt_pk_bf16_f32 v235, v236, v237
    v_add_u32 v12, 40960, v220
    ds_write_b64 v12, v[234:235] offset:0
    v_cvt_pk_bf16_f32 v238, v238, v239
    v_cvt_pk_bf16_f32 v239, v240, v241
    v_add_u32 v12, 40960, v221
    ds_write_b64 v12, v[238:239] offset:0
    v_cvt_pk_bf16_f32 v242, v242, v243
    v_cvt_pk_bf16_f32 v243, v244, v245
    v_add_u32 v12, 40960, v222
    ds_write_b64 v12, v[242:243] offset:0
    v_lshlrev_b32 v226, 16, v188
    v_and_b32 v227, 0xffff0000, v188
    v_lshlrev_b32 v228, 16, v189
    v_and_b32 v229, 0xffff0000, v189
    v_lshlrev_b32 v230, 16, v190
    v_and_b32 v231, 0xffff0000, v190
    v_lshlrev_b32 v232, 16, v191
    v_and_b32 v233, 0xffff0000, v191
    v_lshlrev_b32 v234, 16, v192
    v_and_b32 v235, 0xffff0000, v192
    v_lshlrev_b32 v236, 16, v193
    v_and_b32 v237, 0xffff0000, v193
    v_lshlrev_b32 v238, 16, v194
    v_and_b32 v239, 0xffff0000, v194
    v_lshlrev_b32 v240, 16, v195
    v_and_b32 v241, 0xffff0000, v195
    v_lshlrev_b32 v242, 16, v196
    v_and_b32 v243, 0xffff0000, v196
    v_lshlrev_b32 v244, 16, v197
    v_and_b32 v245, 0xffff0000, v197
    v_mov_b32 v246, 0x358637bd
    v_fmac_f32 v246, v226, v118
    v_fmac_f32 v246, v227, v119
    v_fmac_f32 v246, v228, v120
    v_fmac_f32 v246, v229, v121
    v_fmac_f32 v246, v230, v122
    v_fmac_f32 v246, v231, v123
    v_fmac_f32 v246, v232, v124
    v_fmac_f32 v246, v233, v125
    v_fmac_f32 v246, v234, v126
    v_fmac_f32 v246, v235, v127
    v_fmac_f32 v246, v236, v128
    v_fmac_f32 v246, v237, v129
    v_fmac_f32 v246, v238, v130
    v_fmac_f32 v246, v239, v131
    v_fmac_f32 v246, v240, v132
    v_fmac_f32 v246, v241, v133
    v_fmac_f32 v246, v242, v134
    v_fmac_f32 v246, v243, v135
    v_fmac_f32 v246, v244, v136
    v_fmac_f32 v246, v245, v137
    v_rcp_f32 v246, v246
    s_nop 0
    v_mul_f32 v226, v226, v246
    v_mul_f32 v227, v227, v246
    v_mul_f32 v228, v228, v246
    v_mul_f32 v229, v229, v246
    v_mul_f32 v230, v230, v246
    v_mul_f32 v231, v231, v246
    v_mul_f32 v232, v232, v246
    v_mul_f32 v233, v233, v246
    v_mul_f32 v234, v234, v246
    v_mul_f32 v235, v235, v246
    v_mul_f32 v236, v236, v246
    v_mul_f32 v237, v237, v246
    v_mul_f32 v238, v238, v246
    v_mul_f32 v239, v239, v246
    v_mul_f32 v240, v240, v246
    v_mul_f32 v241, v241, v246
    v_mul_f32 v242, v242, v246
    v_mul_f32 v243, v243, v246
    v_mul_f32 v244, v244, v246
    v_mul_f32 v245, v245, v246
    v_cvt_pk_bf16_f32 v226, v226, v227
    v_cvt_pk_bf16_f32 v227, v228, v229
    v_add_u32 v12, 40960, v218
    ds_write_b64 v12, v[226:227] offset:10240
    v_cvt_pk_bf16_f32 v230, v230, v231
    v_cvt_pk_bf16_f32 v231, v232, v233
    v_add_u32 v12, 40960, v219
    ds_write_b64 v12, v[230:231] offset:10240
    v_cvt_pk_bf16_f32 v234, v234, v235
    v_cvt_pk_bf16_f32 v235, v236, v237
    v_add_u32 v12, 40960, v220
    ds_write_b64 v12, v[234:235] offset:10240
    v_cvt_pk_bf16_f32 v238, v238, v239
    v_cvt_pk_bf16_f32 v239, v240, v241
    v_add_u32 v12, 40960, v221
    ds_write_b64 v12, v[238:239] offset:10240
    v_cvt_pk_bf16_f32 v242, v242, v243
    v_cvt_pk_bf16_f32 v243, v244, v245
    v_add_u32 v12, 40960, v222
    ds_write_b64 v12, v[242:243] offset:10240
    v_lshlrev_b32 v226, 16, v198
    v_and_b32 v227, 0xffff0000, v198
    v_lshlrev_b32 v228, 16, v199
    v_and_b32 v229, 0xffff0000, v199
    v_lshlrev_b32 v230, 16, v200
    v_and_b32 v231, 0xffff0000, v200
    v_lshlrev_b32 v232, 16, v201
    v_and_b32 v233, 0xffff0000, v201
    v_lshlrev_b32 v234, 16, v202
    v_and_b32 v235, 0xffff0000, v202
    v_lshlrev_b32 v236, 16, v203
    v_and_b32 v237, 0xffff0000, v203
    v_lshlrev_b32 v238, 16, v204
    v_and_b32 v239, 0xffff0000, v204
    v_lshlrev_b32 v240, 16, v205
    v_and_b32 v241, 0xffff0000, v205
    v_lshlrev_b32 v242, 16, v206
    v_and_b32 v243, 0xffff0000, v206
    v_lshlrev_b32 v244, 16, v207
    v_and_b32 v245, 0xffff0000, v207
    v_mov_b32 v246, 0x358637bd
    v_fmac_f32 v246, v226, v118
    v_fmac_f32 v246, v227, v119
    v_fmac_f32 v246, v228, v120
    v_fmac_f32 v246, v229, v121
    v_fmac_f32 v246, v230, v122
    v_fmac_f32 v246, v231, v123
    v_fmac_f32 v246, v232, v124
    v_fmac_f32 v246, v233, v125
    v_fmac_f32 v246, v234, v126
    v_fmac_f32 v246, v235, v127
    v_fmac_f32 v246, v236, v128
    v_fmac_f32 v246, v237, v129
    v_fmac_f32 v246, v238, v130
    v_fmac_f32 v246, v239, v131
    v_fmac_f32 v246, v240, v132
    v_fmac_f32 v246, v241, v133
    v_fmac_f32 v246, v242, v134
    v_fmac_f32 v246, v243, v135
    v_fmac_f32 v246, v244, v136
    v_fmac_f32 v246, v245, v137
    v_rcp_f32 v246, v246
    s_nop 0
    v_mul_f32 v226, v226, v246
    v_mul_f32 v227, v227, v246
    v_mul_f32 v228, v228, v246
    v_mul_f32 v229, v229, v246
    v_mul_f32 v230, v230, v246
    v_mul_f32 v231, v231, v246
    v_mul_f32 v232, v232, v246
    v_mul_f32 v233, v233, v246
    v_mul_f32 v234, v234, v246
    v_mul_f32 v235, v235, v246
    v_mul_f32 v236, v236, v246
    v_mul_f32 v237, v237, v246
    v_mul_f32 v238, v238, v246
    v_mul_f32 v239, v239, v246
    v_mul_f32 v240, v240, v246
    v_mul_f32 v241, v241, v246
    v_mul_f32 v242, v242, v246
    v_mul_f32 v243, v243, v246
    v_mul_f32 v244, v244, v246
    v_mul_f32 v245, v245, v246
    v_cvt_pk_bf16_f32 v226, v226, v227
    v_cvt_pk_bf16_f32 v227, v228, v229
    v_add_u32 v12, 40960, v218
    ds_write_b64 v12, v[226:227] offset:20480
    v_cvt_pk_bf16_f32 v230, v230, v231
    v_cvt_pk_bf16_f32 v231, v232, v233
    v_add_u32 v12, 40960, v219
    ds_write_b64 v12, v[230:231] offset:20480
    v_cvt_pk_bf16_f32 v234, v234, v235
    v_cvt_pk_bf16_f32 v235, v236, v237
    v_add_u32 v12, 40960, v220
    ds_write_b64 v12, v[234:235] offset:20480
    v_cvt_pk_bf16_f32 v238, v238, v239
    v_cvt_pk_bf16_f32 v239, v240, v241
    v_add_u32 v12, 40960, v221
    ds_write_b64 v12, v[238:239] offset:20480
    v_cvt_pk_bf16_f32 v242, v242, v243
    v_cvt_pk_bf16_f32 v243, v244, v245
    v_add_u32 v12, 40960, v222
    ds_write_b64 v12, v[242:243] offset:20480
    v_lshlrev_b32 v226, 16, v208
    v_and_b32 v227, 0xffff0000, v208
    v_lshlrev_b32 v228, 16, v209
    v_and_b32 v229, 0xffff0000, v209
    v_lshlrev_b32 v230, 16, v210
    v_and_b32 v231, 0xffff0000, v210
    v_lshlrev_b32 v232, 16, v211
    v_and_b32 v233, 0xffff0000, v211
    v_lshlrev_b32 v234, 16, v212
    v_and_b32 v235, 0xffff0000, v212
    v_lshlrev_b32 v236, 16, v213
    v_and_b32 v237, 0xffff0000, v213
    v_lshlrev_b32 v238, 16, v214
    v_and_b32 v239, 0xffff0000, v214
    v_lshlrev_b32 v240, 16, v215
    v_and_b32 v241, 0xffff0000, v215
    v_lshlrev_b32 v242, 16, v216
    v_and_b32 v243, 0xffff0000, v216
    v_lshlrev_b32 v244, 16, v217
    v_and_b32 v245, 0xffff0000, v217
    v_mov_b32 v246, 0x358637bd
    v_fmac_f32 v246, v226, v118
    v_fmac_f32 v246, v227, v119
    v_fmac_f32 v246, v228, v120
    v_fmac_f32 v246, v229, v121
    v_fmac_f32 v246, v230, v122
    v_fmac_f32 v246, v231, v123
    v_fmac_f32 v246, v232, v124
    v_fmac_f32 v246, v233, v125
    v_fmac_f32 v246, v234, v126
    v_fmac_f32 v246, v235, v127
    v_fmac_f32 v246, v236, v128
    v_fmac_f32 v246, v237, v129
    v_fmac_f32 v246, v238, v130
    v_fmac_f32 v246, v239, v131
    v_fmac_f32 v246, v240, v132
    v_fmac_f32 v246, v241, v133
    v_fmac_f32 v246, v242, v134
    v_fmac_f32 v246, v243, v135
    v_fmac_f32 v246, v244, v136
    v_fmac_f32 v246, v245, v137
    v_rcp_f32 v246, v246
    s_nop 0
    v_mul_f32 v226, v226, v246
    v_mul_f32 v227, v227, v246
    v_mul_f32 v228, v228, v246
    v_mul_f32 v229, v229, v246
    v_mul_f32 v230, v230, v246
    v_mul_f32 v231, v231, v246
    v_mul_f32 v232, v232, v246
    v_mul_f32 v233, v233, v246
    v_mul_f32 v234, v234, v246
    v_mul_f32 v235, v235, v246
    v_mul_f32 v236, v236, v246
    v_mul_f32 v237, v237, v246
    v_mul_f32 v238, v238, v246
    v_mul_f32 v239, v239, v246
    v_mul_f32 v240, v240, v246
    v_mul_f32 v241, v241, v246
    v_mul_f32 v242, v242, v246
    v_mul_f32 v243, v243, v246
    v_mul_f32 v244, v244, v246
    v_mul_f32 v245, v245, v246
    v_cvt_pk_bf16_f32 v226, v226, v227
    v_cvt_pk_bf16_f32 v227, v228, v229
    v_add_u32 v12, 40960, v218
    ds_write_b64 v12, v[226:227] offset:30720
    v_cvt_pk_bf16_f32 v230, v230, v231
    v_cvt_pk_bf16_f32 v231, v232, v233
    v_add_u32 v12, 40960, v219
    ds_write_b64 v12, v[230:231] offset:30720
    v_cvt_pk_bf16_f32 v234, v234, v235
    v_cvt_pk_bf16_f32 v235, v236, v237
    v_add_u32 v12, 40960, v220
    ds_write_b64 v12, v[234:235] offset:30720
    v_cvt_pk_bf16_f32 v238, v238, v239
    v_cvt_pk_bf16_f32 v239, v240, v241
    v_add_u32 v12, 40960, v221
    ds_write_b64 v12, v[238:239] offset:30720
    v_cvt_pk_bf16_f32 v242, v242, v243
    v_cvt_pk_bf16_f32 v243, v244, v245
    v_add_u32 v12, 40960, v222
    ds_write_b64 v12, v[242:243] offset:30720
attn_psk0:
    s_waitcnt vmcnt(0) lgkmcnt(0)
    s_barrier
    ds_read_b128 v[118:121], v7 offset:0
    ds_read_b128 v[122:125], v7 offset:20480
    ds_read_b128 v[126:129], v7 offset:40960
    ds_read_b128 v[130:133], v7 offset:61440
    ds_read_b128 v[134:137], v6 offset:0
    ds_read_b128 v[138:141], v6 offset:20480
    ds_read_b128 v[142:145], v6 offset:40960
    ds_read_b128 v[146:149], v6 offset:61440
    s_waitcnt lgkmcnt(4)
    v_mfma_f32_16x16x32_bf16 v[94:97], v[14:17], v[118:121], v[94:97]
    v_mfma_f32_16x16x32_bf16 v[98:101], v[14:17], v[122:125], v[98:101]
    v_mfma_f32_16x16x32_bf16 v[102:105], v[14:17], v[126:129], v[102:105]
    v_mfma_f32_16x16x32_bf16 v[106:109], v[14:17], v[130:133], v[106:109]
    ds_read_b128 v[118:121], v7 offset:128
    ds_read_b128 v[122:125], v7 offset:20608
    ds_read_b128 v[126:129], v7 offset:41088
    ds_read_b128 v[130:133], v7 offset:61568
    s_waitcnt lgkmcnt(4)
    v_mfma_f32_16x16x32_bf16 v[94:97], v[18:21], v[134:137], v[94:97]
    v_mfma_f32_16x16x32_bf16 v[98:101], v[18:21], v[138:141], v[98:101]
    v_mfma_f32_16x16x32_bf16 v[102:105], v[18:21], v[142:145], v[102:105]
    v_mfma_f32_16x16x32_bf16 v[106:109], v[18:21], v[146:149], v[106:109]
    ds_read_b128 v[134:137], v6 offset:128
    ds_read_b128 v[138:141], v6 offset:20608
    ds_read_b128 v[142:145], v6 offset:41088
    ds_read_b128 v[146:149], v6 offset:61568
    s_waitcnt lgkmcnt(4)
    v_mfma_f32_16x16x32_bf16 v[94:97], v[22:25], v[118:121], v[94:97]
    v_mfma_f32_16x16x32_bf16 v[98:101], v[22:25], v[122:125], v[98:101]
    v_mfma_f32_16x16x32_bf16 v[102:105], v[22:25], v[126:129], v[102:105]
    v_mfma_f32_16x16x32_bf16 v[106:109], v[22:25], v[130:133], v[106:109]
    ds_read_b128 v[118:121], v7 offset:256
    ds_read_b128 v[122:125], v7 offset:20736
    ds_read_b128 v[126:129], v7 offset:41216
    ds_read_b128 v[130:133], v7 offset:61696
    s_waitcnt lgkmcnt(4)
    v_mfma_f32_16x16x32_bf16 v[94:97], v[26:29], v[134:137], v[94:97]
    v_mfma_f32_16x16x32_bf16 v[98:101], v[26:29], v[138:141], v[98:101]
    v_mfma_f32_16x16x32_bf16 v[102:105], v[26:29], v[142:145], v[102:105]
    v_mfma_f32_16x16x32_bf16 v[106:109], v[26:29], v[146:149], v[106:109]
    ds_read_b128 v[134:137], v6 offset:256
    ds_read_b128 v[138:141], v6 offset:20736
    ds_read_b128 v[142:145], v6 offset:41216
    ds_read_b128 v[146:149], v6 offset:61696
    s_waitcnt lgkmcnt(4)
    v_mfma_f32_16x16x32_bf16 v[94:97], v[30:33], v[118:121], v[94:97]
    v_mfma_f32_16x16x32_bf16 v[98:101], v[30:33], v[122:125], v[98:101]
    v_mfma_f32_16x16x32_bf16 v[102:105], v[30:33], v[126:129], v[102:105]
    v_mfma_f32_16x16x32_bf16 v[106:109], v[30:33], v[130:133], v[106:109]
    ds_read_b128 v[118:121], v7 offset:384
    ds_read_b128 v[122:125], v7 offset:20864
    ds_read_b128 v[126:129], v7 offset:41344
    ds_read_b128 v[130:133], v7 offset:61824
    s_waitcnt lgkmcnt(4)
    v_mfma_f32_16x16x32_bf16 v[94:97], v[34:37], v[134:137], v[94:97]
    v_mfma_f32_16x16x32_bf16 v[98:101], v[34:37], v[138:141], v[98:101]
    v_mfma_f32_16x16x32_bf16 v[102:105], v[34:37], v[142:145], v[102:105]
    v_mfma_f32_16x16x32_bf16 v[106:109], v[34:37], v[146:149], v[106:109]
    ds_read_b128 v[134:137], v6 offset:384
    ds_read_b128 v[138:141], v6 offset:20864
    ds_read_b128 v[142:145], v6 offset:41344
    ds_read_b128 v[146:149], v6 offset:61824
    s_waitcnt lgkmcnt(4)
    v_mfma_f32_16x16x32_bf16 v[94:97], v[38:41], v[118:121], v[94:97]
    v_mfma_f32_16x16x32_bf16 v[98:101], v[38:41], v[122:125], v[98:101]
    v_mfma_f32_16x16x32_bf16 v[102:105], v[38:41], v[126:129], v[102:105]
    v_mfma_f32_16x16x32_bf16 v[106:109], v[38:41], v[130:133], v[106:109]
    ds_read_b128 v[118:121], v7 offset:512
    ds_read_b128 v[122:125], v7 offset:20992
    ds_read_b128 v[126:129], v7 offset:41472
    ds_read_b128 v[130:133], v7 offset:61952
    s_waitcnt lgkmcnt(4)
    v_mfma_f32_16x16x32_bf16 v[94:97], v[42:45], v[134:137], v[94:97]
    v_mfma_f32_16x16x32_bf16 v[98:101], v[42:45], v[138:141], v[98:101]
    v_mfma_f32_16x16x32_bf16 v[102:105], v[42:45], v[142:145], v[102:105]
    v_mfma_f32_16x16x32_bf16 v[106:109], v[42:45], v[146:149], v[106:109]
    ds_read_b128 v[134:137], v6 offset:512
    ds_read_b128 v[138:141], v6 offset:20992
    ds_read_b128 v[142:145], v6 offset:41472
    ds_read_b128 v[146:149], v6 offset:61952
    s_waitcnt lgkmcnt(4)
    v_mfma_f32_16x16x32_bf16 v[94:97], v[46:49], v[118:121], v[94:97]
    v_mfma_f32_16x16x32_bf16 v[98:101], v[46:49], v[122:125], v[98:101]
    v_mfma_f32_16x16x32_bf16 v[102:105], v[46:49], v[126:129], v[102:105]
    v_mfma_f32_16x16x32_bf16 v[106:109], v[46:49], v[130:133], v[106:109]
    ds_read_b128 v[118:121], v7 offset:640
    ds_read_b128 v[122:125], v7 offset:21120
    ds_read_b128 v[126:129], v7 offset:41600
    ds_read_b128 v[130:133], v7 offset:62080
    s_waitcnt lgkmcnt(4)
    v_mfma_f32_16x16x32_bf16 v[94:97], v[50:53], v[134:137], v[94:97]
    v_mfma_f32_16x16x32_bf16 v[98:101], v[50:53], v[138:141], v[98:101]
    v_mfma_f32_16x16x32_bf16 v[102:105], v[50:53], v[142:145], v[102:105]
    v_mfma_f32_16x16x32_bf16 v[106:109], v[50:53], v[146:149], v[106:109]
    ds_read_b128 v[134:137], v6 offset:640
    ds_read_b128 v[138:141], v6 offset:21120
    ds_read_b128 v[142:145], v6 offset:41600
    ds_read_b128 v[146:149], v6 offset:62080
    s_waitcnt lgkmcnt(4)
    v_mfma_f32_16x16x32_bf16 v[94:97], v[54:57], v[118:121], v[94:97]
    v_mfma_f32_16x16x32_bf16 v[98:101], v[54:57], v[122:125], v[98:101]
    v_mfma_f32_16x16x32_bf16 v[102:105], v[54:57], v[126:129], v[102:105]
    v_mfma_f32_16x16x32_bf16 v[106:109], v[54:57], v[130:133], v[106:109]
    ds_read_b128 v[118:121], v7 offset:768
    ds_read_b128 v[122:125], v7 offset:21248
    ds_read_b128 v[126:129], v7 offset:41728
    ds_read_b128 v[130:133], v7 offset:62208
    s_waitcnt lgkmcnt(4)
    v_mfma_f32_16x16x32_bf16 v[94:97], v[58:61], v[134:137], v[94:97]
    v_mfma_f32_16x16x32_bf16 v[98:101], v[58:61], v[138:141], v[98:101]
    v_mfma_f32_16x16x32_bf16 v[102:105], v[58:61], v[142:145], v[102:105]
    v_mfma_f32_16x16x32_bf16 v[106:109], v[58:61], v[146:149], v[106:109]
    ds_read_b128 v[134:137], v6 offset:768
    ds_read_b128 v[138:141], v6 offset:21248
    ds_read_b128 v[142:145], v6 offset:41728
    ds_read_b128 v[146:149], v6 offset:62208
    s_waitcnt lgkmcnt(4)
    v_mfma_f32_16x16x32_bf16 v[94:97], v[62:65], v[118:121], v[94:97]
    v_mfma_f32_16x16x32_bf16 v[98:101], v[62:65], v[122:125], v[98:101]
    v_mfma_f32_16x16x32_bf16 v[102:105], v[62:65], v[126:129], v[102:105]
    v_mfma_f32_16x16x32_bf16 v[106:109], v[62:65], v[130:133], v[106:109]
    ds_read_b128 v[118:121], v7 offset:896
    ds_read_b128 v[122:125], v7 offset:21376
    ds_read_b128 v[126:129], v7 offset:41856
    ds_read_b128 v[130:133], v7 offset:62336
    s_waitcnt lgkmcnt(4)
    v_mfma_f32_16x16x32_bf16 v[94:97], v[66:69], v[134:137], v[94:97]
    v_mfma_f32_16x16x32_bf16 v[98:101], v[66:69], v[138:141], v[98:101]
    v_mfma_f32_16x16x32_bf16 v[102:105], v[66:69], v[142:145], v[102:105]
    v_mfma_f32_16x16x32_bf16 v[106:109], v[66:69], v[146:149], v[106:109]
    ds_read_b128 v[134:137], v6 offset:896
    ds_read_b128 v[138:141], v6 offset:21376
    ds_read_b128 v[142:145], v6 offset:41856
    ds_read_b128 v[146:149], v6 offset:62336
    s_waitcnt lgkmcnt(4)
    v_mfma_f32_16x16x32_bf16 v[94:97], v[70:73], v[118:121], v[94:97]
    v_mfma_f32_16x16x32_bf16 v[98:101], v[70:73], v[122:125], v[98:101]
    v_mfma_f32_16x16x32_bf16 v[102:105], v[70:73], v[126:129], v[102:105]
    v_mfma_f32_16x16x32_bf16 v[106:109], v[70:73], v[130:133], v[106:109]
    ds_read_b128 v[118:121], v7 offset:1024
    ds_read_b128 v[122:125], v7 offset:21504
    ds_read_b128 v[126:129], v7 offset:41984
    ds_read_b128 v[130:133], v7 offset:62464
    s_waitcnt lgkmcnt(4)
    v_mfma_f32_16x16x32_bf16 v[94:97], v[74:77], v[134:137], v[94:97]
    v_mfma_f32_16x16x32_bf16 v[98:101], v[74:77], v[138:141], v[98:101]
    v_mfma_f32_16x16x32_bf16 v[102:105], v[74:77], v[142:145], v[102:105]
    v_mfma_f32_16x16x32_bf16 v[106:109], v[74:77], v[146:149], v[106:109]
    ds_read_b128 v[134:137], v6 offset:1024
    ds_read_b128 v[138:141], v6 offset:21504
    ds_read_b128 v[142:145], v6 offset:41984
    ds_read_b128 v[146:149], v6 offset:62464
    s_waitcnt lgkmcnt(4)
    v_mfma_f32_16x16x32_bf16 v[94:97], v[78:81], v[118:121], v[94:97]
    v_mfma_f32_16x16x32_bf16 v[98:101], v[78:81], v[122:125], v[98:101]
    v_mfma_f32_16x16x32_bf16 v[102:105], v[78:81], v[126:129], v[102:105]
    v_mfma_f32_16x16x32_bf16 v[106:109], v[78:81], v[130:133], v[106:109]
    ds_read_b128 v[118:121], v7 offset:1152
    ds_read_b128 v[122:125], v7 offset:21632
    ds_read_b128 v[126:129], v7 offset:42112
    ds_read_b128 v[130:133], v7 offset:62592
    s_waitcnt lgkmcnt(4)
    v_mfma_f32_16x16x32_bf16 v[94:97], v[82:85], v[134:137], v[94:97]
    v_mfma_f32_16x16x32_bf16 v[98:101], v[82:85], v[138:141], v[98:101]
    v_mfma_f32_16x16x32_bf16 v[102:105], v[82:85], v[142:145], v[102:105]
    v_mfma_f32_16x16x32_bf16 v[106:109], v[82:85], v[146:149], v[106:109]
    ds_read_b128 v[134:137], v6 offset:1152
    ds_read_b128 v[138:141], v6 offset:21632
    ds_read_b128 v[142:145], v6 offset:42112
    ds_read_b128 v[146:149], v6 offset:62592
    s_waitcnt lgkmcnt(4)
    v_mfma_f32_16x16x32_bf16 v[94:97], v[86:89], v[118:121], v[94:97]
    v_mfma_f32_16x16x32_bf16 v[98:101], v[86:89], v[122:125], v[98:101]
    v_mfma_f32_16x16x32_bf16 v[102:105], v[86:89], v[126:129], v[102:105]
    v_mfma_f32_16x16x32_bf16 v[106:109], v[86:89], v[130:133], v[106:109]
    s_waitcnt lgkmcnt(0)
    v_mfma_f32_16x16x32_bf16 v[94:97], v[90:93], v[134:137], v[94:97]
    v_mfma_f32_16x16x32_bf16 v[98:101], v[90:93], v[138:141], v[98:101]
    v_mfma_f32_16x16x32_bf16 v[102:105], v[90:93], v[142:145], v[102:105]
    v_mfma_f32_16x16x32_bf16 v[106:109], v[90:93], v[146:149], v[106:109]
    s_nop 7
    s_nop 7
    v_lshlrev_b32 v118, 16, v110
    v_add_f32 v94, v94, v118
    v_and_b32 v118, 0xffff0000, v110
    v_add_f32 v95, v95, v118
    v_lshlrev_b32 v118, 16, v111
    v_add_f32 v96, v96, v118
    v_and_b32 v118, 0xffff0000, v111
    v_add_f32 v97, v97, v118
    v_cvt_pk_bf16_f32 v94, v94, v95
    v_cvt_pk_bf16_f32 v95, v96, v97
    s_mov_b32 s34, 11468800
    buffer_store_dwordx2 v[94:95], v5, s[8:11], s34 offen
    v_lshlrev_b32 v118, 16, v112
    v_add_f32 v98, v98, v118
    v_and_b32 v118, 0xffff0000, v112
    v_add_f32 v99, v99, v118
    v_lshlrev_b32 v118, 16, v113
    v_add_f32 v100, v100, v118
    v_and_b32 v118, 0xffff0000, v113
    v_add_f32 v101, v101, v118
    v_cvt_pk_bf16_f32 v98, v98, v99
    v_cvt_pk_bf16_f32 v99, v100, v101
    s_mov_b32 s34, 11489280
    buffer_store_dwordx2 v[98:99], v5, s[8:11], s34 offen
    v_lshlrev_b32 v118, 16, v114
    v_add_f32 v102, v102, v118
    v_and_b32 v118, 0xffff0000, v114
    v_add_f32 v103, v103, v118
    v_lshlrev_b32 v118, 16, v115
    v_add_f32 v104, v104, v118
    v_and_b32 v118, 0xffff0000, v115
    v_add_f32 v105, v105, v118
    v_cvt_pk_bf16_f32 v102, v102, v103
    v_cvt_pk_bf16_f32 v103, v104, v105
    s_mov_b32 s34, 11509760
    buffer_store_dwordx2 v[102:103], v5, s[8:11], s34 offen
    v_lshlrev_b32 v118, 16, v116
    v_add_f32 v106, v106, v118
    v_and_b32 v118, 0xffff0000, v116
    v_add_f32 v107, v107, v118
    v_lshlrev_b32 v118, 16, v117
    v_add_f32 v108, v108, v118
    v_and_b32 v118, 0xffff0000, v117
    v_add_f32 v109, v109, v118
    v_cvt_pk_bf16_f32 v106, v106, v107
    v_cvt_pk_bf16_f32 v107, v108, v109
    s_mov_b32 s34, 11530240
    buffer_store_dwordx2 v[106:107], v5, s[8:11], s34 offen
attn_done:
    s_endpgm
.globl mix1_kernel
.p2align 8
.type mix1_kernel,@function
mix1_kernel:
    s_cmp_ge_u32 s2, 256
    s_cbranch_scc1 mix1_done
    s_load_dwordx2 s[4:5], s[0:1], 80
    s_load_dwordx2 s[6:7], s[0:1], 0
    s_load_dwordx2 s[28:29], s[0:1], 64
    s_mul_hi_u32 s30, s2, 536870913
    s_mul_i32 s31, s30, 8
    s_sub_u32 s31, s2, s31
    v_lshrrev_b32 v1, 6, v0
    s_nop 0
    v_readfirstlane_b32 s32, v1
    v_and_b32 v1, 63, v0
    s_waitcnt lgkmcnt(0)
    s_mov_b32 s8, s4
    s_mov_b32 s9, s5
    s_and_b32 s9, s9, 0xffff
    s_mov_b32 s10, 268435456
    s_mov_b32 s11, 0x00020000
    s_mov_b32 s12, s6
    s_mov_b32 s13, s7
    s_and_b32 s13, s13, 0xffff
    s_mov_b32 s14, 2621440
    s_mov_b32 s15, 0x00020000
    s_mov_b32 s16, s28
    s_mov_b32 s17, s29
    s_and_b32 s17, s17, 0xffff
    s_mov_b32 s18, 2621440
    s_mov_b32 s19, 0x00020000
    s_mul_i32 s33, s31, 5
    s_add_u32 s33, s33, s32
    s_mul_i32 s33, s33, 20480
    s_add_u32 s33, s33, 2457600
    v_lshlrev_b32 v2, 4, v1
    s_add_u32 s34, s33, 0
    buffer_load_dwordx4 v[14:17], v2, s[8:11], s34 offen
    s_add_u32 s34, s33, 1024
    buffer_load_dwordx4 v[18:21], v2, s[8:11], s34 offen
    s_add_u32 s34, s33, 2048
    buffer_load_dwordx4 v[22:25], v2, s[8:11], s34 offen
    s_add_u32 s34, s33, 3072
    buffer_load_dwordx4 v[26:29], v2, s[8:11], s34 offen
    s_add_u32 s34, s33, 4096
    buffer_load_dwordx4 v[30:33], v2, s[8:11], s34 offen
    s_add_u32 s34, s33, 5120
    buffer_load_dwordx4 v[34:37], v2, s[8:11], s34 offen
    s_add_u32 s34, s33, 6144
    buffer_load_dwordx4 v[38:41], v2, s[8:11], s34 offen
    s_add_u32 s34, s33, 7168
    buffer_load_dwordx4 v[42:45], v2, s[8:11], s34 offen
    s_add_u32 s34, s33, 8192
    buffer_load_dwordx4 v[46:49], v2, s[8:11], s34 offen
    s_add_u32 s34, s33, 9216
    buffer_load_dwordx4 v[50:53], v2, s[8:11], s34 offen
    s_add_u32 s34, s33, 10240
    buffer_load_dwordx4 v[54:57], v2, s[8:11], s34 offen
    s_add_u32 s34, s33, 11264
    buffer_load_dwordx4 v[58:61], v2, s[8:11], s34 offen
    s_add_u32 s34, s33, 12288
    buffer_load_dwordx4 v[62:65], v2, s[8:11], s34 offen
    s_add_u32 s34, s33, 13312
    buffer_load_dwordx4 v[66:69], v2, s[8:11], s34 offen
    s_add_u32 s34, s33, 14336
    buffer_load_dwordx4 v[70:73], v2, s[8:11], s34 offen
    s_add_u32 s34, s33, 15360
    buffer_load_dwordx4 v[74:77], v2, s[8:11], s34 offen
    s_add_u32 s34, s33, 16384
    buffer_load_dwordx4 v[78:81], v2, s[8:11], s34 offen
    s_add_u32 s34, s33, 17408
    buffer_load_dwordx4 v[82:85], v2, s[8:11], s34 offen
    s_add_u32 s34, s33, 18432
    buffer_load_dwordx4 v[86:89], v2, s[8:11], s34 offen
    s_add_u32 s34, s33, 19456
    buffer_load_dwordx4 v[90:93], v2, s[8:11], s34 offen
    v_and_b32 v3, 15, v1
    v_lshrrev_b32 v4, 4, v1
    s_lshl_b32 s35, s30, 6
    v_add_u32 v5, s35, v3
    s_mov_b32 s36, 1280
    v_mul_lo_u32 v5, v5, s36
    s_mul_i32 s36, s31, 160
    s_mul_i32 s37, s32, 32
    s_add_u32 s36, s36, s37
    v_lshl_add_u32 v5, v4, 3, v5
    v_add_u32 v5, s36, v5
    v_and_b32 v6, 7, v1
    v_xor_b32 v7, v4, v6
    v_or_b32 v6, 4, v4
    v_and_b32 v3, 7, v1
    v_xor_b32 v6, v6, v3
    v_and_b32 v3, 15, v1
    v_mul_u32_u24 v3, 1280, v3
    v_lshl_add_u32 v7, v7, 4, v3
    v_lshl_add_u32 v6, v6, 4, v3
    v_mov_b32 v94, 0
    v_mov_b32 v95, 0
    v_mov_b32 v96, 0
    v_mov_b32 v97, 0
    v_mov_b32 v98, 0
    v_mov_b32 v99, 0
    v_mov_b32 v100, 0
    v_mov_b32 v101, 0
    v_mov_b32 v102, 0
    v_mov_b32 v103, 0
    v_mov_b32 v104, 0
    v_mov_b32 v105, 0
    v_mov_b32 v106, 0
    v_mov_b32 v107, 0
    v_mov_b32 v108, 0
    v_mov_b32 v109, 0
    s_cmp_ge_u32 s32, 4
    s_cbranch_scc1 mix1_psk0
    v_and_b32 v3, 15, v1
    s_lshl_b32 s34, s32, 4
    s_add_u32 s34, s34, s35
    v_add_u32 v8, s34, v4
    s_mov_b32 s34, 1280
    v_mul_lo_u32 v8, v8, s34
    v_lshl_add_u32 v8, v3, 4, v8
    s_lshl_b32 s34, s32, 4
    v_add_u32 v9, s34, v4
    v_mul_u32_u24 v9, 1280, v9
    s_mov_b32 s34, 11468800
    buffer_load_dwordx4 v[110:113], v8, s[8:11], s34 offen
    s_mov_b32 s34, 11469056
    buffer_load_dwordx4 v[114:117], v8, s[8:11], s34 offen
    s_mov_b32 s34, 11469312
    buffer_load_dwordx4 v[118:121], v8, s[8:11], s34 offen
    s_mov_b32 s34, 11469568
    buffer_load_dwordx4 v[122:125], v8, s[8:11], s34 offen
    s_mov_b32 s34, 11469824
    buffer_load_dwordx4 v[126:129], v8, s[8:11], s34 offen
    s_mov_b32 s34, 11473920
    buffer_load_dwordx4 v[130:133], v8, s[8:11], s34 offen
    s_mov_b32 s34, 11474176
    buffer_load_dwordx4 v[134:137], v8, s[8:11], s34 offen
    s_mov_b32 s34, 11474432
    buffer_load_dwordx4 v[138:141], v8, s[8:11], s34 offen
    s_mov_b32 s34, 11474688
    buffer_load_dwordx4 v[142:145], v8, s[8:11], s34 offen
    s_mov_b32 s34, 11474944
    buffer_load_dwordx4 v[146:149], v8, s[8:11], s34 offen
    s_mov_b32 s34, 11479040
    buffer_load_dwordx4 v[150:153], v8, s[8:11], s34 offen
    s_mov_b32 s34, 11479296
    buffer_load_dwordx4 v[154:157], v8, s[8:11], s34 offen
    s_mov_b32 s34, 11479552
    buffer_load_dwordx4 v[158:161], v8, s[8:11], s34 offen
    s_mov_b32 s34, 11479808
    buffer_load_dwordx4 v[162:165], v8, s[8:11], s34 offen
    s_mov_b32 s34, 11480064
    buffer_load_dwordx4 v[166:169], v8, s[8:11], s34 offen
    s_mov_b32 s34, 11484160
    buffer_load_dwordx4 v[170:173], v8, s[8:11], s34 offen
    s_mov_b32 s34, 11484416
    buffer_load_dwordx4 v[174:177], v8, s[8:11], s34 offen
    s_mov_b32 s34, 11484672
    buffer_load_dwordx4 v[178:181], v8, s[8:11], s34 offen
    s_mov_b32 s34, 11484928
    buffer_load_dwordx4 v[182:185], v8, s[8:11], s34 offen
    s_mov_b32 s34, 11485184
    buffer_load_dwordx4 v[186:189], v8, s[8:11], s34 offen
    s_waitcnt vmcnt(15)
    v_lshlrev_b32 v190, 16, v110
    v_and_b32 v191, 0xffff0000, v110
    v_lshlrev_b32 v192, 16, v111
    v_and_b32 v193, 0xffff0000, v111
    v_lshlrev_b32 v194, 16, v112
    v_and_b32 v195, 0xffff0000, v112
    v_lshlrev_b32 v196, 16, v113
    v_and_b32 v197, 0xffff0000, v113
    v_lshlrev_b32 v198, 16, v114
    v_and_b32 v199, 0xffff0000, v114
    v_lshlrev_b32 v200, 16, v115
    v_and_b32 v201, 0xffff0000, v115
    v_lshlrev_b32 v202, 16, v116
    v_and_b32 v203, 0xffff0000, v116
    v_lshlrev_b32 v204, 16, v117
    v_and_b32 v205, 0xffff0000, v117
    v_lshlrev_b32 v206, 16, v118
    v_and_b32 v207, 0xffff0000, v118
    v_lshlrev_b32 v208, 16, v119
    v_and_b32 v209, 0xffff0000, v119
    v_lshlrev_b32 v210, 16, v120
    v_and_b32 v211, 0xffff0000, v120
    v_lshlrev_b32 v212, 16, v121
    v_and_b32 v213, 0xffff0000, v121
    v_lshlrev_b32 v214, 16, v122
    v_and_b32 v215, 0xffff0000, v122
    v_lshlrev_b32 v216, 16, v123
    v_and_b32 v217, 0xffff0000, v123
    v_lshlrev_b32 v218, 16, v124
    v_and_b32 v219, 0xffff0000, v124
    v_lshlrev_b32 v220, 16, v125
    v_and_b32 v221, 0xffff0000, v125
    v_lshlrev_b32 v222, 16, v126
    v_and_b32 v223, 0xffff0000, v126
    v_lshlrev_b32 v224, 16, v127
    v_and_b32 v225, 0xffff0000, v127
    v_lshlrev_b32 v226, 16, v128
    v_and_b32 v227, 0xffff0000, v128
    v_lshlrev_b32 v228, 16, v129
    v_and_b32 v229, 0xffff0000, v129
    v_add_f32 v230, v190, v191
    v_add_f32 v230, v230, v192
    v_add_f32 v230, v230, v193
    v_add_f32 v230, v230, v194
    v_add_f32 v230, v230, v195
    v_add_f32 v230, v230, v196
    v_add_f32 v230, v230, v197
    v_add_f32 v230, v230, v198
    v_add_f32 v230, v230, v199
    v_add_f32 v230, v230, v200
    v_add_f32 v230, v230, v201
    v_add_f32 v230, v230, v202
    v_add_f32 v230, v230, v203
    v_add_f32 v230, v230, v204
    v_add_f32 v230, v230, v205
    v_add_f32 v230, v230, v206
    v_add_f32 v230, v230, v207
    v_add_f32 v230, v230, v208
    v_add_f32 v230, v230, v209
    v_add_f32 v230, v230, v210
    v_add_f32 v230, v230, v211
    v_add_f32 v230, v230, v212
    v_add_f32 v230, v230, v213
    v_add_f32 v230, v230, v214
    v_add_f32 v230, v230, v215
    v_add_f32 v230, v230, v216
    v_add_f32 v230, v230, v217
    v_add_f32 v230, v230, v218
    v_add_f32 v230, v230, v219
    v_add_f32 v230, v230, v220
    v_add_f32 v230, v230, v221
    v_add_f32 v230, v230, v222
    v_add_f32 v230, v230, v223
    v_add_f32 v230, v230, v224
    v_add_f32 v230, v230, v225
    v_add_f32 v230, v230, v226
    v_add_f32 v230, v230, v227
    v_add_f32 v230, v230, v228
    v_add_f32 v230, v230, v229
    s_nop 1
    v_add_f32_dpp v230, v230, v230 row_ror:8 row_mask:0xf bank_mask:0xf
    s_nop 1
    v_add_f32_dpp v230, v230, v230 row_ror:4 row_mask:0xf bank_mask:0xf
    s_nop 1
    v_add_f32_dpp v230, v230, v230 row_ror:2 row_mask:0xf bank_mask:0xf
    s_nop 1
    v_add_f32_dpp v230, v230, v230 row_ror:1 row_mask:0xf bank_mask:0xf
    v_mul_f32 v230, 0.0015625, v230
    v_sub_f32 v190, v190, v230
    v_sub_f32 v191, v191, v230
    v_sub_f32 v192, v192, v230
    v_sub_f32 v193, v193, v230
    v_sub_f32 v194, v194, v230
    v_sub_f32 v195, v195, v230
    v_sub_f32 v196, v196, v230
    v_sub_f32 v197, v197, v230
    v_sub_f32 v198, v198, v230
    v_sub_f32 v199, v199, v230
    v_sub_f32 v200, v200, v230
    v_sub_f32 v201, v201, v230
    v_sub_f32 v202, v202, v230
    v_sub_f32 v203, v203, v230
    v_sub_f32 v204, v204, v230
    v_sub_f32 v205, v205, v230
    v_sub_f32 v206, v206, v230
    v_sub_f32 v207, v207, v230
    v_sub_f32 v208, v208, v230
    v_sub_f32 v209, v209, v230
    v_sub_f32 v210, v210, v230
    v_sub_f32 v211, v211, v230
    v_sub_f32 v212, v212, v230
    v_sub_f32 v213, v213, v230
    v_sub_f32 v214, v214, v230
    v_sub_f32 v215, v215, v230
    v_sub_f32 v216, v216, v230
    v_sub_f32 v217, v217, v230
    v_sub_f32 v218, v218, v230
    v_sub_f32 v219, v219, v230
    v_sub_f32 v220, v220, v230
    v_sub_f32 v221, v221, v230
    v_sub_f32 v222, v222, v230
    v_sub_f32 v223, v223, v230
    v_sub_f32 v224, v224, v230
    v_sub_f32 v225, v225, v230
    v_sub_f32 v226, v226, v230
    v_sub_f32 v227, v227, v230
    v_sub_f32 v228, v228, v230
    v_sub_f32 v229, v229, v230
    v_mul_f32 v230, v190, v190
    v_fmac_f32 v230, v191, v191
    v_fmac_f32 v230, v192, v192
    v_fmac_f32 v230, v193, v193
    v_fmac_f32 v230, v194, v194
    v_fmac_f32 v230, v195, v195
    v_fmac_f32 v230, v196, v196
    v_fmac_f32 v230, v197, v197
    v_fmac_f32 v230, v198, v198
    v_fmac_f32 v230, v199, v199
    v_fmac_f32 v230, v200, v200
    v_fmac_f32 v230, v201, v201
    v_fmac_f32 v230, v202, v202
    v_fmac_f32 v230, v203, v203
    v_fmac_f32 v230, v204, v204
    v_fmac_f32 v230, v205, v205
    v_fmac_f32 v230, v206, v206
    v_fmac_f32 v230, v207, v207
    v_fmac_f32 v230, v208, v208
    v_fmac_f32 v230, v209, v209
    v_fmac_f32 v230, v210, v210
    v_fmac_f32 v230, v211, v211
    v_fmac_f32 v230, v212, v212
    v_fmac_f32 v230, v213, v213
    v_fmac_f32 v230, v214, v214
    v_fmac_f32 v230, v215, v215
    v_fmac_f32 v230, v216, v216
    v_fmac_f32 v230, v217, v217
    v_fmac_f32 v230, v218, v218
    v_fmac_f32 v230, v219, v219
    v_fmac_f32 v230, v220, v220
    v_fmac_f32 v230, v221, v221
    v_fmac_f32 v230, v222, v222
    v_fmac_f32 v230, v223, v223
    v_fmac_f32 v230, v224, v224
    v_fmac_f32 v230, v225, v225
    v_fmac_f32 v230, v226, v226
    v_fmac_f32 v230, v227, v227
    v_fmac_f32 v230, v228, v228
    v_fmac_f32 v230, v229, v229
    s_nop 1
    v_add_f32_dpp v230, v230, v230 row_ror:8 row_mask:0xf bank_mask:0xf
    s_nop 1
    v_add_f32_dpp v230, v230, v230 row_ror:4 row_mask:0xf bank_mask:0xf
    s_nop 1
    v_add_f32_dpp v230, v230, v230 row_ror:2 row_mask:0xf bank_mask:0xf
    s_nop 1
    v_add_f32_dpp v230, v230, v230 row_ror:1 row_mask:0xf bank_mask:0xf
    v_mov_b32 v231, 0x3727c5ac
    v_fmac_f32 v231, 0.0015625, v230
    v_rsq_f32 v231, v231
    s_nop 0
    v_mul_f32 v190, v190, v231
    v_mul_f32 v191, v191, v231
    v_mul_f32 v192, v192, v231
    v_mul_f32 v193, v193, v231
    v_mul_f32 v194, v194, v231
    v_mul_f32 v195, v195, v231
    v_mul_f32 v196, v196, v231
    v_mul_f32 v197, v197, v231
    v_mul_f32 v198, v198, v231
    v_mul_f32 v199, v199, v231
    v_mul_f32 v200, v200, v231
    v_mul_f32 v201, v201, v231
    v_mul_f32 v202, v202, v231
    v_mul_f32 v203, v203, v231
    v_mul_f32 v204, v204, v231
    v_mul_f32 v205, v205, v231
    v_mul_f32 v206, v206, v231
    v_mul_f32 v207, v207, v231
    v_mul_f32 v208, v208, v231
    v_mul_f32 v209, v209, v231
    v_mul_f32 v210, v210, v231
    v_mul_f32 v211, v211, v231
    v_mul_f32 v212, v212, v231
    v_mul_f32 v213, v213, v231
    v_mul_f32 v214, v214, v231
    v_mul_f32 v215, v215, v231
    v_mul_f32 v216, v216, v231
    v_mul_f32 v217, v217, v231
    v_mul_f32 v218, v218, v231
    v_mul_f32 v219, v219, v231
    v_mul_f32 v220, v220, v231
    v_mul_f32 v221, v221, v231
    v_mul_f32 v222, v222, v231
    v_mul_f32 v223, v223, v231
    v_mul_f32 v224, v224, v231
    v_mul_f32 v225, v225, v231
    v_mul_f32 v226, v226, v231
    v_mul_f32 v227, v227, v231
    v_mul_f32 v228, v228, v231
    v_mul_f32 v229, v229, v231
    v_cvt_pk_bf16_f32 v110, v190, v191
    v_cvt_pk_bf16_f32 v111, v192, v193
    v_cvt_pk_bf16_f32 v112, v194, v195
    v_cvt_pk_bf16_f32 v113, v196, v197
    v_cvt_pk_bf16_f32 v114, v198, v199
    v_cvt_pk_bf16_f32 v115, v200, v201
    v_cvt_pk_bf16_f32 v116, v202, v203
    v_cvt_pk_bf16_f32 v117, v204, v205
    v_cvt_pk_bf16_f32 v118, v206, v207
    v_cvt_pk_bf16_f32 v119, v208, v209
    v_cvt_pk_bf16_f32 v120, v210, v211
    v_cvt_pk_bf16_f32 v121, v212, v213
    v_cvt_pk_bf16_f32 v122, v214, v215
    v_cvt_pk_bf16_f32 v123, v216, v217
    v_cvt_pk_bf16_f32 v124, v218, v219
    v_cvt_pk_bf16_f32 v125, v220, v221
    v_cvt_pk_bf16_f32 v126, v222, v223
    v_cvt_pk_bf16_f32 v127, v224, v225
    v_cvt_pk_bf16_f32 v128, v226, v227
    v_cvt_pk_bf16_f32 v129, v228, v229
    s_cmp_lg_u32 s31, 0
    s_cbranch_scc1 mix1_nw0
    s_mov_b32 s34, 14090240
    buffer_store_dwordx4 v[110:113], v8, s[8:11], s34 offen
    s_mov_b32 s34, 14090496
    buffer_store_dwordx4 v[114:117], v8, s[8:11], s34 offen
    s_mov_b32 s34, 14090752
    buffer_store_dwordx4 v[118:121], v8, s[8:11], s34 offen
    s_mov_b32 s34, 14091008
    buffer_store_dwordx4 v[122:125], v8, s[8:11], s34 offen
    s_mov_b32 s34, 14091264
    buffer_store_dwordx4 v[126:129], v8, s[8:11], s34 offen
mix1_nw0:
    v_lshlrev_b32 v190, 16, v110
    v_and_b32 v191, 0xffff0000, v110
    v_lshlrev_b32 v192, 16, v111
    v_and_b32 v193, 0xffff0000, v111
    v_lshlrev_b32 v194, 16, v112
    v_and_b32 v195, 0xffff0000, v112
    v_lshlrev_b32 v196, 16, v113
    v_and_b32 v197, 0xffff0000, v113
    v_lshlrev_b32 v198, 16, v114
    v_and_b32 v199, 0xffff0000, v114
    v_lshlrev_b32 v200, 16, v115
    v_and_b32 v201, 0xffff0000, v115
    v_lshlrev_b32 v202, 16, v116
    v_and_b32 v203, 0xffff0000, v116
    v_lshlrev_b32 v204, 16, v117
    v_and_b32 v205, 0xffff0000, v117
    v_lshlrev_b32 v206, 16, v118
    v_and_b32 v207, 0xffff0000, v118
    v_lshlrev_b32 v208, 16, v119
    v_and_b32 v209, 0xffff0000, v119
    v_lshlrev_b32 v210, 16, v120
    v_and_b32 v211, 0xffff0000, v120
    v_lshlrev_b32 v212, 16, v121
    v_and_b32 v213, 0xffff0000, v121
    v_lshlrev_b32 v214, 16, v122
    v_and_b32 v215, 0xffff0000, v122
    v_lshlrev_b32 v216, 16, v123
    v_and_b32 v217, 0xffff0000, v123
    v_lshlrev_b32 v218, 16, v124
    v_and_b32 v219, 0xffff0000, v124
    v_lshlrev_b32 v220, 16, v125
    v_and_b32 v221, 0xffff0000, v125
    v_lshlrev_b32 v222, 16, v126
    v_and_b32 v223, 0xffff0000, v126
    v_lshlrev_b32 v224, 16, v127
    v_and_b32 v225, 0xffff0000, v127
    v_lshlrev_b32 v226, 16, v128
    v_and_b32 v227, 0xffff0000, v128
    v_lshlrev_b32 v228, 16, v129
    v_and_b32 v229, 0xffff0000, v129
    v_add_f32 v230, v190, v191
    v_add_f32 v230, v230, v192
    v_add_f32 v230, v230, v193
    v_add_f32 v230, v230, v194
    v_add_f32 v230, v230, v195
    v_add_f32 v230, v230, v196
    v_add_f32 v230, v230, v197
    v_add_f32 v230, v230, v198
    v_add_f32 v230, v230, v199
    v_add_f32 v230, v230, v200
    v_add_f32 v230, v230, v201
    v_add_f32 v230, v230, v202
    v_add_f32 v230, v230, v203
    v_add_f32 v230, v230, v204
    v_add_f32 v230, v230, v205
    v_add_f32 v230, v230, v206
    v_add_f32 v230, v230, v207
    v_add_f32 v230, v230, v208
    v_add_f32 v230, v230, v209
    v_add_f32 v230, v230, v210
    v_add_f32 v230, v230, v211
    v_add_f32 v230, v230, v212
    v_add_f32 v230, v230, v213
    v_add_f32 v230, v230, v214
    v_add_f32 v230, v230, v215
    v_add_f32 v230, v230, v216
    v_add_f32 v230, v230, v217
    v_add_f32 v230, v230, v218
    v_add_f32 v230, v230, v219
    v_add_f32 v230, v230, v220
    v_add_f32 v230, v230, v221
    v_add_f32 v230, v230, v222
    v_add_f32 v230, v230, v223
    v_add_f32 v230, v230, v224
    v_add_f32 v230, v230, v225
    v_add_f32 v230, v230, v226
    v_add_f32 v230, v230, v227
    v_add_f32 v230, v230, v228
    v_add_f32 v230, v230, v229
    s_nop 1
    v_add_f32_dpp v230, v230, v230 row_ror:8 row_mask:0xf bank_mask:0xf
    s_nop 1
    v_add_f32_dpp v230, v230, v230 row_ror:4 row_mask:0xf bank_mask:0xf
    s_nop 1
    v_add_f32_dpp v230, v230, v230 row_ror:2 row_mask:0xf bank_mask:0xf
    s_nop 1
    v_add_f32_dpp v230, v230, v230 row_ror:1 row_mask:0xf bank_mask:0xf
    v_mul_f32 v230, 0.0015625, v230
    v_sub_f32 v190, v190, v230
    v_sub_f32 v191, v191, v230
    v_sub_f32 v192, v192, v230
    v_sub_f32 v193, v193, v230
    v_sub_f32 v194, v194, v230
    v_sub_f32 v195, v195, v230
    v_sub_f32 v196, v196, v230
    v_sub_f32 v197, v197, v230
    v_sub_f32 v198, v198, v230
    v_sub_f32 v199, v199, v230
    v_sub_f32 v200, v200, v230
    v_sub_f32 v201, v201, v230
    v_sub_f32 v202, v202, v230
    v_sub_f32 v203, v203, v230
    v_sub_f32 v204, v204, v230
    v_sub_f32 v205, v205, v230
    v_sub_f32 v206, v206, v230
    v_sub_f32 v207, v207, v230
    v_sub_f32 v208, v208, v230
    v_sub_f32 v209, v209, v230
    v_sub_f32 v210, v210, v230
    v_sub_f32 v211, v211, v230
    v_sub_f32 v212, v212, v230
    v_sub_f32 v213, v213, v230
    v_sub_f32 v214, v214, v230
    v_sub_f32 v215, v215, v230
    v_sub_f32 v216, v216, v230
    v_sub_f32 v217, v217, v230
    v_sub_f32 v218, v218, v230
    v_sub_f32 v219, v219, v230
    v_sub_f32 v220, v220, v230
    v_sub_f32 v221, v221, v230
    v_sub_f32 v222, v222, v230
    v_sub_f32 v223, v223, v230
    v_sub_f32 v224, v224, v230
    v_sub_f32 v225, v225, v230
    v_sub_f32 v226, v226, v230
    v_sub_f32 v227, v227, v230
    v_sub_f32 v228, v228, v230
    v_sub_f32 v229, v229, v230
    v_mul_f32 v230, v190, v190
    v_fmac_f32 v230, v191, v191
    v_fmac_f32 v230, v192, v192
    v_fmac_f32 v230, v193, v193
    v_fmac_f32 v230, v194, v194
    v_fmac_f32 v230, v195, v195
    v_fmac_f32 v230, v196, v196
    v_fmac_f32 v230, v197, v197
    v_fmac_f32 v230, v198, v198
    v_fmac_f32 v230, v199, v199
    v_fmac_f32 v230, v200, v200
    v_fmac_f32 v230, v201, v201
    v_fmac_f32 v230, v202, v202
    v_fmac_f32 v230, v203, v203
    v_fmac_f32 v230, v204, v204
    v_fmac_f32 v230, v205, v205
    v_fmac_f32 v230, v206, v206
    v_fmac_f32 v230, v207, v207
    v_fmac_f32 v230, v208, v208
    v_fmac_f32 v230, v209, v209
    v_fmac_f32 v230, v210, v210
    v_fmac_f32 v230, v211, v211
    v_fmac_f32 v230, v212, v212
    v_fmac_f32 v230, v213, v213
    v_fmac_f32 v230, v214, v214
    v_fmac_f32 v230, v215, v215
    v_fmac_f32 v230, v216, v216
    v_fmac_f32 v230, v217, v217
    v_fmac_f32 v230, v218, v218
    v_fmac_f32 v230, v219, v219
    v_fmac_f32 v230, v220, v220
    v_fmac_f32 v230, v221, v221
    v_fmac_f32 v230, v222, v222
    v_fmac_f32 v230, v223, v223
    v_fmac_f32 v230, v224, v224
    v_fmac_f32 v230, v225, v225
    v_fmac_f32 v230, v226, v226
    v_fmac_f32 v230, v227, v227
    v_fmac_f32 v230, v228, v228
    v_fmac_f32 v230, v229, v229
    s_nop 1
    v_add_f32_dpp v230, v230, v230 row_ror:8 row_mask:0xf bank_mask:0xf
    s_nop 1
    v_add_f32_dpp v230, v230, v230 row_ror:4 row_mask:0xf bank_mask:0xf
    s_nop 1
    v_add_f32_dpp v230, v230, v230 row_ror:2 row_mask:0xf bank_mask:0xf
    s_nop 1
    v_add_f32_dpp v230, v230, v230 row_ror:1 row_mask:0xf bank_mask:0xf
    v_mov_b32 v231, 0x3727c5ac
    v_fmac_f32 v231, 0.0015625, v230
    v_rsq_f32 v231, v231
    s_nop 0
    v_mul_f32 v190, v190, v231
    v_mul_f32 v191, v191, v231
    v_mul_f32 v192, v192, v231
    v_mul_f32 v193, v193, v231
    v_mul_f32 v194, v194, v231
    v_mul_f32 v195, v195, v231
    v_mul_f32 v196, v196, v231
    v_mul_f32 v197, v197, v231
    v_mul_f32 v198, v198, v231
    v_mul_f32 v199, v199, v231
    v_mul_f32 v200, v200, v231
    v_mul_f32 v201, v201, v231
    v_mul_f32 v202, v202, v231
    v_mul_f32 v203, v203, v231
    v_mul_f32 v204, v204, v231
    v_mul_f32 v205, v205, v231
    v_mul_f32 v206, v206, v231
    v_mul_f32 v207, v207, v231
    v_mul_f32 v208, v208, v231
    v_mul_f32 v209, v209, v231
    v_mul_f32 v210, v210, v231
    v_mul_f32 v211, v211, v231
    v_mul_f32 v212, v212, v231
    v_mul_f32 v213, v213, v231
    v_mul_f32 v214, v214, v231
    v_mul_f32 v215, v215, v231
    v_mul_f32 v216, v216, v231
    v_mul_f32 v217, v217, v231
    v_mul_f32 v218, v218, v231
    v_mul_f32 v219, v219, v231
    v_mul_f32 v220, v220, v231
    v_mul_f32 v221, v221, v231
    v_mul_f32 v222, v222, v231
    v_mul_f32 v223, v223, v231
    v_mul_f32 v224, v224, v231
    v_mul_f32 v225, v225, v231
    v_mul_f32 v226, v226, v231
    v_mul_f32 v227, v227, v231
    v_mul_f32 v228, v228, v231
    v_mul_f32 v229, v229, v231
    v_and_b32 v3, 15, v1
    v_add_u32 v10, 0, v4
    v_xor_b32 v3, v3, v10
    v_lshl_add_u32 v3, v3, 4, v9
    v_cvt_pk_bf16_f32 v190, v190, v191
    v_cvt_pk_bf16_f32 v191, v192, v193
    v_cvt_pk_bf16_f32 v192, v194, v195
    v_cvt_pk_bf16_f32 v193, v196, v197
    ds_write_b128 v3, v[190:193] offset:0
    v_cvt_pk_bf16_f32 v198, v198, v199
    v_cvt_pk_bf16_f32 v199, v200, v201
    v_cvt_pk_bf16_f32 v200, v202, v203
    v_cvt_pk_bf16_f32 v201, v204, v205
    ds_write_b128 v3, v[198:201] offset:256
    v_cvt_pk_bf16_f32 v206, v206, v207
    v_cvt_pk_bf16_f32 v207, v208, v209
    v_cvt_pk_bf16_f32 v208, v210, v211
    v_cvt_pk_bf16_f32 v209, v212, v213
    ds_write_b128 v3, v[206:209] offset:512
    v_cvt_pk_bf16_f32 v214, v214, v215
    v_cvt_pk_bf16_f32 v215, v216, v217
    v_cvt_pk_bf16_f32 v216, v218, v219
    v_cvt_pk_bf16_f32 v217, v220, v221
    ds_write_b128 v3, v[214:217] offset:768
    v_cvt_pk_bf16_f32 v222, v222, v223
    v_cvt_pk_bf16_f32 v223, v224, v225
    v_cvt_pk_bf16_f32 v224, v226, v227
    v_cvt_pk_bf16_f32 v225, v228, v229
    ds_write_b128 v3, v[222:225] offset:1024
    s_waitcnt vmcnt(0)
    s_waitcnt vmcnt(10)
    v_lshlrev_b32 v190, 16, v130
    v_and_b32 v191, 0xffff0000, v130
    v_lshlrev_b32 v192, 16, v131
    v_and_b32 v193, 0xffff0000, v131
    v_lshlrev_b32 v194, 16, v132
    v_and_b32 v195, 0xffff0000, v132
    v_lshlrev_b32 v196, 16, v133
    v_and_b32 v197, 0xffff0000, v133
    v_lshlrev_b32 v198, 16, v134
    v_and_b32 v199, 0xffff0000, v134
    v_lshlrev_b32 v200, 16, v135
    v_and_b32 v201, 0xffff0000, v135
    v_lshlrev_b32 v202, 16, v136
    v_and_b32 v203, 0xffff0000, v136
    v_lshlrev_b32 v204, 16, v137
    v_and_b32 v205, 0xffff0000, v137
    v_lshlrev_b32 v206, 16, v138
    v_and_b32 v207, 0xffff0000, v138
    v_lshlrev_b32 v208, 16, v139
    v_and_b32 v209, 0xffff0000, v139
    v_lshlrev_b32 v210, 16, v140
    v_and_b32 v211, 0xffff0000, v140
    v_lshlrev_b32 v212, 16, v141
    v_and_b32 v213, 0xffff0000, v141
    v_lshlrev_b32 v214, 16, v142
    v_and_b32 v215, 0xffff0000, v142
    v_lshlrev_b32 v216, 16, v143
    v_and_b32 v217, 0xffff0000, v143
    v_lshlrev_b32 v218, 16, v144
    v_and_b32 v219, 0xffff0000, v144
    v_lshlrev_b32 v220, 16, v145
    v_and_b32 v221, 0xffff0000, v145
    v_lshlrev_b32 v222, 16, v146
    v_and_b32 v223, 0xffff0000, v146
    v_lshlrev_b32 v224, 16, v147
    v_and_b32 v225, 0xffff0000, v147
    v_lshlrev_b32 v226, 16, v148
    v_and_b32 v227, 0xffff0000, v148
    v_lshlrev_b32 v228, 16, v149
    v_and_b32 v229, 0xffff0000, v149
    v_add_f32 v230, v190, v191
    v_add_f32 v230, v230, v192
    v_add_f32 v230, v230, v193
    v_add_f32 v230, v230, v194
    v_add_f32 v230, v230, v195
    v_add_f32 v230, v230, v196
    v_add_f32 v230, v230, v197
    v_add_f32 v230, v230, v198
    v_add_f32 v230, v230, v199
    v_add_f32 v230, v230, v200
    v_add_f32 v230, v230, v201
    v_add_f32 v230, v230, v202
    v_add_f32 v230, v230, v203
    v_add_f32 v230, v230, v204
    v_add_f32 v230, v230, v205
    v_add_f32 v230, v230, v206
    v_add_f32 v230, v230, v207
    v_add_f32 v230, v230, v208
    v_add_f32 v230, v230, v209
    v_add_f32 v230, v230, v210
    v_add_f32 v230, v230, v211
    v_add_f32 v230, v230, v212
    v_add_f32 v230, v230, v213
    v_add_f32 v230, v230, v214
    v_add_f32 v230, v230, v215
    v_add_f32 v230, v230, v216
    v_add_f32 v230, v230, v217
    v_add_f32 v230, v230, v218
    v_add_f32 v230, v230, v219
    v_add_f32 v230, v230, v220
    v_add_f32 v230, v230, v221
    v_add_f32 v230, v230, v222
    v_add_f32 v230, v230, v223
    v_add_f32 v230, v230, v224
    v_add_f32 v230, v230, v225
    v_add_f32 v230, v230, v226
    v_add_f32 v230, v230, v227
    v_add_f32 v230, v230, v228
    v_add_f32 v230, v230, v229
    s_nop 1
    v_add_f32_dpp v230, v230, v230 row_ror:8 row_mask:0xf bank_mask:0xf
    s_nop 1
    v_add_f32_dpp v230, v230, v230 row_ror:4 row_mask:0xf bank_mask:0xf
    s_nop 1
    v_add_f32_dpp v230, v230, v230 row_ror:2 row_mask:0xf bank_mask:0xf
    s_nop 1
    v_add_f32_dpp v230, v230, v230 row_ror:1 row_mask:0xf bank_mask:0xf
    v_mul_f32 v230, 0.0015625, v230
    v_sub_f32 v190, v190, v230
    v_sub_f32 v191, v191, v230
    v_sub_f32 v192, v192, v230
    v_sub_f32 v193, v193, v230
    v_sub_f32 v194, v194, v230
    v_sub_f32 v195, v195, v230
    v_sub_f32 v196, v196, v230
    v_sub_f32 v197, v197, v230
    v_sub_f32 v198, v198, v230
    v_sub_f32 v199, v199, v230
    v_sub_f32 v200, v200, v230
    v_sub_f32 v201, v201, v230
    v_sub_f32 v202, v202, v230
    v_sub_f32 v203, v203, v230
    v_sub_f32 v204, v204, v230
    v_sub_f32 v205, v205, v230
    v_sub_f32 v206, v206, v230
    v_sub_f32 v207, v207, v230
    v_sub_f32 v208, v208, v230
    v_sub_f32 v209, v209, v230
    v_sub_f32 v210, v210, v230
    v_sub_f32 v211, v211, v230
    v_sub_f32 v212, v212, v230
    v_sub_f32 v213, v213, v230
    v_sub_f32 v214, v214, v230
    v_sub_f32 v215, v215, v230
    v_sub_f32 v216, v216, v230
    v_sub_f32 v217, v217, v230
    v_sub_f32 v218, v218, v230
    v_sub_f32 v219, v219, v230
    v_sub_f32 v220, v220, v230
    v_sub_f32 v221, v221, v230
    v_sub_f32 v222, v222, v230
    v_sub_f32 v223, v223, v230
    v_sub_f32 v224, v224, v230
    v_sub_f32 v225, v225, v230
    v_sub_f32 v226, v226, v230
    v_sub_f32 v227, v227, v230
    v_sub_f32 v228, v228, v230
    v_sub_f32 v229, v229, v230
    v_mul_f32 v230, v190, v190
    v_fmac_f32 v230, v191, v191
    v_fmac_f32 v230, v192, v192
    v_fmac_f32 v230, v193, v193
    v_fmac_f32 v230, v194, v194
    v_fmac_f32 v230, v195, v195
    v_fmac_f32 v230, v196, v196
    v_fmac_f32 v230, v197, v197
    v_fmac_f32 v230, v198, v198
    v_fmac_f32 v230, v199, v199
    v_fmac_f32 v230, v200, v200
    v_fmac_f32 v230, v201, v201
    v_fmac_f32 v230, v202, v202
    v_fmac_f32 v230, v203, v203
    v_fmac_f32 v230, v204, v204
    v_fmac_f32 v230, v205, v205
    v_fmac_f32 v230, v206, v206
    v_fmac_f32 v230, v207, v207
    v_fmac_f32 v230, v208, v208
    v_fmac_f32 v230, v209, v209
    v_fmac_f32 v230, v210, v210
    v_fmac_f32 v230, v211, v211
    v_fmac_f32 v230, v212, v212
    v_fmac_f32 v230, v213, v213
    v_fmac_f32 v230, v214, v214
    v_fmac_f32 v230, v215, v215
    v_fmac_f32 v230, v216, v216
    v_fmac_f32 v230, v217, v217
    v_fmac_f32 v230, v218, v218
    v_fmac_f32 v230, v219, v219
    v_fmac_f32 v230, v220, v220
    v_fmac_f32 v230, v221, v221
    v_fmac_f32 v230, v222, v222
    v_fmac_f32 v230, v223, v223
    v_fmac_f32 v230, v224, v224
    v_fmac_f32 v230, v225, v225
    v_fmac_f32 v230, v226, v226
    v_fmac_f32 v230, v227, v227
    v_fmac_f32 v230, v228, v228
    v_fmac_f32 v230, v229, v229
    s_nop 1
    v_add_f32_dpp v230, v230, v230 row_ror:8 row_mask:0xf bank_mask:0xf
    s_nop 1
    v_add_f32_dpp v230, v230, v230 row_ror:4 row_mask:0xf bank_mask:0xf
    s_nop 1
    v_add_f32_dpp v230, v230, v230 row_ror:2 row_mask:0xf bank_mask:0xf
    s_nop 1
    v_add_f32_dpp v230, v230, v230 row_ror:1 row_mask:0xf bank_mask:0xf
    v_mov_b32 v231, 0x3727c5ac
    v_fmac_f32 v231, 0.0015625, v230
    v_rsq_f32 v231, v231
    s_nop 0
    v_mul_f32 v190, v190, v231
    v_mul_f32 v191, v191, v231
    v_mul_f32 v192, v192, v231
    v_mul_f32 v193, v193, v231
    v_mul_f32 v194, v194, v231
    v_mul_f32 v195, v195, v231
    v_mul_f32 v196, v196, v231
    v_mul_f32 v197, v197, v231
    v_mul_f32 v198, v198, v231
    v_mul_f32 v199, v199, v231
    v_mul_f32 v200, v200, v231
    v_mul_f32 v201, v201, v231
    v_mul_f32 v202, v202, v231
    v_mul_f32 v203, v203, v231
    v_mul_f32 v204, v204, v231
    v_mul_f32 v205, v205, v231
    v_mul_f32 v206, v206, v231
    v_mul_f32 v207, v207, v231
    v_mul_f32 v208, v208, v231
    v_mul_f32 v209, v209, v231
    v_mul_f32 v210, v210, v231
    v_mul_f32 v211, v211, v231
    v_mul_f32 v212, v212, v231
    v_mul_f32 v213, v213, v231
    v_mul_f32 v214, v214, v231
    v_mul_f32 v215, v215, v231
    v_mul_f32 v216, v216, v231
    v_mul_f32 v217, v217, v231
    v_mul_f32 v218, v218, v231
    v_mul_f32 v219, v219, v231
    v_mul_f32 v220, v220, v231
    v_mul_f32 v221, v221, v231
    v_mul_f32 v222, v222, v231
    v_mul_f32 v223, v223, v231
    v_mul_f32 v224, v224, v231
    v_mul_f32 v225, v225, v231
    v_mul_f32 v226, v226, v231
    v_mul_f32 v227, v227, v231
    v_mul_f32 v228, v228, v231
    v_mul_f32 v229, v229, v231
    v_cvt_pk_bf16_f32 v130, v190, v191
    v_cvt_pk_bf16_f32 v131, v192, v193
    v_cvt_pk_bf16_f32 v132, v194, v195
    v_cvt_pk_bf16_f32 v133, v196, v197
    v_cvt_pk_bf16_f32 v134, v198, v199
    v_cvt_pk_bf16_f32 v135, v200, v201
    v_cvt_pk_bf16_f32 v136, v202, v203
    v_cvt_pk_bf16_f32 v137, v204, v205
    v_cvt_pk_bf16_f32 v138, v206, v207
    v_cvt_pk_bf16_f32 v139, v208, v209
    v_cvt_pk_bf16_f32 v140, v210, v211
    v_cvt_pk_bf16_f32 v141, v212, v213
    v_cvt_pk_bf16_f32 v142, v214, v215
    v_cvt_pk_bf16_f32 v143, v216, v217
    v_cvt_pk_bf16_f32 v144, v218, v219
    v_cvt_pk_bf16_f32 v145, v220, v221
    v_cvt_pk_bf16_f32 v146, v222, v223
    v_cvt_pk_bf16_f32 v147, v224, v225
    v_cvt_pk_bf16_f32 v148, v226, v227
    v_cvt_pk_bf16_f32 v149, v228, v229
    s_cmp_lg_u32 s31, 0
    s_cbranch_scc1 mix1_nw1
    s_mov_b32 s34, 14095360
    buffer_store_dwordx4 v[130:133], v8, s[8:11], s34 offen
    s_mov_b32 s34, 14095616
    buffer_store_dwordx4 v[134:137], v8, s[8:11], s34 offen
    s_mov_b32 s34, 14095872
    buffer_store_dwordx4 v[138:141], v8, s[8:11], s34 offen
    s_mov_b32 s34, 14096128
    buffer_store_dwordx4 v[142:145], v8, s[8:11], s34 offen
    s_mov_b32 s34, 14096384
    buffer_store_dwordx4 v[146:149], v8, s[8:11], s34 offen
mix1_nw1:
    v_lshlrev_b32 v190, 16, v130
    v_and_b32 v191, 0xffff0000, v130
    v_lshlrev_b32 v192, 16, v131
    v_and_b32 v193, 0xffff0000, v131
    v_lshlrev_b32 v194, 16, v132
    v_and_b32 v195, 0xffff0000, v132
    v_lshlrev_b32 v196, 16, v133
    v_and_b32 v197, 0xffff0000, v133
    v_lshlrev_b32 v198, 16, v134
    v_and_b32 v199, 0xffff0000, v134
    v_lshlrev_b32 v200, 16, v135
    v_and_b32 v201, 0xffff0000, v135
    v_lshlrev_b32 v202, 16, v136
    v_and_b32 v203, 0xffff0000, v136
    v_lshlrev_b32 v204, 16, v137
    v_and_b32 v205, 0xffff0000, v137
    v_lshlrev_b32 v206, 16, v138
    v_and_b32 v207, 0xffff0000, v138
    v_lshlrev_b32 v208, 16, v139
    v_and_b32 v209, 0xffff0000, v139
    v_lshlrev_b32 v210, 16, v140
    v_and_b32 v211, 0xffff0000, v140
    v_lshlrev_b32 v212, 16, v141
    v_and_b32 v213, 0xffff0000, v141
    v_lshlrev_b32 v214, 16, v142
    v_and_b32 v215, 0xffff0000, v142
    v_lshlrev_b32 v216, 16, v143
    v_and_b32 v217, 0xffff0000, v143
    v_lshlrev_b32 v218, 16, v144
    v_and_b32 v219, 0xffff0000, v144
    v_lshlrev_b32 v220, 16, v145
    v_and_b32 v221, 0xffff0000, v145
    v_lshlrev_b32 v222, 16, v146
    v_and_b32 v223, 0xffff0000, v146
    v_lshlrev_b32 v224, 16, v147
    v_and_b32 v225, 0xffff0000, v147
    v_lshlrev_b32 v226, 16, v148
    v_and_b32 v227, 0xffff0000, v148
    v_lshlrev_b32 v228, 16, v149
    v_and_b32 v229, 0xffff0000, v149
    v_add_f32 v230, v190, v191
    v_add_f32 v230, v230, v192
    v_add_f32 v230, v230, v193
    v_add_f32 v230, v230, v194
    v_add_f32 v230, v230, v195
    v_add_f32 v230, v230, v196
    v_add_f32 v230, v230, v197
    v_add_f32 v230, v230, v198
    v_add_f32 v230, v230, v199
    v_add_f32 v230, v230, v200
    v_add_f32 v230, v230, v201
    v_add_f32 v230, v230, v202
    v_add_f32 v230, v230, v203
    v_add_f32 v230, v230, v204
    v_add_f32 v230, v230, v205
    v_add_f32 v230, v230, v206
    v_add_f32 v230, v230, v207
    v_add_f32 v230, v230, v208
    v_add_f32 v230, v230, v209
    v_add_f32 v230, v230, v210
    v_add_f32 v230, v230, v211
    v_add_f32 v230, v230, v212
    v_add_f32 v230, v230, v213
    v_add_f32 v230, v230, v214
    v_add_f32 v230, v230, v215
    v_add_f32 v230, v230, v216
    v_add_f32 v230, v230, v217
    v_add_f32 v230, v230, v218
    v_add_f32 v230, v230, v219
    v_add_f32 v230, v230, v220
    v_add_f32 v230, v230, v221
    v_add_f32 v230, v230, v222
    v_add_f32 v230, v230, v223
    v_add_f32 v230, v230, v224
    v_add_f32 v230, v230, v225
    v_add_f32 v230, v230, v226
    v_add_f32 v230, v230, v227
    v_add_f32 v230, v230, v228
    v_add_f32 v230, v230, v229
    s_nop 1
    v_add_f32_dpp v230, v230, v230 row_ror:8 row_mask:0xf bank_mask:0xf
    s_nop 1
    v_add_f32_dpp v230, v230, v230 row_ror:4 row_mask:0xf bank_mask:0xf
    s_nop 1
    v_add_f32_dpp v230, v230, v230 row_ror:2 row_mask:0xf bank_mask:0xf
    s_nop 1
    v_add_f32_dpp v230, v230, v230 row_ror:1 row_mask:0xf bank_mask:0xf
    v_mul_f32 v230, 0.0015625, v230
    v_sub_f32 v190, v190, v230
    v_sub_f32 v191, v191, v230
    v_sub_f32 v192, v192, v230
    v_sub_f32 v193, v193, v230
    v_sub_f32 v194, v194, v230
    v_sub_f32 v195, v195, v230
    v_sub_f32 v196, v196, v230
    v_sub_f32 v197, v197, v230
    v_sub_f32 v198, v198, v230
    v_sub_f32 v199, v199, v230
    v_sub_f32 v200, v200, v230
    v_sub_f32 v201, v201, v230
    v_sub_f32 v202, v202, v230
    v_sub_f32 v203, v203, v230
    v_sub_f32 v204, v204, v230
    v_sub_f32 v205, v205, v230
    v_sub_f32 v206, v206, v230
    v_sub_f32 v207, v207, v230
    v_sub_f32 v208, v208, v230
    v_sub_f32 v209, v209, v230
    v_sub_f32 v210, v210, v230
    v_sub_f32 v211, v211, v230
    v_sub_f32 v212, v212, v230
    v_sub_f32 v213, v213, v230
    v_sub_f32 v214, v214, v230
    v_sub_f32 v215, v215, v230
    v_sub_f32 v216, v216, v230
    v_sub_f32 v217, v217, v230
    v_sub_f32 v218, v218, v230
    v_sub_f32 v219, v219, v230
    v_sub_f32 v220, v220, v230
    v_sub_f32 v221, v221, v230
    v_sub_f32 v222, v222, v230
    v_sub_f32 v223, v223, v230
    v_sub_f32 v224, v224, v230
    v_sub_f32 v225, v225, v230
    v_sub_f32 v226, v226, v230
    v_sub_f32 v227, v227, v230
    v_sub_f32 v228, v228, v230
    v_sub_f32 v229, v229, v230
    v_mul_f32 v230, v190, v190
    v_fmac_f32 v230, v191, v191
    v_fmac_f32 v230, v192, v192
    v_fmac_f32 v230, v193, v193
    v_fmac_f32 v230, v194, v194
    v_fmac_f32 v230, v195, v195
    v_fmac_f32 v230, v196, v196
    v_fmac_f32 v230, v197, v197
    v_fmac_f32 v230, v198, v198
    v_fmac_f32 v230, v199, v199
    v_fmac_f32 v230, v200, v200
    v_fmac_f32 v230, v201, v201
    v_fmac_f32 v230, v202, v202
    v_fmac_f32 v230, v203, v203
    v_fmac_f32 v230, v204, v204
    v_fmac_f32 v230, v205, v205
    v_fmac_f32 v230, v206, v206
    v_fmac_f32 v230, v207, v207
    v_fmac_f32 v230, v208, v208
    v_fmac_f32 v230, v209, v209
    v_fmac_f32 v230, v210, v210
    v_fmac_f32 v230, v211, v211
    v_fmac_f32 v230, v212, v212
    v_fmac_f32 v230, v213, v213
    v_fmac_f32 v230, v214, v214
    v_fmac_f32 v230, v215, v215
    v_fmac_f32 v230, v216, v216
    v_fmac_f32 v230, v217, v217
    v_fmac_f32 v230, v218, v218
    v_fmac_f32 v230, v219, v219
    v_fmac_f32 v230, v220, v220
    v_fmac_f32 v230, v221, v221
    v_fmac_f32 v230, v222, v222
    v_fmac_f32 v230, v223, v223
    v_fmac_f32 v230, v224, v224
    v_fmac_f32 v230, v225, v225
    v_fmac_f32 v230, v226, v226
    v_fmac_f32 v230, v227, v227
    v_fmac_f32 v230, v228, v228
    v_fmac_f32 v230, v229, v229
    s_nop 1
    v_add_f32_dpp v230, v230, v230 row_ror:8 row_mask:0xf bank_mask:0xf
    s_nop 1
    v_add_f32_dpp v230, v230, v230 row_ror:4 row_mask:0xf bank_mask:0xf
    s_nop 1
    v_add_f32_dpp v230, v230, v230 row_ror:2 row_mask:0xf bank_mask:0xf
    s_nop 1
    v_add_f32_dpp v230, v230, v230 row_ror:1 row_mask:0xf bank_mask:0xf
    v_mov_b32 v231, 0x3727c5ac
    v_fmac_f32 v231, 0.0015625, v230
    v_rsq_f32 v231, v231
    s_nop 0
    v_mul_f32 v190, v190, v231
    v_mul_f32 v191, v191, v231
    v_mul_f32 v192, v192, v231
    v_mul_f32 v193, v193, v231
    v_mul_f32 v194, v194, v231
    v_mul_f32 v195, v195, v231
    v_mul_f32 v196, v196, v231
    v_mul_f32 v197, v197, v231
    v_mul_f32 v198, v198, v231
    v_mul_f32 v199, v199, v231
    v_mul_f32 v200, v200, v231
    v_mul_f32 v201, v201, v231
    v_mul_f32 v202, v202, v231
    v_mul_f32 v203, v203, v231
    v_mul_f32 v204, v204, v231
    v_mul_f32 v205, v205, v231
    v_mul_f32 v206, v206, v231
    v_mul_f32 v207, v207, v231
    v_mul_f32 v208, v208, v231
    v_mul_f32 v209, v209, v231
    v_mul_f32 v210, v210, v231
    v_mul_f32 v211, v211, v231
    v_mul_f32 v212, v212, v231
    v_mul_f32 v213, v213, v231
    v_mul_f32 v214, v214, v231
    v_mul_f32 v215, v215, v231
    v_mul_f32 v216, v216, v231
    v_mul_f32 v217, v217, v231
    v_mul_f32 v218, v218, v231
    v_mul_f32 v219, v219, v231
    v_mul_f32 v220, v220, v231
    v_mul_f32 v221, v221, v231
    v_mul_f32 v222, v222, v231
    v_mul_f32 v223, v223, v231
    v_mul_f32 v224, v224, v231
    v_mul_f32 v225, v225, v231
    v_mul_f32 v226, v226, v231
    v_mul_f32 v227, v227, v231
    v_mul_f32 v228, v228, v231
    v_mul_f32 v229, v229, v231
    v_and_b32 v3, 15, v1
    v_add_u32 v10, 4, v4
    v_xor_b32 v3, v3, v10
    v_lshl_add_u32 v3, v3, 4, v9
    v_cvt_pk_bf16_f32 v190, v190, v191
    v_cvt_pk_bf16_f32 v191, v192, v193
    v_cvt_pk_bf16_f32 v192, v194, v195
    v_cvt_pk_bf16_f32 v193, v196, v197
    ds_write_b128 v3, v[190:193] offset:5120
    v_cvt_pk_bf16_f32 v198, v198, v199
    v_cvt_pk_bf16_f32 v199, v200, v201
    v_cvt_pk_bf16_f32 v200, v202, v203
    v_cvt_pk_bf16_f32 v201, v204, v205
    ds_write_b128 v3, v[198:201] offset:5376
    v_cvt_pk_bf16_f32 v206, v206, v207
    v_cvt_pk_bf16_f32 v207, v208, v209
    v_cvt_pk_bf16_f32 v208, v210, v211
    v_cvt_pk_bf16_f32 v209, v212, v213
    ds_write_b128 v3, v[206:209] offset:5632
    v_cvt_pk_bf16_f32 v214, v214, v215
    v_cvt_pk_bf16_f32 v215, v216, v217
    v_cvt_pk_bf16_f32 v216, v218, v219
    v_cvt_pk_bf16_f32 v217, v220, v221
    ds_write_b128 v3, v[214:217] offset:5888
    v_cvt_pk_bf16_f32 v222, v222, v223
    v_cvt_pk_bf16_f32 v223, v224, v225
    v_cvt_pk_bf16_f32 v224, v226, v227
    v_cvt_pk_bf16_f32 v225, v228, v229
    ds_write_b128 v3, v[222:225] offset:6144
    s_waitcnt vmcnt(0)
    s_waitcnt vmcnt(5)
    v_lshlrev_b32 v190, 16, v150
    v_and_b32 v191, 0xffff0000, v150
    v_lshlrev_b32 v192, 16, v151
    v_and_b32 v193, 0xffff0000, v151
    v_lshlrev_b32 v194, 16, v152
    v_and_b32 v195, 0xffff0000, v152
    v_lshlrev_b32 v196, 16, v153
    v_and_b32 v197, 0xffff0000, v153
    v_lshlrev_b32 v198, 16, v154
    v_and_b32 v199, 0xffff0000, v154
    v_lshlrev_b32 v200, 16, v155
    v_and_b32 v201, 0xffff0000, v155
    v_lshlrev_b32 v202, 16, v156
    v_and_b32 v203, 0xffff0000, v156
    v_lshlrev_b32 v204, 16, v157
    v_and_b32 v205, 0xffff0000, v157
    v_lshlrev_b32 v206, 16, v158
    v_and_b32 v207, 0xffff0000, v158
    v_lshlrev_b32 v208, 16, v159
    v_and_b32 v209, 0xffff0000, v159
    v_lshlrev_b32 v210, 16, v160
    v_and_b32 v211, 0xffff0000, v160
    v_lshlrev_b32 v212, 16, v161
    v_and_b32 v213, 0xffff0000, v161
    v_lshlrev_b32 v214, 16, v162
    v_and_b32 v215, 0xffff0000, v162
    v_lshlrev_b32 v216, 16, v163
    v_and_b32 v217, 0xffff0000, v163
    v_lshlrev_b32 v218, 16, v164
    v_and_b32 v219, 0xffff0000, v164
    v_lshlrev_b32 v220, 16, v165
    v_and_b32 v221, 0xffff0000, v165
    v_lshlrev_b32 v222, 16, v166
    v_and_b32 v223, 0xffff0000, v166
    v_lshlrev_b32 v224, 16, v167
    v_and_b32 v225, 0xffff0000, v167
    v_lshlrev_b32 v226, 16, v168
    v_and_b32 v227, 0xffff0000, v168
    v_lshlrev_b32 v228, 16, v169
    v_and_b32 v229, 0xffff0000, v169
    v_add_f32 v230, v190, v191
    v_add_f32 v230, v230, v192
    v_add_f32 v230, v230, v193
    v_add_f32 v230, v230, v194
    v_add_f32 v230, v230, v195
    v_add_f32 v230, v230, v196
    v_add_f32 v230, v230, v197
    v_add_f32 v230, v230, v198
    v_add_f32 v230, v230, v199
    v_add_f32 v230, v230, v200
    v_add_f32 v230, v230, v201
    v_add_f32 v230, v230, v202
    v_add_f32 v230, v230, v203
    v_add_f32 v230, v230, v204
    v_add_f32 v230, v230, v205
    v_add_f32 v230, v230, v206
    v_add_f32 v230, v230, v207
    v_add_f32 v230, v230, v208
    v_add_f32 v230, v230, v209
    v_add_f32 v230, v230, v210
    v_add_f32 v230, v230, v211
    v_add_f32 v230, v230, v212
    v_add_f32 v230, v230, v213
    v_add_f32 v230, v230, v214
    v_add_f32 v230, v230, v215
    v_add_f32 v230, v230, v216
    v_add_f32 v230, v230, v217
    v_add_f32 v230, v230, v218
    v_add_f32 v230, v230, v219
    v_add_f32 v230, v230, v220
    v_add_f32 v230, v230, v221
    v_add_f32 v230, v230, v222
    v_add_f32 v230, v230, v223
    v_add_f32 v230, v230, v224
    v_add_f32 v230, v230, v225
    v_add_f32 v230, v230, v226
    v_add_f32 v230, v230, v227
    v_add_f32 v230, v230, v228
    v_add_f32 v230, v230, v229
    s_nop 1
    v_add_f32_dpp v230, v230, v230 row_ror:8 row_mask:0xf bank_mask:0xf
    s_nop 1
    v_add_f32_dpp v230, v230, v230 row_ror:4 row_mask:0xf bank_mask:0xf
    s_nop 1
    v_add_f32_dpp v230, v230, v230 row_ror:2 row_mask:0xf bank_mask:0xf
    s_nop 1
    v_add_f32_dpp v230, v230, v230 row_ror:1 row_mask:0xf bank_mask:0xf
    v_mul_f32 v230, 0.0015625, v230
    v_sub_f32 v190, v190, v230
    v_sub_f32 v191, v191, v230
    v_sub_f32 v192, v192, v230
    v_sub_f32 v193, v193, v230
    v_sub_f32 v194, v194, v230
    v_sub_f32 v195, v195, v230
    v_sub_f32 v196, v196, v230
    v_sub_f32 v197, v197, v230
    v_sub_f32 v198, v198, v230
    v_sub_f32 v199, v199, v230
    v_sub_f32 v200, v200, v230
    v_sub_f32 v201, v201, v230
    v_sub_f32 v202, v202, v230
    v_sub_f32 v203, v203, v230
    v_sub_f32 v204, v204, v230
    v_sub_f32 v205, v205, v230
    v_sub_f32 v206, v206, v230
    v_sub_f32 v207, v207, v230
    v_sub_f32 v208, v208, v230
    v_sub_f32 v209, v209, v230
    v_sub_f32 v210, v210, v230
    v_sub_f32 v211, v211, v230
    v_sub_f32 v212, v212, v230
    v_sub_f32 v213, v213, v230
    v_sub_f32 v214, v214, v230
    v_sub_f32 v215, v215, v230
    v_sub_f32 v216, v216, v230
    v_sub_f32 v217, v217, v230
    v_sub_f32 v218, v218, v230
    v_sub_f32 v219, v219, v230
    v_sub_f32 v220, v220, v230
    v_sub_f32 v221, v221, v230
    v_sub_f32 v222, v222, v230
    v_sub_f32 v223, v223, v230
    v_sub_f32 v224, v224, v230
    v_sub_f32 v225, v225, v230
    v_sub_f32 v226, v226, v230
    v_sub_f32 v227, v227, v230
    v_sub_f32 v228, v228, v230
    v_sub_f32 v229, v229, v230
    v_mul_f32 v230, v190, v190
    v_fmac_f32 v230, v191, v191
    v_fmac_f32 v230, v192, v192
    v_fmac_f32 v230, v193, v193
    v_fmac_f32 v230, v194, v194
    v_fmac_f32 v230, v195, v195
    v_fmac_f32 v230, v196, v196
    v_fmac_f32 v230, v197, v197
    v_fmac_f32 v230, v198, v198
    v_fmac_f32 v230, v199, v199
    v_fmac_f32 v230, v200, v200
    v_fmac_f32 v230, v201, v201
    v_fmac_f32 v230, v202, v202
    v_fmac_f32 v230, v203, v203
    v_fmac_f32 v230, v204, v204
    v_fmac_f32 v230, v205, v205
    v_fmac_f32 v230, v206, v206
    v_fmac_f32 v230, v207, v207
    v_fmac_f32 v230, v208, v208
    v_fmac_f32 v230, v209, v209
    v_fmac_f32 v230, v210, v210
    v_fmac_f32 v230, v211, v211
    v_fmac_f32 v230, v212, v212
    v_fmac_f32 v230, v213, v213
    v_fmac_f32 v230, v214, v214
    v_fmac_f32 v230, v215, v215
    v_fmac_f32 v230, v216, v216
    v_fmac_f32 v230, v217, v217
    v_fmac_f32 v230, v218, v218
    v_fmac_f32 v230, v219, v219
    v_fmac_f32 v230, v220, v220
    v_fmac_f32 v230, v221, v221
    v_fmac_f32 v230, v222, v222
    v_fmac_f32 v230, v223, v223
    v_fmac_f32 v230, v224, v224
    v_fmac_f32 v230, v225, v225
    v_fmac_f32 v230, v226, v226
    v_fmac_f32 v230, v227, v227
    v_fmac_f32 v230, v228, v228
    v_fmac_f32 v230, v229, v229
    s_nop 1
    v_add_f32_dpp v230, v230, v230 row_ror:8 row_mask:0xf bank_mask:0xf
    s_nop 1
    v_add_f32_dpp v230, v230, v230 row_ror:4 row_mask:0xf bank_mask:0xf
    s_nop 1
    v_add_f32_dpp v230, v230, v230 row_ror:2 row_mask:0xf bank_mask:0xf
    s_nop 1
    v_add_f32_dpp v230, v230, v230 row_ror:1 row_mask:0xf bank_mask:0xf
    v_mov_b32 v231, 0x3727c5ac
    v_fmac_f32 v231, 0.0015625, v230
    v_rsq_f32 v231, v231
    s_nop 0
    v_mul_f32 v190, v190, v231
    v_mul_f32 v191, v191, v231
    v_mul_f32 v192, v192, v231
    v_mul_f32 v193, v193, v231
    v_mul_f32 v194, v194, v231
    v_mul_f32 v195, v195, v231
    v_mul_f32 v196, v196, v231
    v_mul_f32 v197, v197, v231
    v_mul_f32 v198, v198, v231
    v_mul_f32 v199, v199, v231
    v_mul_f32 v200, v200, v231
    v_mul_f32 v201, v201, v231
    v_mul_f32 v202, v202, v231
    v_mul_f32 v203, v203, v231
    v_mul_f32 v204, v204, v231
    v_mul_f32 v205, v205, v231
    v_mul_f32 v206, v206, v231
    v_mul_f32 v207, v207, v231
    v_mul_f32 v208, v208, v231
    v_mul_f32 v209, v209, v231
    v_mul_f32 v210, v210, v231
    v_mul_f32 v211, v211, v231
    v_mul_f32 v212, v212, v231
    v_mul_f32 v213, v213, v231
    v_mul_f32 v214, v214, v231
    v_mul_f32 v215, v215, v231
    v_mul_f32 v216, v216, v231
    v_mul_f32 v217, v217, v231
    v_mul_f32 v218, v218, v231
    v_mul_f32 v219, v219, v231
    v_mul_f32 v220, v220, v231
    v_mul_f32 v221, v221, v231
    v_mul_f32 v222, v222, v231
    v_mul_f32 v223, v223, v231
    v_mul_f32 v224, v224, v231
    v_mul_f32 v225, v225, v231
    v_mul_f32 v226, v226, v231
    v_mul_f32 v227, v227, v231
    v_mul_f32 v228, v228, v231
    v_mul_f32 v229, v229, v231
    v_cvt_pk_bf16_f32 v150, v190, v191
    v_cvt_pk_bf16_f32 v151, v192, v193
    v_cvt_pk_bf16_f32 v152, v194, v195
    v_cvt_pk_bf16_f32 v153, v196, v197
    v_cvt_pk_bf16_f32 v154, v198, v199
    v_cvt_pk_bf16_f32 v155, v200, v201
    v_cvt_pk_bf16_f32 v156, v202, v203
    v_cvt_pk_bf16_f32 v157, v204, v205
    v_cvt_pk_bf16_f32 v158, v206, v207
    v_cvt_pk_bf16_f32 v159, v208, v209
    v_cvt_pk_bf16_f32 v160, v210, v211
    v_cvt_pk_bf16_f32 v161, v212, v213
    v_cvt_pk_bf16_f32 v162, v214, v215
    v_cvt_pk_bf16_f32 v163, v216, v217
    v_cvt_pk_bf16_f32 v164, v218, v219
    v_cvt_pk_bf16_f32 v165, v220, v221
    v_cvt_pk_bf16_f32 v166, v222, v223
    v_cvt_pk_bf16_f32 v167, v224, v225
    v_cvt_pk_bf16_f32 v168, v226, v227
    v_cvt_pk_bf16_f32 v169, v228, v229
    s_cmp_lg_u32 s31, 0
    s_cbranch_scc1 mix1_nw2
    s_mov_b32 s34, 14100480
    buffer_store_dwordx4 v[150:153], v8, s[8:11], s34 offen
    s_mov_b32 s34, 14100736
    buffer_store_dwordx4 v[154:157], v8, s[8:11], s34 offen
    s_mov_b32 s34, 14100992
    buffer_store_dwordx4 v[158:161], v8, s[8:11], s34 offen
    s_mov_b32 s34, 14101248
    buffer_store_dwordx4 v[162:165], v8, s[8:11], s34 offen
    s_mov_b32 s34, 14101504
    buffer_store_dwordx4 v[166:169], v8, s[8:11], s34 offen
mix1_nw2:
    v_lshlrev_b32 v190, 16, v150
    v_and_b32 v191, 0xffff0000, v150
    v_lshlrev_b32 v192, 16, v151
    v_and_b32 v193, 0xffff0000, v151
    v_lshlrev_b32 v194, 16, v152
    v_and_b32 v195, 0xffff0000, v152
    v_lshlrev_b32 v196, 16, v153
    v_and_b32 v197, 0xffff0000, v153
    v_lshlrev_b32 v198, 16, v154
    v_and_b32 v199, 0xffff0000, v154
    v_lshlrev_b32 v200, 16, v155
    v_and_b32 v201, 0xffff0000, v155
    v_lshlrev_b32 v202, 16, v156
    v_and_b32 v203, 0xffff0000, v156
    v_lshlrev_b32 v204, 16, v157
    v_and_b32 v205, 0xffff0000, v157
    v_lshlrev_b32 v206, 16, v158
    v_and_b32 v207, 0xffff0000, v158
    v_lshlrev_b32 v208, 16, v159
    v_and_b32 v209, 0xffff0000, v159
    v_lshlrev_b32 v210, 16, v160
    v_and_b32 v211, 0xffff0000, v160
    v_lshlrev_b32 v212, 16, v161
    v_and_b32 v213, 0xffff0000, v161
    v_lshlrev_b32 v214, 16, v162
    v_and_b32 v215, 0xffff0000, v162
    v_lshlrev_b32 v216, 16, v163
    v_and_b32 v217, 0xffff0000, v163
    v_lshlrev_b32 v218, 16, v164
    v_and_b32 v219, 0xffff0000, v164
    v_lshlrev_b32 v220, 16, v165
    v_and_b32 v221, 0xffff0000, v165
    v_lshlrev_b32 v222, 16, v166
    v_and_b32 v223, 0xffff0000, v166
    v_lshlrev_b32 v224, 16, v167
    v_and_b32 v225, 0xffff0000, v167
    v_lshlrev_b32 v226, 16, v168
    v_and_b32 v227, 0xffff0000, v168
    v_lshlrev_b32 v228, 16, v169
    v_and_b32 v229, 0xffff0000, v169
    v_add_f32 v230, v190, v191
    v_add_f32 v230, v230, v192
    v_add_f32 v230, v230, v193
    v_add_f32 v230, v230, v194
    v_add_f32 v230, v230, v195
    v_add_f32 v230, v230, v196
    v_add_f32 v230, v230, v197
    v_add_f32 v230, v230, v198
    v_add_f32 v230, v230, v199
    v_add_f32 v230, v230, v200
    v_add_f32 v230, v230, v201
    v_add_f32 v230, v230, v202
    v_add_f32 v230, v230, v203
    v_add_f32 v230, v230, v204
    v_add_f32 v230, v230, v205
    v_add_f32 v230, v230, v206
    v_add_f32 v230, v230, v207
    v_add_f32 v230, v230, v208
    v_add_f32 v230, v230, v209
    v_add_f32 v230, v230, v210
    v_add_f32 v230, v230, v211
    v_add_f32 v230, v230, v212
    v_add_f32 v230, v230, v213
    v_add_f32 v230, v230, v214
    v_add_f32 v230, v230, v215
    v_add_f32 v230, v230, v216
    v_add_f32 v230, v230, v217
    v_add_f32 v230, v230, v218
    v_add_f32 v230, v230, v219
    v_add_f32 v230, v230, v220
    v_add_f32 v230, v230, v221
    v_add_f32 v230, v230, v222
    v_add_f32 v230, v230, v223
    v_add_f32 v230, v230, v224
    v_add_f32 v230, v230, v225
    v_add_f32 v230, v230, v226
    v_add_f32 v230, v230, v227
    v_add_f32 v230, v230, v228
    v_add_f32 v230, v230, v229
    s_nop 1
    v_add_f32_dpp v230, v230, v230 row_ror:8 row_mask:0xf bank_mask:0xf
    s_nop 1
    v_add_f32_dpp v230, v230, v230 row_ror:4 row_mask:0xf bank_mask:0xf
    s_nop 1
    v_add_f32_dpp v230, v230, v230 row_ror:2 row_mask:0xf bank_mask:0xf
    s_nop 1
    v_add_f32_dpp v230, v230, v230 row_ror:1 row_mask:0xf bank_mask:0xf
    v_mul_f32 v230, 0.0015625, v230
    v_sub_f32 v190, v190, v230
    v_sub_f32 v191, v191, v230
    v_sub_f32 v192, v192, v230
    v_sub_f32 v193, v193, v230
    v_sub_f32 v194, v194, v230
    v_sub_f32 v195, v195, v230
    v_sub_f32 v196, v196, v230
    v_sub_f32 v197, v197, v230
    v_sub_f32 v198, v198, v230
    v_sub_f32 v199, v199, v230
    v_sub_f32 v200, v200, v230
    v_sub_f32 v201, v201, v230
    v_sub_f32 v202, v202, v230
    v_sub_f32 v203, v203, v230
    v_sub_f32 v204, v204, v230
    v_sub_f32 v205, v205, v230
    v_sub_f32 v206, v206, v230
    v_sub_f32 v207, v207, v230
    v_sub_f32 v208, v208, v230
    v_sub_f32 v209, v209, v230
    v_sub_f32 v210, v210, v230
    v_sub_f32 v211, v211, v230
    v_sub_f32 v212, v212, v230
    v_sub_f32 v213, v213, v230
    v_sub_f32 v214, v214, v230
    v_sub_f32 v215, v215, v230
    v_sub_f32 v216, v216, v230
    v_sub_f32 v217, v217, v230
    v_sub_f32 v218, v218, v230
    v_sub_f32 v219, v219, v230
    v_sub_f32 v220, v220, v230
    v_sub_f32 v221, v221, v230
    v_sub_f32 v222, v222, v230
    v_sub_f32 v223, v223, v230
    v_sub_f32 v224, v224, v230
    v_sub_f32 v225, v225, v230
    v_sub_f32 v226, v226, v230
    v_sub_f32 v227, v227, v230
    v_sub_f32 v228, v228, v230
    v_sub_f32 v229, v229, v230
    v_mul_f32 v230, v190, v190
    v_fmac_f32 v230, v191, v191
    v_fmac_f32 v230, v192, v192
    v_fmac_f32 v230, v193, v193
    v_fmac_f32 v230, v194, v194
    v_fmac_f32 v230, v195, v195
    v_fmac_f32 v230, v196, v196
    v_fmac_f32 v230, v197, v197
    v_fmac_f32 v230, v198, v198
    v_fmac_f32 v230, v199, v199
    v_fmac_f32 v230, v200, v200
    v_fmac_f32 v230, v201, v201
    v_fmac_f32 v230, v202, v202
    v_fmac_f32 v230, v203, v203
    v_fmac_f32 v230, v204, v204
    v_fmac_f32 v230, v205, v205
    v_fmac_f32 v230, v206, v206
    v_fmac_f32 v230, v207, v207
    v_fmac_f32 v230, v208, v208
    v_fmac_f32 v230, v209, v209
    v_fmac_f32 v230, v210, v210
    v_fmac_f32 v230, v211, v211
    v_fmac_f32 v230, v212, v212
    v_fmac_f32 v230, v213, v213
    v_fmac_f32 v230, v214, v214
    v_fmac_f32 v230, v215, v215
    v_fmac_f32 v230, v216, v216
    v_fmac_f32 v230, v217, v217
    v_fmac_f32 v230, v218, v218
    v_fmac_f32 v230, v219, v219
    v_fmac_f32 v230, v220, v220
    v_fmac_f32 v230, v221, v221
    v_fmac_f32 v230, v222, v222
    v_fmac_f32 v230, v223, v223
    v_fmac_f32 v230, v224, v224
    v_fmac_f32 v230, v225, v225
    v_fmac_f32 v230, v226, v226
    v_fmac_f32 v230, v227, v227
    v_fmac_f32 v230, v228, v228
    v_fmac_f32 v230, v229, v229
    s_nop 1
    v_add_f32_dpp v230, v230, v230 row_ror:8 row_mask:0xf bank_mask:0xf
    s_nop 1
    v_add_f32_dpp v230, v230, v230 row_ror:4 row_mask:0xf bank_mask:0xf
    s_nop 1
    v_add_f32_dpp v230, v230, v230 row_ror:2 row_mask:0xf bank_mask:0xf
    s_nop 1
    v_add_f32_dpp v230, v230, v230 row_ror:1 row_mask:0xf bank_mask:0xf
    v_mov_b32 v231, 0x3727c5ac
    v_fmac_f32 v231, 0.0015625, v230
    v_rsq_f32 v231, v231
    s_nop 0
    v_mul_f32 v190, v190, v231
    v_mul_f32 v191, v191, v231
    v_mul_f32 v192, v192, v231
    v_mul_f32 v193, v193, v231
    v_mul_f32 v194, v194, v231
    v_mul_f32 v195, v195, v231
    v_mul_f32 v196, v196, v231
    v_mul_f32 v197, v197, v231
    v_mul_f32 v198, v198, v231
    v_mul_f32 v199, v199, v231
    v_mul_f32 v200, v200, v231
    v_mul_f32 v201, v201, v231
    v_mul_f32 v202, v202, v231
    v_mul_f32 v203, v203, v231
    v_mul_f32 v204, v204, v231
    v_mul_f32 v205, v205, v231
    v_mul_f32 v206, v206, v231
    v_mul_f32 v207, v207, v231
    v_mul_f32 v208, v208, v231
    v_mul_f32 v209, v209, v231
    v_mul_f32 v210, v210, v231
    v_mul_f32 v211, v211, v231
    v_mul_f32 v212, v212, v231
    v_mul_f32 v213, v213, v231
    v_mul_f32 v214, v214, v231
    v_mul_f32 v215, v215, v231
    v_mul_f32 v216, v216, v231
    v_mul_f32 v217, v217, v231
    v_mul_f32 v218, v218, v231
    v_mul_f32 v219, v219, v231
    v_mul_f32 v220, v220, v231
    v_mul_f32 v221, v221, v231
    v_mul_f32 v222, v222, v231
    v_mul_f32 v223, v223, v231
    v_mul_f32 v224, v224, v231
    v_mul_f32 v225, v225, v231
    v_mul_f32 v226, v226, v231
    v_mul_f32 v227, v227, v231
    v_mul_f32 v228, v228, v231
    v_mul_f32 v229, v229, v231
    v_and_b32 v3, 15, v1
    v_add_u32 v10, 0, v4
    v_xor_b32 v3, v3, v10
    v_lshl_add_u32 v3, v3, 4, v9
    v_cvt_pk_bf16_f32 v190, v190, v191
    v_cvt_pk_bf16_f32 v191, v192, v193
    v_cvt_pk_bf16_f32 v192, v194, v195
    v_cvt_pk_bf16_f32 v193, v196, v197
    ds_write_b128 v3, v[190:193] offset:10240
    v_cvt_pk_bf16_f32 v198, v198, v199
    v_cvt_pk_bf16_f32 v199, v200, v201
    v_cvt_pk_bf16_f32 v200, v202, v203
    v_cvt_pk_bf16_f32 v201, v204, v205
    ds_write_b128 v3, v[198:201] offset:10496
    v_cvt_pk_bf16_f32 v206, v206, v207
    v_cvt_pk_bf16_f32 v207, v208, v209
    v_cvt_pk_bf16_f32 v208, v210, v211
    v_cvt_pk_bf16_f32 v209, v212, v213
    ds_write_b128 v3, v[206:209] offset:10752
    v_cvt_pk_bf16_f32 v214, v214, v215
    v_cvt_pk_bf16_f32 v215, v216, v217
    v_cvt_pk_bf16_f32 v216, v218, v219
    v_cvt_pk_bf16_f32 v217, v220, v221
    ds_write_b128 v3, v[214:217] offset:11008
    v_cvt_pk_bf16_f32 v222, v222, v223
    v_cvt_pk_bf16_f32 v223, v224, v225
    v_cvt_pk_bf16_f32 v224, v226, v227
    v_cvt_pk_bf16_f32 v225, v228, v229
    ds_write_b128 v3, v[222:225] offset:11264
    s_waitcnt vmcnt(0)
    s_waitcnt vmcnt(0)
    v_lshlrev_b32 v190, 16, v170
    v_and_b32 v191, 0xffff0000, v170
    v_lshlrev_b32 v192, 16, v171
    v_and_b32 v193, 0xffff0000, v171
    v_lshlrev_b32 v194, 16, v172
    v_and_b32 v195, 0xffff0000, v172
    v_lshlrev_b32 v196, 16, v173
    v_and_b32 v197, 0xffff0000, v173
    v_lshlrev_b32 v198, 16, v174
    v_and_b32 v199, 0xffff0000, v174
    v_lshlrev_b32 v200, 16, v175
    v_and_b32 v201, 0xffff0000, v175
    v_lshlrev_b32 v202, 16, v176
    v_and_b32 v203, 0xffff0000, v176
    v_lshlrev_b32 v204, 16, v177
    v_and_b32 v205, 0xffff0000, v177
    v_lshlrev_b32 v206, 16, v178
    v_and_b32 v207, 0xffff0000, v178
    v_lshlrev_b32 v208, 16, v179
    v_and_b32 v209, 0xffff0000, v179
    v_lshlrev_b32 v210, 16, v180
    v_and_b32 v211, 0xffff0000, v180
    v_lshlrev_b32 v212, 16, v181
    v_and_b32 v213, 0xffff0000, v181
    v_lshlrev_b32 v214, 16, v182
    v_and_b32 v215, 0xffff0000, v182
    v_lshlrev_b32 v216, 16, v183
    v_and_b32 v217, 0xffff0000, v183
    v_lshlrev_b32 v218, 16, v184
    v_and_b32 v219, 0xffff0000, v184
    v_lshlrev_b32 v220, 16, v185
    v_and_b32 v221, 0xffff0000, v185
    v_lshlrev_b32 v222, 16, v186
    v_and_b32 v223, 0xffff0000, v186
    v_lshlrev_b32 v224, 16, v187
    v_and_b32 v225, 0xffff0000, v187
    v_lshlrev_b32 v226, 16, v188
    v_and_b32 v227, 0xffff0000, v188
    v_lshlrev_b32 v228, 16, v189
    v_and_b32 v229, 0xffff0000, v189
    v_add_f32 v230, v190, v191
    v_add_f32 v230, v230, v192
    v_add_f32 v230, v230, v193
    v_add_f32 v230, v230, v194
    v_add_f32 v230, v230, v195
    v_add_f32 v230, v230, v196
    v_add_f32 v230, v230, v197
    v_add_f32 v230, v230, v198
    v_add_f32 v230, v230, v199
    v_add_f32 v230, v230, v200
    v_add_f32 v230, v230, v201
    v_add_f32 v230, v230, v202
    v_add_f32 v230, v230, v203
    v_add_f32 v230, v230, v204
    v_add_f32 v230, v230, v205
    v_add_f32 v230, v230, v206
    v_add_f32 v230, v230, v207
    v_add_f32 v230, v230, v208
    v_add_f32 v230, v230, v209
    v_add_f32 v230, v230, v210
    v_add_f32 v230, v230, v211
    v_add_f32 v230, v230, v212
    v_add_f32 v230, v230, v213
    v_add_f32 v230, v230, v214
    v_add_f32 v230, v230, v215
    v_add_f32 v230, v230, v216
    v_add_f32 v230, v230, v217
    v_add_f32 v230, v230, v218
    v_add_f32 v230, v230, v219
    v_add_f32 v230, v230, v220
    v_add_f32 v230, v230, v221
    v_add_f32 v230, v230, v222
    v_add_f32 v230, v230, v223
    v_add_f32 v230, v230, v224
    v_add_f32 v230, v230, v225
    v_add_f32 v230, v230, v226
    v_add_f32 v230, v230, v227
    v_add_f32 v230, v230, v228
    v_add_f32 v230, v230, v229
    s_nop 1
    v_add_f32_dpp v230, v230, v230 row_ror:8 row_mask:0xf bank_mask:0xf
    s_nop 1
    v_add_f32_dpp v230, v230, v230 row_ror:4 row_mask:0xf bank_mask:0xf
    s_nop 1
    v_add_f32_dpp v230, v230, v230 row_ror:2 row_mask:0xf bank_mask:0xf
    s_nop 1
    v_add_f32_dpp v230, v230, v230 row_ror:1 row_mask:0xf bank_mask:0xf
    v_mul_f32 v230, 0.0015625, v230
    v_sub_f32 v190, v190, v230
    v_sub_f32 v191, v191, v230
    v_sub_f32 v192, v192, v230
    v_sub_f32 v193, v193, v230
    v_sub_f32 v194, v194, v230
    v_sub_f32 v195, v195, v230
    v_sub_f32 v196, v196, v230
    v_sub_f32 v197, v197, v230
    v_sub_f32 v198, v198, v230
    v_sub_f32 v199, v199, v230
    v_sub_f32 v200, v200, v230
    v_sub_f32 v201, v201, v230
    v_sub_f32 v202, v202, v230
    v_sub_f32 v203, v203, v230
    v_sub_f32 v204, v204, v230
    v_sub_f32 v205, v205, v230
    v_sub_f32 v206, v206, v230
    v_sub_f32 v207, v207, v230
    v_sub_f32 v208, v208, v230
    v_sub_f32 v209, v209, v230
    v_sub_f32 v210, v210, v230
    v_sub_f32 v211, v211, v230
    v_sub_f32 v212, v212, v230
    v_sub_f32 v213, v213, v230
    v_sub_f32 v214, v214, v230
    v_sub_f32 v215, v215, v230
    v_sub_f32 v216, v216, v230
    v_sub_f32 v217, v217, v230
    v_sub_f32 v218, v218, v230
    v_sub_f32 v219, v219, v230
    v_sub_f32 v220, v220, v230
    v_sub_f32 v221, v221, v230
    v_sub_f32 v222, v222, v230
    v_sub_f32 v223, v223, v230
    v_sub_f32 v224, v224, v230
    v_sub_f32 v225, v225, v230
    v_sub_f32 v226, v226, v230
    v_sub_f32 v227, v227, v230
    v_sub_f32 v228, v228, v230
    v_sub_f32 v229, v229, v230
    v_mul_f32 v230, v190, v190
    v_fmac_f32 v230, v191, v191
    v_fmac_f32 v230, v192, v192
    v_fmac_f32 v230, v193, v193
    v_fmac_f32 v230, v194, v194
    v_fmac_f32 v230, v195, v195
    v_fmac_f32 v230, v196, v196
    v_fmac_f32 v230, v197, v197
    v_fmac_f32 v230, v198, v198
    v_fmac_f32 v230, v199, v199
    v_fmac_f32 v230, v200, v200
    v_fmac_f32 v230, v201, v201
    v_fmac_f32 v230, v202, v202
    v_fmac_f32 v230, v203, v203
    v_fmac_f32 v230, v204, v204
    v_fmac_f32 v230, v205, v205
    v_fmac_f32 v230, v206, v206
    v_fmac_f32 v230, v207, v207
    v_fmac_f32 v230, v208, v208
    v_fmac_f32 v230, v209, v209
    v_fmac_f32 v230, v210, v210
    v_fmac_f32 v230, v211, v211
    v_fmac_f32 v230, v212, v212
    v_fmac_f32 v230, v213, v213
    v_fmac_f32 v230, v214, v214
    v_fmac_f32 v230, v215, v215
    v_fmac_f32 v230, v216, v216
    v_fmac_f32 v230, v217, v217
    v_fmac_f32 v230, v218, v218
    v_fmac_f32 v230, v219, v219
    v_fmac_f32 v230, v220, v220
    v_fmac_f32 v230, v221, v221
    v_fmac_f32 v230, v222, v222
    v_fmac_f32 v230, v223, v223
    v_fmac_f32 v230, v224, v224
    v_fmac_f32 v230, v225, v225
    v_fmac_f32 v230, v226, v226
    v_fmac_f32 v230, v227, v227
    v_fmac_f32 v230, v228, v228
    v_fmac_f32 v230, v229, v229
    s_nop 1
    v_add_f32_dpp v230, v230, v230 row_ror:8 row_mask:0xf bank_mask:0xf
    s_nop 1
    v_add_f32_dpp v230, v230, v230 row_ror:4 row_mask:0xf bank_mask:0xf
    s_nop 1
    v_add_f32_dpp v230, v230, v230 row_ror:2 row_mask:0xf bank_mask:0xf
    s_nop 1
    v_add_f32_dpp v230, v230, v230 row_ror:1 row_mask:0xf bank_mask:0xf
    v_mov_b32 v231, 0x3727c5ac
    v_fmac_f32 v231, 0.0015625, v230
    v_rsq_f32 v231, v231
    s_nop 0
    v_mul_f32 v190, v190, v231
    v_mul_f32 v191, v191, v231
    v_mul_f32 v192, v192, v231
    v_mul_f32 v193, v193, v231
    v_mul_f32 v194, v194, v231
    v_mul_f32 v195, v195, v231
    v_mul_f32 v196, v196, v231
    v_mul_f32 v197, v197, v231
    v_mul_f32 v198, v198, v231
    v_mul_f32 v199, v199, v231
    v_mul_f32 v200, v200, v231
    v_mul_f32 v201, v201, v231
    v_mul_f32 v202, v202, v231
    v_mul_f32 v203, v203, v231
    v_mul_f32 v204, v204, v231
    v_mul_f32 v205, v205, v231
    v_mul_f32 v206, v206, v231
    v_mul_f32 v207, v207, v231
    v_mul_f32 v208, v208, v231
    v_mul_f32 v209, v209, v231
    v_mul_f32 v210, v210, v231
    v_mul_f32 v211, v211, v231
    v_mul_f32 v212, v212, v231
    v_mul_f32 v213, v213, v231
    v_mul_f32 v214, v214, v231
    v_mul_f32 v215, v215, v231
    v_mul_f32 v216, v216, v231
    v_mul_f32 v217, v217, v231
    v_mul_f32 v218, v218, v231
    v_mul_f32 v219, v219, v231
    v_mul_f32 v220, v220, v231
    v_mul_f32 v221, v221, v231
    v_mul_f32 v222, v222, v231
    v_mul_f32 v223, v223, v231
    v_mul_f32 v224, v224, v231
    v_mul_f32 v225, v225, v231
    v_mul_f32 v226, v226, v231
    v_mul_f32 v227, v227, v231
    v_mul_f32 v228, v228, v231
    v_mul_f32 v229, v229, v231
    v_cvt_pk_bf16_f32 v170, v190, v191
    v_cvt_pk_bf16_f32 v171, v192, v193
    v_cvt_pk_bf16_f32 v172, v194, v195
    v_cvt_pk_bf16_f32 v173, v196, v197
    v_cvt_pk_bf16_f32 v174, v198, v199
    v_cvt_pk_bf16_f32 v175, v200, v201
    v_cvt_pk_bf16_f32 v176, v202, v203
    v_cvt_pk_bf16_f32 v177, v204, v205
    v_cvt_pk_bf16_f32 v178, v206, v207
    v_cvt_pk_bf16_f32 v179, v208, v209
    v_cvt_pk_bf16_f32 v180, v210, v211
    v_cvt_pk_bf16_f32 v181, v212, v213
    v_cvt_pk_bf16_f32 v182, v214, v215
    v_cvt_pk_bf16_f32 v183, v216, v217
    v_cvt_pk_bf16_f32 v184, v218, v219
    v_cvt_pk_bf16_f32 v185, v220, v221
    v_cvt_pk_bf16_f32 v186, v222, v223
    v_cvt_pk_bf16_f32 v187, v224, v225
    v_cvt_pk_bf16_f32 v188, v226, v227
    v_cvt_pk_bf16_f32 v189, v228, v229
    s_cmp_lg_u32 s31, 0
    s_cbranch_scc1 mix1_nw3
    s_mov_b32 s34, 14105600
    buffer_store_dwordx4 v[170:173], v8, s[8:11], s34 offen
    s_mov_b32 s34, 14105856
    buffer_store_dwordx4 v[174:177], v8, s[8:11], s34 offen
    s_mov_b32 s34, 14106112
    buffer_store_dwordx4 v[178:181], v8, s[8:11], s34 offen
    s_mov_b32 s34, 14106368
    buffer_store_dwordx4 v[182:185], v8, s[8:11], s34 offen
    s_mov_b32 s34, 14106624
    buffer_store_dwordx4 v[186:189], v8, s[8:11], s34 offen
mix1_nw3:
    v_lshlrev_b32 v190, 16, v170
    v_and_b32 v191, 0xffff0000, v170
    v_lshlrev_b32 v192, 16, v171
    v_and_b32 v193, 0xffff0000, v171
    v_lshlrev_b32 v194, 16, v172
    v_and_b32 v195, 0xffff0000, v172
    v_lshlrev_b32 v196, 16, v173
    v_and_b32 v197, 0xffff0000, v173
    v_lshlrev_b32 v198, 16, v174
    v_and_b32 v199, 0xffff0000, v174
    v_lshlrev_b32 v200, 16, v175
    v_and_b32 v201, 0xffff0000, v175
    v_lshlrev_b32 v202, 16, v176
    v_and_b32 v203, 0xffff0000, v176
    v_lshlrev_b32 v204, 16, v177
    v_and_b32 v205, 0xffff0000, v177
    v_lshlrev_b32 v206, 16, v178
    v_and_b32 v207, 0xffff0000, v178
    v_lshlrev_b32 v208, 16, v179
    v_and_b32 v209, 0xffff0000, v179
    v_lshlrev_b32 v210, 16, v180
    v_and_b32 v211, 0xffff0000, v180
    v_lshlrev_b32 v212, 16, v181
    v_and_b32 v213, 0xffff0000, v181
    v_lshlrev_b32 v214, 16, v182
    v_and_b32 v215, 0xffff0000, v182
    v_lshlrev_b32 v216, 16, v183
    v_and_b32 v217, 0xffff0000, v183
    v_lshlrev_b32 v218, 16, v184
    v_and_b32 v219, 0xffff0000, v184
    v_lshlrev_b32 v220, 16, v185
    v_and_b32 v221, 0xffff0000, v185
    v_lshlrev_b32 v222, 16, v186
    v_and_b32 v223, 0xffff0000, v186
    v_lshlrev_b32 v224, 16, v187
    v_and_b32 v225, 0xffff0000, v187
    v_lshlrev_b32 v226, 16, v188
    v_and_b32 v227, 0xffff0000, v188
    v_lshlrev_b32 v228, 16, v189
    v_and_b32 v229, 0xffff0000, v189
    v_add_f32 v230, v190, v191
    v_add_f32 v230, v230, v192
    v_add_f32 v230, v230, v193
    v_add_f32 v230, v230, v194
    v_add_f32 v230, v230, v195
    v_add_f32 v230, v230, v196
    v_add_f32 v230, v230, v197
    v_add_f32 v230, v230, v198
    v_add_f32 v230, v230, v199
    v_add_f32 v230, v230, v200
    v_add_f32 v230, v230, v201
    v_add_f32 v230, v230, v202
    v_add_f32 v230, v230, v203
    v_add_f32 v230, v230, v204
    v_add_f32 v230, v230, v205
    v_add_f32 v230, v230, v206
    v_add_f32 v230, v230, v207
    v_add_f32 v230, v230, v208
    v_add_f32 v230, v230, v209
    v_add_f32 v230, v230, v210
    v_add_f32 v230, v230, v211
    v_add_f32 v230, v230, v212
    v_add_f32 v230, v230, v213
    v_add_f32 v230, v230, v214
    v_add_f32 v230, v230, v215
    v_add_f32 v230, v230, v216
    v_add_f32 v230, v230, v217
    v_add_f32 v230, v230, v218
    v_add_f32 v230, v230, v219
    v_add_f32 v230, v230, v220
    v_add_f32 v230, v230, v221
    v_add_f32 v230, v230, v222
    v_add_f32 v230, v230, v223
    v_add_f32 v230, v230, v224
    v_add_f32 v230, v230, v225
    v_add_f32 v230, v230, v226
    v_add_f32 v230, v230, v227
    v_add_f32 v230, v230, v228
    v_add_f32 v230, v230, v229
    s_nop 1
    v_add_f32_dpp v230, v230, v230 row_ror:8 row_mask:0xf bank_mask:0xf
    s_nop 1
    v_add_f32_dpp v230, v230, v230 row_ror:4 row_mask:0xf bank_mask:0xf
    s_nop 1
    v_add_f32_dpp v230, v230, v230 row_ror:2 row_mask:0xf bank_mask:0xf
    s_nop 1
    v_add_f32_dpp v230, v230, v230 row_ror:1 row_mask:0xf bank_mask:0xf
    v_mul_f32 v230, 0.0015625, v230
    v_sub_f32 v190, v190, v230
    v_sub_f32 v191, v191, v230
    v_sub_f32 v192, v192, v230
    v_sub_f32 v193, v193, v230
    v_sub_f32 v194, v194, v230
    v_sub_f32 v195, v195, v230
    v_sub_f32 v196, v196, v230
    v_sub_f32 v197, v197, v230
    v_sub_f32 v198, v198, v230
    v_sub_f32 v199, v199, v230
    v_sub_f32 v200, v200, v230
    v_sub_f32 v201, v201, v230
    v_sub_f32 v202, v202, v230
    v_sub_f32 v203, v203, v230
    v_sub_f32 v204, v204, v230
    v_sub_f32 v205, v205, v230
    v_sub_f32 v206, v206, v230
    v_sub_f32 v207, v207, v230
    v_sub_f32 v208, v208, v230
    v_sub_f32 v209, v209, v230
    v_sub_f32 v210, v210, v230
    v_sub_f32 v211, v211, v230
    v_sub_f32 v212, v212, v230
    v_sub_f32 v213, v213, v230
    v_sub_f32 v214, v214, v230
    v_sub_f32 v215, v215, v230
    v_sub_f32 v216, v216, v230
    v_sub_f32 v217, v217, v230
    v_sub_f32 v218, v218, v230
    v_sub_f32 v219, v219, v230
    v_sub_f32 v220, v220, v230
    v_sub_f32 v221, v221, v230
    v_sub_f32 v222, v222, v230
    v_sub_f32 v223, v223, v230
    v_sub_f32 v224, v224, v230
    v_sub_f32 v225, v225, v230
    v_sub_f32 v226, v226, v230
    v_sub_f32 v227, v227, v230
    v_sub_f32 v228, v228, v230
    v_sub_f32 v229, v229, v230
    v_mul_f32 v230, v190, v190
    v_fmac_f32 v230, v191, v191
    v_fmac_f32 v230, v192, v192
    v_fmac_f32 v230, v193, v193
    v_fmac_f32 v230, v194, v194
    v_fmac_f32 v230, v195, v195
    v_fmac_f32 v230, v196, v196
    v_fmac_f32 v230, v197, v197
    v_fmac_f32 v230, v198, v198
    v_fmac_f32 v230, v199, v199
    v_fmac_f32 v230, v200, v200
    v_fmac_f32 v230, v201, v201
    v_fmac_f32 v230, v202, v202
    v_fmac_f32 v230, v203, v203
    v_fmac_f32 v230, v204, v204
    v_fmac_f32 v230, v205, v205
    v_fmac_f32 v230, v206, v206
    v_fmac_f32 v230, v207, v207
    v_fmac_f32 v230, v208, v208
    v_fmac_f32 v230, v209, v209
    v_fmac_f32 v230, v210, v210
    v_fmac_f32 v230, v211, v211
    v_fmac_f32 v230, v212, v212
    v_fmac_f32 v230, v213, v213
    v_fmac_f32 v230, v214, v214
    v_fmac_f32 v230, v215, v215
    v_fmac_f32 v230, v216, v216
    v_fmac_f32 v230, v217, v217
    v_fmac_f32 v230, v218, v218
    v_fmac_f32 v230, v219, v219
    v_fmac_f32 v230, v220, v220
    v_fmac_f32 v230, v221, v221
    v_fmac_f32 v230, v222, v222
    v_fmac_f32 v230, v223, v223
    v_fmac_f32 v230, v224, v224
    v_fmac_f32 v230, v225, v225
    v_fmac_f32 v230, v226, v226
    v_fmac_f32 v230, v227, v227
    v_fmac_f32 v230, v228, v228
    v_fmac_f32 v230, v229, v229
    s_nop 1
    v_add_f32_dpp v230, v230, v230 row_ror:8 row_mask:0xf bank_mask:0xf
    s_nop 1
    v_add_f32_dpp v230, v230, v230 row_ror:4 row_mask:0xf bank_mask:0xf
    s_nop 1
    v_add_f32_dpp v230, v230, v230 row_ror:2 row_mask:0xf bank_mask:0xf
    s_nop 1
    v_add_f32_dpp v230, v230, v230 row_ror:1 row_mask:0xf bank_mask:0xf
    v_mov_b32 v231, 0x3727c5ac
    v_fmac_f32 v231, 0.0015625, v230
    v_rsq_f32 v231, v231
    s_nop 0
    v_mul_f32 v190, v190, v231
    v_mul_f32 v191, v191, v231
    v_mul_f32 v192, v192, v231
    v_mul_f32 v193, v193, v231
    v_mul_f32 v194, v194, v231
    v_mul_f32 v195, v195, v231
    v_mul_f32 v196, v196, v231
    v_mul_f32 v197, v197, v231
    v_mul_f32 v198, v198, v231
    v_mul_f32 v199, v199, v231
    v_mul_f32 v200, v200, v231
    v_mul_f32 v201, v201, v231
    v_mul_f32 v202, v202, v231
    v_mul_f32 v203, v203, v231
    v_mul_f32 v204, v204, v231
    v_mul_f32 v205, v205, v231
    v_mul_f32 v206, v206, v231
    v_mul_f32 v207, v207, v231
    v_mul_f32 v208, v208, v231
    v_mul_f32 v209, v209, v231
    v_mul_f32 v210, v210, v231
    v_mul_f32 v211, v211, v231
    v_mul_f32 v212, v212, v231
    v_mul_f32 v213, v213, v231
    v_mul_f32 v214, v214, v231
    v_mul_f32 v215, v215, v231
    v_mul_f32 v216, v216, v231
    v_mul_f32 v217, v217, v231
    v_mul_f32 v218, v218, v231
    v_mul_f32 v219, v219, v231
    v_mul_f32 v220, v220, v231
    v_mul_f32 v221, v221, v231
    v_mul_f32 v222, v222, v231
    v_mul_f32 v223, v223, v231
    v_mul_f32 v224, v224, v231
    v_mul_f32 v225, v225, v231
    v_mul_f32 v226, v226, v231
    v_mul_f32 v227, v227, v231
    v_mul_f32 v228, v228, v231
    v_mul_f32 v229, v229, v231
    v_and_b32 v3, 15, v1
    v_add_u32 v10, 4, v4
    v_xor_b32 v3, v3, v10
    v_lshl_add_u32 v3, v3, 4, v9
    v_cvt_pk_bf16_f32 v190, v190, v191
    v_cvt_pk_bf16_f32 v191, v192, v193
    v_cvt_pk_bf16_f32 v192, v194, v195
    v_cvt_pk_bf16_f32 v193, v196, v197
    ds_write_b128 v3, v[190:193] offset:15360
    v_cvt_pk_bf16_f32 v198, v198, v199
    v_cvt_pk_bf16_f32 v199, v200, v201
    v_cvt_pk_bf16_f32 v200, v202, v203
    v_cvt_pk_bf16_f32 v201, v204, v205
    ds_write_b128 v3, v[198:201] offset:15616
    v_cvt_pk_bf16_f32 v206, v206, v207
    v_cvt_pk_bf16_f32 v207, v208, v209
    v_cvt_pk_bf16_f32 v208, v210, v211
    v_cvt_pk_bf16_f32 v209, v212, v213
    ds_write_b128 v3, v[206:209] offset:15872
    v_cvt_pk_bf16_f32 v214, v214, v215
    v_cvt_pk_bf16_f32 v215, v216, v217
    v_cvt_pk_bf16_f32 v216, v218, v219
    v_cvt_pk_bf16_f32 v217, v220, v221
    ds_write_b128 v3, v[214:217] offset:16128
    v_cvt_pk_bf16_f32 v222, v222, v223
    v_cvt_pk_bf16_f32 v223, v224, v225
    v_cvt_pk_bf16_f32 v224, v226, v227
    v_cvt_pk_bf16_f32 v225, v228, v229
    ds_write_b128 v3, v[222:225] offset:16384
    s_waitcnt vmcnt(0)
mix1_psk0:
    s_waitcnt vmcnt(0) lgkmcnt(0)
    s_barrier
    ds_read_b128 v[110:113], v7 offset:0
    ds_read_b128 v[114:117], v7 offset:20480
    ds_read_b128 v[118:121], v7 offset:40960
    ds_read_b128 v[122:125], v7 offset:61440
    ds_read_b128 v[126:129], v6 offset:0
    ds_read_b128 v[130:133], v6 offset:20480
    ds_read_b128 v[134:137], v6 offset:40960
    ds_read_b128 v[138:141], v6 offset:61440
    s_waitcnt lgkmcnt(4)
    v_mfma_f32_16x16x32_bf16 v[94:97], v[14:17], v[110:113], v[94:97]
    v_mfma_f32_16x16x32_bf16 v[98:101], v[14:17], v[114:117], v[98:101]
    v_mfma_f32_16x16x32_bf16 v[102:105], v[14:17], v[118:121], v[102:105]
    v_mfma_f32_16x16x32_bf16 v[106:109], v[14:17], v[122:125], v[106:109]
    ds_read_b128 v[110:113], v7 offset:128
    ds_read_b128 v[114:117], v7 offset:20608
    ds_read_b128 v[118:121], v7 offset:41088
    ds_read_b128 v[122:125], v7 offset:61568
    s_waitcnt lgkmcnt(4)
    v_mfma_f32_16x16x32_bf16 v[94:97], v[18:21], v[126:129], v[94:97]
    v_mfma_f32_16x16x32_bf16 v[98:101], v[18:21], v[130:133], v[98:101]
    v_mfma_f32_16x16x32_bf16 v[102:105], v[18:21], v[134:137], v[102:105]
    v_mfma_f32_16x16x32_bf16 v[106:109], v[18:21], v[138:141], v[106:109]
    ds_read_b128 v[126:129], v6 offset:128
    ds_read_b128 v[130:133], v6 offset:20608
    ds_read_b128 v[134:137], v6 offset:41088
    ds_read_b128 v[138:141], v6 offset:61568
    s_waitcnt lgkmcnt(4)
    v_mfma_f32_16x16x32_bf16 v[94:97], v[22:25], v[110:113], v[94:97]
    v_mfma_f32_16x16x32_bf16 v[98:101], v[22:25], v[114:117], v[98:101]
    v_mfma_f32_16x16x32_bf16 v[102:105], v[22:25], v[118:121], v[102:105]
    v_mfma_f32_16x16x32_bf16 v[106:109], v[22:25], v[122:125], v[106:109]
    ds_read_b128 v[110:113], v7 offset:256
    ds_read_b128 v[114:117], v7 offset:20736
    ds_read_b128 v[118:121], v7 offset:41216
    ds_read_b128 v[122:125], v7 offset:61696
    s_waitcnt lgkmcnt(4)
    v_mfma_f32_16x16x32_bf16 v[94:97], v[26:29], v[126:129], v[94:97]
    v_mfma_f32_16x16x32_bf16 v[98:101], v[26:29], v[130:133], v[98:101]
    v_mfma_f32_16x16x32_bf16 v[102:105], v[26:29], v[134:137], v[102:105]
    v_mfma_f32_16x16x32_bf16 v[106:109], v[26:29], v[138:141], v[106:109]
    ds_read_b128 v[126:129], v6 offset:256
    ds_read_b128 v[130:133], v6 offset:20736
    ds_read_b128 v[134:137], v6 offset:41216
    ds_read_b128 v[138:141], v6 offset:61696
    s_waitcnt lgkmcnt(4)
    v_mfma_f32_16x16x32_bf16 v[94:97], v[30:33], v[110:113], v[94:97]
    v_mfma_f32_16x16x32_bf16 v[98:101], v[30:33], v[114:117], v[98:101]
    v_mfma_f32_16x16x32_bf16 v[102:105], v[30:33], v[118:121], v[102:105]
    v_mfma_f32_16x16x32_bf16 v[106:109], v[30:33], v[122:125], v[106:109]
    ds_read_b128 v[110:113], v7 offset:384
    ds_read_b128 v[114:117], v7 offset:20864
    ds_read_b128 v[118:121], v7 offset:41344
    ds_read_b128 v[122:125], v7 offset:61824
    s_waitcnt lgkmcnt(4)
    v_mfma_f32_16x16x32_bf16 v[94:97], v[34:37], v[126:129], v[94:97]
    v_mfma_f32_16x16x32_bf16 v[98:101], v[34:37], v[130:133], v[98:101]
    v_mfma_f32_16x16x32_bf16 v[102:105], v[34:37], v[134:137], v[102:105]
    v_mfma_f32_16x16x32_bf16 v[106:109], v[34:37], v[138:141], v[106:109]
    ds_read_b128 v[126:129], v6 offset:384
    ds_read_b128 v[130:133], v6 offset:20864
    ds_read_b128 v[134:137], v6 offset:41344
    ds_read_b128 v[138:141], v6 offset:61824
    s_waitcnt lgkmcnt(4)
    v_mfma_f32_16x16x32_bf16 v[94:97], v[38:41], v[110:113], v[94:97]
    v_mfma_f32_16x16x32_bf16 v[98:101], v[38:41], v[114:117], v[98:101]
    v_mfma_f32_16x16x32_bf16 v[102:105], v[38:41], v[118:121], v[102:105]
    v_mfma_f32_16x16x32_bf16 v[106:109], v[38:41], v[122:125], v[106:109]
    ds_read_b128 v[110:113], v7 offset:512
    ds_read_b128 v[114:117], v7 offset:20992
    ds_read_b128 v[118:121], v7 offset:41472
    ds_read_b128 v[122:125], v7 offset:61952
    s_waitcnt lgkmcnt(4)
    v_mfma_f32_16x16x32_bf16 v[94:97], v[42:45], v[126:129], v[94:97]
    v_mfma_f32_16x16x32_bf16 v[98:101], v[42:45], v[130:133], v[98:101]
    v_mfma_f32_16x16x32_bf16 v[102:105], v[42:45], v[134:137], v[102:105]
    v_mfma_f32_16x16x32_bf16 v[106:109], v[42:45], v[138:141], v[106:109]
    ds_read_b128 v[126:129], v6 offset:512
    ds_read_b128 v[130:133], v6 offset:20992
    ds_read_b128 v[134:137], v6 offset:41472
    ds_read_b128 v[138:141], v6 offset:61952
    s_waitcnt lgkmcnt(4)
    v_mfma_f32_16x16x32_bf16 v[94:97], v[46:49], v[110:113], v[94:97]
    v_mfma_f32_16x16x32_bf16 v[98:101], v[46:49], v[114:117], v[98:101]
    v_mfma_f32_16x16x32_bf16 v[102:105], v[46:49], v[118:121], v[102:105]
    v_mfma_f32_16x16x32_bf16 v[106:109], v[46:49], v[122:125], v[106:109]
    ds_read_b128 v[110:113], v7 offset:640
    ds_read_b128 v[114:117], v7 offset:21120
    ds_read_b128 v[118:121], v7 offset:41600
    ds_read_b128 v[122:125], v7 offset:62080
    s_waitcnt lgkmcnt(4)
    v_mfma_f32_16x16x32_bf16 v[94:97], v[50:53], v[126:129], v[94:97]
    v_mfma_f32_16x16x32_bf16 v[98:101], v[50:53], v[130:133], v[98:101]
    v_mfma_f32_16x16x32_bf16 v[102:105], v[50:53], v[134:137], v[102:105]
    v_mfma_f32_16x16x32_bf16 v[106:109], v[50:53], v[138:141], v[106:109]
    ds_read_b128 v[126:129], v6 offset:640
    ds_read_b128 v[130:133], v6 offset:21120
    ds_read_b128 v[134:137], v6 offset:41600
    ds_read_b128 v[138:141], v6 offset:62080
    s_waitcnt lgkmcnt(4)
    v_mfma_f32_16x16x32_bf16 v[94:97], v[54:57], v[110:113], v[94:97]
    v_mfma_f32_16x16x32_bf16 v[98:101], v[54:57], v[114:117], v[98:101]
    v_mfma_f32_16x16x32_bf16 v[102:105], v[54:57], v[118:121], v[102:105]
    v_mfma_f32_16x16x32_bf16 v[106:109], v[54:57], v[122:125], v[106:109]
    ds_read_b128 v[110:113], v7 offset:768
    ds_read_b128 v[114:117], v7 offset:21248
    ds_read_b128 v[118:121], v7 offset:41728
    ds_read_b128 v[122:125], v7 offset:62208
    s_waitcnt lgkmcnt(4)
    v_mfma_f32_16x16x32_bf16 v[94:97], v[58:61], v[126:129], v[94:97]
    v_mfma_f32_16x16x32_bf16 v[98:101], v[58:61], v[130:133], v[98:101]
    v_mfma_f32_16x16x32_bf16 v[102:105], v[58:61], v[134:137], v[102:105]
    v_mfma_f32_16x16x32_bf16 v[106:109], v[58:61], v[138:141], v[106:109]
    ds_read_b128 v[126:129], v6 offset:768
    ds_read_b128 v[130:133], v6 offset:21248
    ds_read_b128 v[134:137], v6 offset:41728
    ds_read_b128 v[138:141], v6 offset:62208
    s_waitcnt lgkmcnt(4)
    v_mfma_f32_16x16x32_bf16 v[94:97], v[62:65], v[110:113], v[94:97]
    v_mfma_f32_16x16x32_bf16 v[98:101], v[62:65], v[114:117], v[98:101]
    v_mfma_f32_16x16x32_bf16 v[102:105], v[62:65], v[118:121], v[102:105]
    v_mfma_f32_16x16x32_bf16 v[106:109], v[62:65], v[122:125], v[106:109]
    ds_read_b128 v[110:113], v7 offset:896
    ds_read_b128 v[114:117], v7 offset:21376
    ds_read_b128 v[118:121], v7 offset:41856
    ds_read_b128 v[122:125], v7 offset:62336
    s_waitcnt lgkmcnt(4)
    v_mfma_f32_16x16x32_bf16 v[94:97], v[66:69], v[126:129], v[94:97]
    v_mfma_f32_16x16x32_bf16 v[98:101], v[66:69], v[130:133], v[98:101]
    v_mfma_f32_16x16x32_bf16 v[102:105], v[66:69], v[134:137], v[102:105]
    v_mfma_f32_16x16x32_bf16 v[106:109], v[66:69], v[138:141], v[106:109]
    ds_read_b128 v[126:129], v6 offset:896
    ds_read_b128 v[130:133], v6 offset:21376
    ds_read_b128 v[134:137], v6 offset:41856
    ds_read_b128 v[138:141], v6 offset:62336
    s_waitcnt lgkmcnt(4)
    v_mfma_f32_16x16x32_bf16 v[94:97], v[70:73], v[110:113], v[94:97]
    v_mfma_f32_16x16x32_bf16 v[98:101], v[70:73], v[114:117], v[98:101]
    v_mfma_f32_16x16x32_bf16 v[102:105], v[70:73], v[118:121], v[102:105]
    v_mfma_f32_16x16x32_bf16 v[106:109], v[70:73], v[122:125], v[106:109]
    ds_read_b128 v[110:113], v7 offset:1024
    ds_read_b128 v[114:117], v7 offset:21504
    ds_read_b128 v[118:121], v7 offset:41984
    ds_read_b128 v[122:125], v7 offset:62464
    s_waitcnt lgkmcnt(4)
    v_mfma_f32_16x16x32_bf16 v[94:97], v[74:77], v[126:129], v[94:97]
    v_mfma_f32_16x16x32_bf16 v[98:101], v[74:77], v[130:133], v[98:101]
    v_mfma_f32_16x16x32_bf16 v[102:105], v[74:77], v[134:137], v[102:105]
    v_mfma_f32_16x16x32_bf16 v[106:109], v[74:77], v[138:141], v[106:109]
    ds_read_b128 v[126:129], v6 offset:1024
    ds_read_b128 v[130:133], v6 offset:21504
    ds_read_b128 v[134:137], v6 offset:41984
    ds_read_b128 v[138:141], v6 offset:62464
    s_waitcnt lgkmcnt(4)
    v_mfma_f32_16x16x32_bf16 v[94:97], v[78:81], v[110:113], v[94:97]
    v_mfma_f32_16x16x32_bf16 v[98:101], v[78:81], v[114:117], v[98:101]
    v_mfma_f32_16x16x32_bf16 v[102:105], v[78:81], v[118:121], v[102:105]
    v_mfma_f32_16x16x32_bf16 v[106:109], v[78:81], v[122:125], v[106:109]
    ds_read_b128 v[110:113], v7 offset:1152
    ds_read_b128 v[114:117], v7 offset:21632
    ds_read_b128 v[118:121], v7 offset:42112
    ds_read_b128 v[122:125], v7 offset:62592
    s_waitcnt lgkmcnt(4)
    v_mfma_f32_16x16x32_bf16 v[94:97], v[82:85], v[126:129], v[94:97]
    v_mfma_f32_16x16x32_bf16 v[98:101], v[82:85], v[130:133], v[98:101]
    v_mfma_f32_16x16x32_bf16 v[102:105], v[82:85], v[134:137], v[102:105]
    v_mfma_f32_16x16x32_bf16 v[106:109], v[82:85], v[138:141], v[106:109]
    ds_read_b128 v[126:129], v6 offset:1152
    ds_read_b128 v[130:133], v6 offset:21632
    ds_read_b128 v[134:137], v6 offset:42112
    ds_read_b128 v[138:141], v6 offset:62592
    s_waitcnt lgkmcnt(4)
    v_mfma_f32_16x16x32_bf16 v[94:97], v[86:89], v[110:113], v[94:97]
    v_mfma_f32_16x16x32_bf16 v[98:101], v[86:89], v[114:117], v[98:101]
    v_mfma_f32_16x16x32_bf16 v[102:105], v[86:89], v[118:121], v[102:105]
    v_mfma_f32_16x16x32_bf16 v[106:109], v[86:89], v[122:125], v[106:109]
    s_waitcnt lgkmcnt(0)
    v_mfma_f32_16x16x32_bf16 v[94:97], v[90:93], v[126:129], v[94:97]
    v_mfma_f32_16x16x32_bf16 v[98:101], v[90:93], v[130:133], v[98:101]
    v_mfma_f32_16x16x32_bf16 v[102:105], v[90:93], v[134:137], v[102:105]
    v_mfma_f32_16x16x32_bf16 v[106:109], v[90:93], v[138:141], v[106:109]
    s_nop 7
    s_nop 7
    v_mul_f32 v110, v94, v94
    v_mov_b32 v111, 0x3f4c422a
    v_fmac_f32 v111, 0x3d122279, v110
    v_mul_f32 v111, v111, v94
    v_mul_f32 v111, 0xc038aa3b, v111
    v_exp_f32 v111, v111
    s_nop 0
    v_add_f32 v111, 1.0, v111
    v_rcp_f32 v111, v111
    s_nop 0
    v_mul_f32 v94, v94, v111
    v_mul_f32 v110, v95, v95
    v_mov_b32 v111, 0x3f4c422a
    v_fmac_f32 v111, 0x3d122279, v110
    v_mul_f32 v111, v111, v95
    v_mul_f32 v111, 0xc038aa3b, v111
    v_exp_f32 v111, v111
    s_nop 0
    v_add_f32 v111, 1.0, v111
    v_rcp_f32 v111, v111
    s_nop 0
    v_mul_f32 v95, v95, v111
    v_mul_f32 v110, v96, v96
    v_mov_b32 v111, 0x3f4c422a
    v_fmac_f32 v111, 0x3d122279, v110
    v_mul_f32 v111, v111, v96
    v_mul_f32 v111, 0xc038aa3b, v111
    v_exp_f32 v111, v111
    s_nop 0
    v_add_f32 v111, 1.0, v111
    v_rcp_f32 v111, v111
    s_nop 0
    v_mul_f32 v96, v96, v111
    v_mul_f32 v110, v97, v97
    v_mov_b32 v111, 0x3f4c422a
    v_fmac_f32 v111, 0x3d122279, v110
    v_mul_f32 v111, v111, v97
    v_mul_f32 v111, 0xc038aa3b, v111
    v_exp_f32 v111, v111
    s_nop 0
    v_add_f32 v111, 1.0, v111
    v_rcp_f32 v111, v111
    s_nop 0
    v_mul_f32 v97, v97, v111
    v_cvt_pk_bf16_f32 v94, v94, v95
    v_cvt_pk_bf16_f32 v95, v96, v97
    s_mov_b32 s34, 16711680
    buffer_store_dwordx2 v[94:95], v5, s[8:11], s34 offen
    v_mul_f32 v110, v98, v98
    v_mov_b32 v111, 0x3f4c422a
    v_fmac_f32 v111, 0x3d122279, v110
    v_mul_f32 v111, v111, v98
    v_mul_f32 v111, 0xc038aa3b, v111
    v_exp_f32 v111, v111
    s_nop 0
    v_add_f32 v111, 1.0, v111
    v_rcp_f32 v111, v111
    s_nop 0
    v_mul_f32 v98, v98, v111
    v_mul_f32 v110, v99, v99
    v_mov_b32 v111, 0x3f4c422a
    v_fmac_f32 v111, 0x3d122279, v110
    v_mul_f32 v111, v111, v99
    v_mul_f32 v111, 0xc038aa3b, v111
    v_exp_f32 v111, v111
    s_nop 0
    v_add_f32 v111, 1.0, v111
    v_rcp_f32 v111, v111
    s_nop 0
    v_mul_f32 v99, v99, v111
    v_mul_f32 v110, v100, v100
    v_mov_b32 v111, 0x3f4c422a
    v_fmac_f32 v111, 0x3d122279, v110
    v_mul_f32 v111, v111, v100
    v_mul_f32 v111, 0xc038aa3b, v111
    v_exp_f32 v111, v111
    s_nop 0
    v_add_f32 v111, 1.0, v111
    v_rcp_f32 v111, v111
    s_nop 0
    v_mul_f32 v100, v100, v111
    v_mul_f32 v110, v101, v101
    v_mov_b32 v111, 0x3f4c422a
    v_fmac_f32 v111, 0x3d122279, v110
    v_mul_f32 v111, v111, v101
    v_mul_f32 v111, 0xc038aa3b, v111
    v_exp_f32 v111, v111
    s_nop 0
    v_add_f32 v111, 1.0, v111
    v_rcp_f32 v111, v111
    s_nop 0
    v_mul_f32 v101, v101, v111
    v_cvt_pk_bf16_f32 v98, v98, v99
    v_cvt_pk_bf16_f32 v99, v100, v101
    s_mov_b32 s34, 16732160
    buffer_store_dwordx2 v[98:99], v5, s[8:11], s34 offen
    v_mul_f32 v110, v102, v102
    v_mov_b32 v111, 0x3f4c422a
    v_fmac_f32 v111, 0x3d122279, v110
    v_mul_f32 v111, v111, v102
    v_mul_f32 v111, 0xc038aa3b, v111
    v_exp_f32 v111, v111
    s_nop 0
    v_add_f32 v111, 1.0, v111
    v_rcp_f32 v111, v111
    s_nop 0
    v_mul_f32 v102, v102, v111
    v_mul_f32 v110, v103, v103
    v_mov_b32 v111, 0x3f4c422a
    v_fmac_f32 v111, 0x3d122279, v110
    v_mul_f32 v111, v111, v103
    v_mul_f32 v111, 0xc038aa3b, v111
    v_exp_f32 v111, v111
    s_nop 0
    v_add_f32 v111, 1.0, v111
    v_rcp_f32 v111, v111
    s_nop 0
    v_mul_f32 v103, v103, v111
    v_mul_f32 v110, v104, v104
    v_mov_b32 v111, 0x3f4c422a
    v_fmac_f32 v111, 0x3d122279, v110
    v_mul_f32 v111, v111, v104
    v_mul_f32 v111, 0xc038aa3b, v111
    v_exp_f32 v111, v111
    s_nop 0
    v_add_f32 v111, 1.0, v111
    v_rcp_f32 v111, v111
    s_nop 0
    v_mul_f32 v104, v104, v111
    v_mul_f32 v110, v105, v105
    v_mov_b32 v111, 0x3f4c422a
    v_fmac_f32 v111, 0x3d122279, v110
    v_mul_f32 v111, v111, v105
    v_mul_f32 v111, 0xc038aa3b, v111
    v_exp_f32 v111, v111
    s_nop 0
    v_add_f32 v111, 1.0, v111
    v_rcp_f32 v111, v111
    s_nop 0
    v_mul_f32 v105, v105, v111
    v_cvt_pk_bf16_f32 v102, v102, v103
    v_cvt_pk_bf16_f32 v103, v104, v105
    s_mov_b32 s34, 16752640
    buffer_store_dwordx2 v[102:103], v5, s[8:11], s34 offen
    v_mul_f32 v110, v106, v106
    v_mov_b32 v111, 0x3f4c422a
    v_fmac_f32 v111, 0x3d122279, v110
    v_mul_f32 v111, v111, v106
    v_mul_f32 v111, 0xc038aa3b, v111
    v_exp_f32 v111, v111
    s_nop 0
    v_add_f32 v111, 1.0, v111
    v_rcp_f32 v111, v111
    s_nop 0
    v_mul_f32 v106, v106, v111
    v_mul_f32 v110, v107, v107
    v_mov_b32 v111, 0x3f4c422a
    v_fmac_f32 v111, 0x3d122279, v110
    v_mul_f32 v111, v111, v107
    v_mul_f32 v111, 0xc038aa3b, v111
    v_exp_f32 v111, v111
    s_nop 0
    v_add_f32 v111, 1.0, v111
    v_rcp_f32 v111, v111
    s_nop 0
    v_mul_f32 v107, v107, v111
    v_mul_f32 v110, v108, v108
    v_mov_b32 v111, 0x3f4c422a
    v_fmac_f32 v111, 0x3d122279, v110
    v_mul_f32 v111, v111, v108
    v_mul_f32 v111, 0xc038aa3b, v111
    v_exp_f32 v111, v111
    s_nop 0
    v_add_f32 v111, 1.0, v111
    v_rcp_f32 v111, v111
    s_nop 0
    v_mul_f32 v108, v108, v111
    v_mul_f32 v110, v109, v109
    v_mov_b32 v111, 0x3f4c422a
    v_fmac_f32 v111, 0x3d122279, v110
    v_mul_f32 v111, v111, v109
    v_mul_f32 v111, 0xc038aa3b, v111
    v_exp_f32 v111, v111
    s_nop 0
    v_add_f32 v111, 1.0, v111
    v_rcp_f32 v111, v111
    s_nop 0
    v_mul_f32 v109, v109, v111
    v_cvt_pk_bf16_f32 v106, v106, v107
    v_cvt_pk_bf16_f32 v107, v108, v109
    s_mov_b32 s34, 16773120
    buffer_store_dwordx2 v[106:107], v5, s[8:11], s34 offen
mix1_done:
    s_endpgm
.globl mix2_kernel
.p2align 8
.type mix2_kernel,@function
mix2_kernel:
    s_cmp_ge_u32 s2, 256
    s_cbranch_scc1 mix2_done
    s_load_dwordx2 s[4:5], s[0:1], 80
    s_load_dwordx2 s[6:7], s[0:1], 0
    s_load_dwordx2 s[28:29], s[0:1], 64
    s_mul_hi_u32 s30, s2, 536870913
    s_mul_i32 s31, s30, 8
    s_sub_u32 s31, s2, s31
    v_lshrrev_b32 v1, 6, v0
    s_nop 0
    v_readfirstlane_b32 s32, v1
    v_and_b32 v1, 63, v0
    s_waitcnt lgkmcnt(0)
    s_mov_b32 s8, s4
    s_mov_b32 s9, s5
    s_and_b32 s9, s9, 0xffff
    s_mov_b32 s10, 268435456
    s_mov_b32 s11, 0x00020000
    s_mov_b32 s12, s6
    s_mov_b32 s13, s7
    s_and_b32 s13, s13, 0xffff
    s_mov_b32 s14, 2621440
    s_mov_b32 s15, 0x00020000
    s_mov_b32 s16, s28
    s_mov_b32 s17, s29
    s_and_b32 s17, s17, 0xffff
    s_mov_b32 s18, 2621440
    s_mov_b32 s19, 0x00020000
    s_mul_i32 s33, s31, 5
    s_add_u32 s33, s33, s32
    s_mul_i32 s33, s33, 20480
    s_add_u32 s33, s33, 3276800
    v_lshlrev_b32 v2, 4, v1
    s_add_u32 s34, s33, 0
    buffer_load_dwordx4 v[14:17], v2, s[8:11], s34 offen
    s_add_u32 s34, s33, 1024
    buffer_load_dwordx4 v[18:21], v2, s[8:11], s34 offen
    s_add_u32 s34, s33, 2048
    buffer_load_dwordx4 v[22:25], v2, s[8:11], s34 offen
    s_add_u32 s34, s33, 3072
    buffer_load_dwordx4 v[26:29], v2, s[8:11], s34 offen
    s_add_u32 s34, s33, 4096
    buffer_load_dwordx4 v[30:33], v2, s[8:11], s34 offen
    s_add_u32 s34, s33, 5120
    buffer_load_dwordx4 v[34:37], v2, s[8:11], s34 offen
    s_add_u32 s34, s33, 6144
    buffer_load_dwordx4 v[38:41], v2, s[8:11], s34 offen
    s_add_u32 s34, s33, 7168
    buffer_load_dwordx4 v[42:45], v2, s[8:11], s34 offen
    s_add_u32 s34, s33, 8192
    buffer_load_dwordx4 v[46:49], v2, s[8:11], s34 offen
    s_add_u32 s34, s33, 9216
    buffer_load_dwordx4 v[50:53], v2, s[8:11], s34 offen
    s_add_u32 s34, s33, 10240
    buffer_load_dwordx4 v[54:57], v2, s[8:11], s34 offen
    s_add_u32 s34, s33, 11264
    buffer_load_dwordx4 v[58:61], v2, s[8:11], s34 offen
    s_add_u32 s34, s33, 12288
    buffer_load_dwordx4 v[62:65], v2, s[8:11], s34 offen
    s_add_u32 s34, s33, 13312
    buffer_load_dwordx4 v[66:69], v2, s[8:11], s34 offen
    s_add_u32 s34, s33, 14336
    buffer_load_dwordx4 v[70:73], v2, s[8:11], s34 offen
    s_add_u32 s34, s33, 15360
    buffer_load_dwordx4 v[74:77], v2, s[8:11], s34 offen
    s_add_u32 s34, s33, 16384
    buffer_load_dwordx4 v[78:81], v2, s[8:11], s34 offen
    s_add_u32 s34, s33, 17408
    buffer_load_dwordx4 v[82:85], v2, s[8:11], s34 offen
    s_add_u32 s34, s33, 18432
    buffer_load_dwordx4 v[86:89], v2, s[8:11], s34 offen
    s_add_u32 s34, s33, 19456
    buffer_load_dwordx4 v[90:93], v2, s[8:11], s34 offen
    v_and_b32 v3, 15, v1
    v_lshrrev_b32 v4, 4, v1
    s_lshl_b32 s35, s30, 6
    v_add_u32 v5, s35, v3
    s_mov_b32 s36, 1280
    v_mul_lo_u32 v5, v5, s36
    s_mul_i32 s36, s31, 160
    s_mul_i32 s37, s32, 32
    s_add_u32 s36, s36, s37
    v_lshl_add_u32 v5, v4, 3, v5
    v_add_u32 v5, s36, v5
    s_mov_b32 s34, 14090240
    buffer_load_dwordx2 v[110:111], v5, s[8:11], s34 offen
    s_mov_b32 s34, 14110720
    buffer_load_dwordx2 v[112:113], v5, s[8:11], s34 offen
    s_mov_b32 s34, 14131200
    buffer_load_dwordx2 v[114:115], v5, s[8:11], s34 offen
    s_mov_b32 s34, 14151680
    buffer_load_dwordx2 v[116:117], v5, s[8:11], s34 offen
    v_and_b32 v6, 7, v1
    v_xor_b32 v7, v4, v6
    v_or_b32 v6, 4, v4
    v_and_b32 v3, 7, v1
    v_xor_b32 v6, v6, v3
    v_and_b32 v3, 15, v1
    v_mul_u32_u24 v3, 1280, v3
    v_lshl_add_u32 v7, v7, 4, v3
    v_lshl_add_u32 v6, v6, 4, v3
    v_mov_b32 v94, 0
    v_mov_b32 v95, 0
    v_mov_b32 v96, 0
    v_mov_b32 v97, 0
    v_mov_b32 v98, 0
    v_mov_b32 v99, 0
    v_mov_b32 v100, 0
    v_mov_b32 v101, 0
    v_mov_b32 v102, 0
    v_mov_b32 v103, 0
    v_mov_b32 v104, 0
    v_mov_b32 v105, 0
    v_mov_b32 v106, 0
    v_mov_b32 v107, 0
    v_mov_b32 v108, 0
    v_mov_b32 v109, 0
    s_cmp_ge_u32 s32, 4
    s_cbranch_scc1 mix2_psk0
    v_and_b32 v3, 15, v1
    s_lshl_b32 s34, s32, 4
    s_add_u32 s34, s34, s35
    v_add_u32 v8, s34, v4
    s_mov_b32 s34, 1280
    v_mul_lo_u32 v8, v8, s34
    v_lshl_add_u32 v8, v3, 4, v8
    s_lshl_b32 s34, s32, 4
    v_add_u32 v9, s34, v4
    v_mul_u32_u24 v9, 1280, v9
    s_add_u32 s20, s4, 16711680
    s_addc_u32 s21, s5, 0
    s_and_b32 s21, s21, 0xffff
    s_mov_b32 s22, 2621440
    s_mov_b32 s23, 0x00020000
    v_and_b32 v3, 15, v1
    v_add_u32 v10, 0, v4
    v_xor_b32 v3, v3, v10
    v_lshl_add_u32 v3, v3, 4, v9
    v_and_b32 v10, 15, v1
    v_add_u32 v10, 0, v10
    v_mov_b32 v11, -1280
    v_cmp_le_u32 vcc, 20, v10
    v_mov_b32 v12, 1280
    v_cndmask_b32 v11, v11, v12, vcc
    v_cmp_le_u32 vcc, 40, v10
    v_mov_b32 v12, -2560
    v_cndmask_b32 v11, v11, v12, vcc
    v_cmp_le_u32 vcc, 60, v10
    v_mov_b32 v12, 2560
    v_cndmask_b32 v11, v11, v12, vcc
    v_add_u32 v11, v11, v8
    v_add_u32 v11, 0, v11
    buffer_load_dwordx4 v[118:121], v11, s[20:23], 0 offen
    v_and_b32 v10, 15, v1
    v_add_u32 v10, 16, v10
    v_mov_b32 v11, -1280
    v_cmp_le_u32 vcc, 20, v10
    v_mov_b32 v12, 1280
    v_cndmask_b32 v11, v11, v12, vcc
    v_cmp_le_u32 vcc, 40, v10
    v_mov_b32 v12, -2560
    v_cndmask_b32 v11, v11, v12, vcc
    v_cmp_le_u32 vcc, 60, v10
    v_mov_b32 v12, 2560
    v_cndmask_b32 v11, v11, v12, vcc
    v_add_u32 v11, v11, v8
    v_add_u32 v11, 256, v11
    buffer_load_dwordx4 v[122:125], v11, s[20:23], 0 offen
    v_and_b32 v10, 15, v1
    v_add_u32 v10, 32, v10
    v_mov_b32 v11, -1280
    v_cmp_le_u32 vcc, 20, v10
    v_mov_b32 v12, 1280
    v_cndmask_b32 v11, v11, v12, vcc
    v_cmp_le_u32 vcc, 40, v10
    v_mov_b32 v12, -2560
    v_cndmask_b32 v11, v11, v12, vcc
    v_cmp_le_u32 vcc, 60, v10
    v_mov_b32 v12, 2560
    v_cndmask_b32 v11, v11, v12, vcc
    v_add_u32 v11, v11, v8
    v_add_u32 v11, 512, v11
    buffer_load_dwordx4 v[126:129], v11, s[20:23], 0 offen
    v_and_b32 v10, 15, v1
    v_add_u32 v10, 48, v10
    v_mov_b32 v11, -1280
    v_cmp_le_u32 vcc, 20, v10
    v_mov_b32 v12, 1280
    v_cndmask_b32 v11, v11, v12, vcc
    v_cmp_le_u32 vcc, 40, v10
    v_mov_b32 v12, -2560
    v_cndmask_b32 v11, v11, v12, vcc
    v_cmp_le_u32 vcc, 60, v10
    v_mov_b32 v12, 2560
    v_cndmask_b32 v11, v11, v12, vcc
    v_add_u32 v11, v11, v8
    v_add_u32 v11, 768, v11
    buffer_load_dwordx4 v[130:133], v11, s[20:23], 0 offen
    v_and_b32 v10, 15, v1
    v_add_u32 v10, 64, v10
    v_mov_b32 v11, -1280
    v_cmp_le_u32 vcc, 20, v10
    v_mov_b32 v12, 1280
    v_cndmask_b32 v11, v11, v12, vcc
    v_cmp_le_u32 vcc, 40, v10
    v_mov_b32 v12, -2560
    v_cndmask_b32 v11, v11, v12, vcc
    v_cmp_le_u32 vcc, 60, v10
    v_mov_b32 v12, 2560
    v_cndmask_b32 v11, v11, v12, vcc
    v_add_u32 v11, v11, v8
    v_add_u32 v11, 1024, v11
    buffer_load_dwordx4 v[134:137], v11, s[20:23], 0 offen
    s_waitcnt vmcnt(0)
    ds_write_b128 v3, v[118:121] offset:0
    ds_write_b128 v3, v[122:125] offset:256
    ds_write_b128 v3, v[126:129] offset:512
    ds_write_b128 v3, v[130:133] offset:768
    ds_write_b128 v3, v[134:137] offset:1024
    s_waitcnt lgkmcnt(0)
    v_and_b32 v3, 15, v1
    v_add_u32 v10, 4, v4
    v_xor_b32 v3, v3, v10
    v_lshl_add_u32 v3, v3, 4, v9
    v_and_b32 v10, 15, v1
    v_add_u32 v10, 0, v10
    v_mov_b32 v11, -1280
    v_cmp_le_u32 vcc, 20, v10
    v_mov_b32 v12, 1280
    v_cndmask_b32 v11, v11, v12, vcc
    v_cmp_le_u32 vcc, 40, v10
    v_mov_b32 v12, -2560
    v_cndmask_b32 v11, v11, v12, vcc
    v_cmp_le_u32 vcc, 60, v10
    v_mov_b32 v12, 2560
    v_cndmask_b32 v11, v11, v12, vcc
    v_add_u32 v11, v11, v8
    v_add_u32 v11, 5120, v11
    buffer_load_dwordx4 v[118:121], v11, s[20:23], 0 offen
    v_and_b32 v10, 15, v1
    v_add_u32 v10, 16, v10
    v_mov_b32 v11, -1280
    v_cmp_le_u32 vcc, 20, v10
    v_mov_b32 v12, 1280
    v_cndmask_b32 v11, v11, v12, vcc
    v_cmp_le_u32 vcc, 40, v10
    v_mov_b32 v12, -2560
    v_cndmask_b32 v11, v11, v12, vcc
    v_cmp_le_u32 vcc, 60, v10
    v_mov_b32 v12, 2560
    v_cndmask_b32 v11, v11, v12, vcc
    v_add_u32 v11, v11, v8
    v_add_u32 v11, 5376, v11
    buffer_load_dwordx4 v[122:125], v11, s[20:23], 0 offen
    v_and_b32 v10, 15, v1
    v_add_u32 v10, 32, v10
    v_mov_b32 v11, -1280
    v_cmp_le_u32 vcc, 20, v10
    v_mov_b32 v12, 1280
    v_cndmask_b32 v11, v11, v12, vcc
    v_cmp_le_u32 vcc, 40, v10
    v_mov_b32 v12, -2560
    v_cndmask_b32 v11, v11, v12, vcc
    v_cmp_le_u32 vcc, 60, v10
    v_mov_b32 v12, 2560
    v_cndmask_b32 v11, v11, v12, vcc
    v_add_u32 v11, v11, v8
    v_add_u32 v11, 5632, v11
    buffer_load_dwordx4 v[126:129], v11, s[20:23], 0 offen
    v_and_b32 v10, 15, v1
    v_add_u32 v10, 48, v10
    v_mov_b32 v11, -1280
    v_cmp_le_u32 vcc, 20, v10
    v_mov_b32 v12, 1280
    v_cndmask_b32 v11, v11, v12, vcc
    v_cmp_le_u32 vcc, 40, v10
    v_mov_b32 v12, -2560
    v_cndmask_b32 v11, v11, v12, vcc
    v_cmp_le_u32 vcc, 60, v10
    v_mov_b32 v12, 2560
    v_cndmask_b32 v11, v11, v12, vcc
    v_add_u32 v11, v11, v8
    v_add_u32 v11, 5888, v11
    buffer_load_dwordx4 v[130:133], v11, s[20:23], 0 offen
    v_and_b32 v10, 15, v1
    v_add_u32 v10, 64, v10
    v_mov_b32 v11, -1280
    v_cmp_le_u32 vcc, 20, v10
    v_mov_b32 v12, 1280
    v_cndmask_b32 v11, v11, v12, vcc
    v_cmp_le_u32 vcc, 40, v10
    v_mov_b32 v12, -2560
    v_cndmask_b32 v11, v11, v12, vcc
    v_cmp_le_u32 vcc, 60, v10
    v_mov_b32 v12, 2560
    v_cndmask_b32 v11, v11, v12, vcc
    v_add_u32 v11, v11, v8
    v_add_u32 v11, 6144, v11
    buffer_load_dwordx4 v[134:137], v11, s[20:23], 0 offen
    s_waitcnt vmcnt(0)
    ds_write_b128 v3, v[118:121] offset:5120
    ds_write_b128 v3, v[122:125] offset:5376
    ds_write_b128 v3, v[126:129] offset:5632
    ds_write_b128 v3, v[130:133] offset:5888
    ds_write_b128 v3, v[134:137] offset:6144
    s_waitcnt lgkmcnt(0)
    v_and_b32 v3, 15, v1
    v_add_u32 v10, 0, v4
    v_xor_b32 v3, v3, v10
    v_lshl_add_u32 v3, v3, 4, v9
    v_and_b32 v10, 15, v1
    v_add_u32 v10, 0, v10
    v_mov_b32 v11, -1280
    v_cmp_le_u32 vcc, 20, v10
    v_mov_b32 v12, 1280
    v_cndmask_b32 v11, v11, v12, vcc
    v_cmp_le_u32 vcc, 40, v10
    v_mov_b32 v12, -2560
    v_cndmask_b32 v11, v11, v12, vcc
    v_cmp_le_u32 vcc, 60, v10
    v_mov_b32 v12, 2560
    v_cndmask_b32 v11, v11, v12, vcc
    v_add_u32 v11, v11, v8
    v_add_u32 v11, 10240, v11
    buffer_load_dwordx4 v[118:121], v11, s[20:23], 0 offen
    v_and_b32 v10, 15, v1
    v_add_u32 v10, 16, v10
    v_mov_b32 v11, -1280
    v_cmp_le_u32 vcc, 20, v10
    v_mov_b32 v12, 1280
    v_cndmask_b32 v11, v11, v12, vcc
    v_cmp_le_u32 vcc, 40, v10
    v_mov_b32 v12, -2560
    v_cndmask_b32 v11, v11, v12, vcc
    v_cmp_le_u32 vcc, 60, v10
    v_mov_b32 v12, 2560
    v_cndmask_b32 v11, v11, v12, vcc
    v_add_u32 v11, v11, v8
    v_add_u32 v11, 10496, v11
    buffer_load_dwordx4 v[122:125], v11, s[20:23], 0 offen
    v_and_b32 v10, 15, v1
    v_add_u32 v10, 32, v10
    v_mov_b32 v11, -1280
    v_cmp_le_u32 vcc, 20, v10
    v_mov_b32 v12, 1280
    v_cndmask_b32 v11, v11, v12, vcc
    v_cmp_le_u32 vcc, 40, v10
    v_mov_b32 v12, -2560
    v_cndmask_b32 v11, v11, v12, vcc
    v_cmp_le_u32 vcc, 60, v10
    v_mov_b32 v12, 2560
    v_cndmask_b32 v11, v11, v12, vcc
    v_add_u32 v11, v11, v8
    v_add_u32 v11, 10752, v11
    buffer_load_dwordx4 v[126:129], v11, s[20:23], 0 offen
    v_and_b32 v10, 15, v1
    v_add_u32 v10, 48, v10
    v_mov_b32 v11, -1280
    v_cmp_le_u32 vcc, 20, v10
    v_mov_b32 v12, 1280
    v_cndmask_b32 v11, v11, v12, vcc
    v_cmp_le_u32 vcc, 40, v10
    v_mov_b32 v12, -2560
    v_cndmask_b32 v11, v11, v12, vcc
    v_cmp_le_u32 vcc, 60, v10
    v_mov_b32 v12, 2560
    v_cndmask_b32 v11, v11, v12, vcc
    v_add_u32 v11, v11, v8
    v_add_u32 v11, 11008, v11
    buffer_load_dwordx4 v[130:133], v11, s[20:23], 0 offen
    v_and_b32 v10, 15, v1
    v_add_u32 v10, 64, v10
    v_mov_b32 v11, -1280
    v_cmp_le_u32 vcc, 20, v10
    v_mov_b32 v12, 1280
    v_cndmask_b32 v11, v11, v12, vcc
    v_cmp_le_u32 vcc, 40, v10
    v_mov_b32 v12, -2560
    v_cndmask_b32 v11, v11, v12, vcc
    v_cmp_le_u32 vcc, 60, v10
    v_mov_b32 v12, 2560
    v_cndmask_b32 v11, v11, v12, vcc
    v_add_u32 v11, v11, v8
    v_add_u32 v11, 11264, v11
    buffer_load_dwordx4 v[134:137], v11, s[20:23], 0 offen
    s_waitcnt vmcnt(0)
    ds_write_b128 v3, v[118:121] offset:10240
    ds_write_b128 v3, v[122:125] offset:10496
    ds_write_b128 v3, v[126:129] offset:10752
    ds_write_b128 v3, v[130:133] offset:11008
    ds_write_b128 v3, v[134:137] offset:11264
    s_waitcnt lgkmcnt(0)
    v_and_b32 v3, 15, v1
    v_add_u32 v10, 4, v4
    v_xor_b32 v3, v3, v10
    v_lshl_add_u32 v3, v3, 4, v9
    v_and_b32 v10, 15, v1
    v_add_u32 v10, 0, v10
    v_mov_b32 v11, -1280
    v_cmp_le_u32 vcc, 20, v10
    v_mov_b32 v12, 1280
    v_cndmask_b32 v11, v11, v12, vcc
    v_cmp_le_u32 vcc, 40, v10
    v_mov_b32 v12, -2560
    v_cndmask_b32 v11, v11, v12, vcc
    v_cmp_le_u32 vcc, 60, v10
    v_mov_b32 v12, 2560
    v_cndmask_b32 v11, v11, v12, vcc
    v_add_u32 v11, v11, v8
    v_add_u32 v11, 15360, v11
    buffer_load_dwordx4 v[118:121], v11, s[20:23], 0 offen
    v_and_b32 v10, 15, v1
    v_add_u32 v10, 16, v10
    v_mov_b32 v11, -1280
    v_cmp_le_u32 vcc, 20, v10
    v_mov_b32 v12, 1280
    v_cndmask_b32 v11, v11, v12, vcc
    v_cmp_le_u32 vcc, 40, v10
    v_mov_b32 v12, -2560
    v_cndmask_b32 v11, v11, v12, vcc
    v_cmp_le_u32 vcc, 60, v10
    v_mov_b32 v12, 2560
    v_cndmask_b32 v11, v11, v12, vcc
    v_add_u32 v11, v11, v8
    v_add_u32 v11, 15616, v11
    buffer_load_dwordx4 v[122:125], v11, s[20:23], 0 offen
    v_and_b32 v10, 15, v1
    v_add_u32 v10, 32, v10
    v_mov_b32 v11, -1280
    v_cmp_le_u32 vcc, 20, v10
    v_mov_b32 v12, 1280
    v_cndmask_b32 v11, v11, v12, vcc
    v_cmp_le_u32 vcc, 40, v10
    v_mov_b32 v12, -2560
    v_cndmask_b32 v11, v11, v12, vcc
    v_cmp_le_u32 vcc, 60, v10
    v_mov_b32 v12, 2560
    v_cndmask_b32 v11, v11, v12, vcc
    v_add_u32 v11, v11, v8
    v_add_u32 v11, 15872, v11
    buffer_load_dwordx4 v[126:129], v11, s[20:23], 0 offen
    v_and_b32 v10, 15, v1
    v_add_u32 v10, 48, v10
    v_mov_b32 v11, -1280
    v_cmp_le_u32 vcc, 20, v10
    v_mov_b32 v12, 1280
    v_cndmask_b32 v11, v11, v12, vcc
    v_cmp_le_u32 vcc, 40, v10
    v_mov_b32 v12, -2560
    v_cndmask_b32 v11, v11, v12, vcc
    v_cmp_le_u32 vcc, 60, v10
    v_mov_b32 v12, 2560
    v_cndmask_b32 v11, v11, v12, vcc
    v_add_u32 v11, v11, v8
    v_add_u32 v11, 16128, v11
    buffer_load_dwordx4 v[130:133], v11, s[20:23], 0 offen
    v_and_b32 v10, 15, v1
    v_add_u32 v10, 64, v10
    v_mov_b32 v11, -1280
    v_cmp_le_u32 vcc, 20, v10
    v_mov_b32 v12, 1280
    v_cndmask_b32 v11, v11, v12, vcc
    v_cmp_le_u32 vcc, 40, v10
    v_mov_b32 v12, -2560
    v_cndmask_b32 v11, v11, v12, vcc
    v_cmp_le_u32 vcc, 60, v10
    v_mov_b32 v12, 2560
    v_cndmask_b32 v11, v11, v12, vcc
    v_add_u32 v11, v11, v8
    v_add_u32 v11, 16384, v11
    buffer_load_dwordx4 v[134:137], v11, s[20:23], 0 offen
    s_waitcnt vmcnt(0)
    ds_write_b128 v3, v[118:121] offset:15360
    ds_write_b128 v3, v[122:125] offset:15616
    ds_write_b128 v3, v[126:129] offset:15872
    ds_write_b128 v3, v[130:133] offset:16128
    ds_write_b128 v3, v[134:137] offset:16384
    s_waitcnt lgkmcnt(0)
mix2_psk0:
    s_waitcnt vmcnt(0) lgkmcnt(0)
    s_barrier
    ds_read_b128 v[118:121], v7 offset:0
    ds_read_b128 v[122:125], v7 offset:20480
    ds_read_b128 v[126:129], v7 offset:40960
    ds_read_b128 v[130:133], v7 offset:61440
    ds_read_b128 v[134:137], v6 offset:0
    ds_read_b128 v[138:141], v6 offset:20480
    ds_read_b128 v[142:145], v6 offset:40960
    ds_read_b128 v[146:149], v6 offset:61440
    s_waitcnt lgkmcnt(4)
    v_mfma_f32_16x16x32_bf16 v[94:97], v[14:17], v[118:121], v[94:97]
    v_mfma_f32_16x16x32_bf16 v[98:101], v[14:17], v[122:125], v[98:101]
    v_mfma_f32_16x16x32_bf16 v[102:105], v[14:17], v[126:129], v[102:105]
    v_mfma_f32_16x16x32_bf16 v[106:109], v[14:17], v[130:133], v[106:109]
    ds_read_b128 v[118:121], v7 offset:128
    ds_read_b128 v[122:125], v7 offset:20608
    ds_read_b128 v[126:129], v7 offset:41088
    ds_read_b128 v[130:133], v7 offset:61568
    s_waitcnt lgkmcnt(4)
    v_mfma_f32_16x16x32_bf16 v[94:97], v[18:21], v[134:137], v[94:97]
    v_mfma_f32_16x16x32_bf16 v[98:101], v[18:21], v[138:141], v[98:101]
    v_mfma_f32_16x16x32_bf16 v[102:105], v[18:21], v[142:145], v[102:105]
    v_mfma_f32_16x16x32_bf16 v[106:109], v[18:21], v[146:149], v[106:109]
    ds_read_b128 v[134:137], v6 offset:128
    ds_read_b128 v[138:141], v6 offset:20608
    ds_read_b128 v[142:145], v6 offset:41088
    ds_read_b128 v[146:149], v6 offset:61568
    s_waitcnt lgkmcnt(4)
    v_mfma_f32_16x16x32_bf16 v[94:97], v[22:25], v[118:121], v[94:97]
    v_mfma_f32_16x16x32_bf16 v[98:101], v[22:25], v[122:125], v[98:101]
    v_mfma_f32_16x16x32_bf16 v[102:105], v[22:25], v[126:129], v[102:105]
    v_mfma_f32_16x16x32_bf16 v[106:109], v[22:25], v[130:133], v[106:109]
    ds_read_b128 v[118:121], v7 offset:256
    ds_read_b128 v[122:125], v7 offset:20736
    ds_read_b128 v[126:129], v7 offset:41216
    ds_read_b128 v[130:133], v7 offset:61696
    s_waitcnt lgkmcnt(4)
    v_mfma_f32_16x16x32_bf16 v[94:97], v[26:29], v[134:137], v[94:97]
    v_mfma_f32_16x16x32_bf16 v[98:101], v[26:29], v[138:141], v[98:101]
    v_mfma_f32_16x16x32_bf16 v[102:105], v[26:29], v[142:145], v[102:105]
    v_mfma_f32_16x16x32_bf16 v[106:109], v[26:29], v[146:149], v[106:109]
    ds_read_b128 v[134:137], v6 offset:256
    ds_read_b128 v[138:141], v6 offset:20736
    ds_read_b128 v[142:145], v6 offset:41216
    ds_read_b128 v[146:149], v6 offset:61696
    s_waitcnt lgkmcnt(4)
    v_mfma_f32_16x16x32_bf16 v[94:97], v[30:33], v[118:121], v[94:97]
    v_mfma_f32_16x16x32_bf16 v[98:101], v[30:33], v[122:125], v[98:101]
    v_mfma_f32_16x16x32_bf16 v[102:105], v[30:33], v[126:129], v[102:105]
    v_mfma_f32_16x16x32_bf16 v[106:109], v[30:33], v[130:133], v[106:109]
    ds_read_b128 v[118:121], v7 offset:384
    ds_read_b128 v[122:125], v7 offset:20864
    ds_read_b128 v[126:129], v7 offset:41344
    ds_read_b128 v[130:133], v7 offset:61824
    s_waitcnt lgkmcnt(4)
    v_mfma_f32_16x16x32_bf16 v[94:97], v[34:37], v[134:137], v[94:97]
    v_mfma_f32_16x16x32_bf16 v[98:101], v[34:37], v[138:141], v[98:101]
    v_mfma_f32_16x16x32_bf16 v[102:105], v[34:37], v[142:145], v[102:105]
    v_mfma_f32_16x16x32_bf16 v[106:109], v[34:37], v[146:149], v[106:109]
    ds_read_b128 v[134:137], v6 offset:384
    ds_read_b128 v[138:141], v6 offset:20864
    ds_read_b128 v[142:145], v6 offset:41344
    ds_read_b128 v[146:149], v6 offset:61824
    s_waitcnt lgkmcnt(4)
    v_mfma_f32_16x16x32_bf16 v[94:97], v[38:41], v[118:121], v[94:97]
    v_mfma_f32_16x16x32_bf16 v[98:101], v[38:41], v[122:125], v[98:101]
    v_mfma_f32_16x16x32_bf16 v[102:105], v[38:41], v[126:129], v[102:105]
    v_mfma_f32_16x16x32_bf16 v[106:109], v[38:41], v[130:133], v[106:109]
    ds_read_b128 v[118:121], v7 offset:512
    ds_read_b128 v[122:125], v7 offset:20992
    ds_read_b128 v[126:129], v7 offset:41472
    ds_read_b128 v[130:133], v7 offset:61952
    s_waitcnt lgkmcnt(4)
    v_mfma_f32_16x16x32_bf16 v[94:97], v[42:45], v[134:137], v[94:97]
    v_mfma_f32_16x16x32_bf16 v[98:101], v[42:45], v[138:141], v[98:101]
    v_mfma_f32_16x16x32_bf16 v[102:105], v[42:45], v[142:145], v[102:105]
    v_mfma_f32_16x16x32_bf16 v[106:109], v[42:45], v[146:149], v[106:109]
    ds_read_b128 v[134:137], v6 offset:512
    ds_read_b128 v[138:141], v6 offset:20992
    ds_read_b128 v[142:145], v6 offset:41472
    ds_read_b128 v[146:149], v6 offset:61952
    s_waitcnt lgkmcnt(4)
    v_mfma_f32_16x16x32_bf16 v[94:97], v[46:49], v[118:121], v[94:97]
    v_mfma_f32_16x16x32_bf16 v[98:101], v[46:49], v[122:125], v[98:101]
    v_mfma_f32_16x16x32_bf16 v[102:105], v[46:49], v[126:129], v[102:105]
    v_mfma_f32_16x16x32_bf16 v[106:109], v[46:49], v[130:133], v[106:109]
    ds_read_b128 v[118:121], v7 offset:640
    ds_read_b128 v[122:125], v7 offset:21120
    ds_read_b128 v[126:129], v7 offset:41600
    ds_read_b128 v[130:133], v7 offset:62080
    s_waitcnt lgkmcnt(4)
    v_mfma_f32_16x16x32_bf16 v[94:97], v[50:53], v[134:137], v[94:97]
    v_mfma_f32_16x16x32_bf16 v[98:101], v[50:53], v[138:141], v[98:101]
    v_mfma_f32_16x16x32_bf16 v[102:105], v[50:53], v[142:145], v[102:105]
    v_mfma_f32_16x16x32_bf16 v[106:109], v[50:53], v[146:149], v[106:109]
    ds_read_b128 v[134:137], v6 offset:640
    ds_read_b128 v[138:141], v6 offset:21120
    ds_read_b128 v[142:145], v6 offset:41600
    ds_read_b128 v[146:149], v6 offset:62080
    s_waitcnt lgkmcnt(4)
    v_mfma_f32_16x16x32_bf16 v[94:97], v[54:57], v[118:121], v[94:97]
    v_mfma_f32_16x16x32_bf16 v[98:101], v[54:57], v[122:125], v[98:101]
    v_mfma_f32_16x16x32_bf16 v[102:105], v[54:57], v[126:129], v[102:105]
    v_mfma_f32_16x16x32_bf16 v[106:109], v[54:57], v[130:133], v[106:109]
    ds_read_b128 v[118:121], v7 offset:768
    ds_read_b128 v[122:125], v7 offset:21248
    ds_read_b128 v[126:129], v7 offset:41728
    ds_read_b128 v[130:133], v7 offset:62208
    s_waitcnt lgkmcnt(4)
    v_mfma_f32_16x16x32_bf16 v[94:97], v[58:61], v[134:137], v[94:97]
    v_mfma_f32_16x16x32_bf16 v[98:101], v[58:61], v[138:141], v[98:101]
    v_mfma_f32_16x16x32_bf16 v[102:105], v[58:61], v[142:145], v[102:105]
    v_mfma_f32_16x16x32_bf16 v[106:109], v[58:61], v[146:149], v[106:109]
    ds_read_b128 v[134:137], v6 offset:768
    ds_read_b128 v[138:141], v6 offset:21248
    ds_read_b128 v[142:145], v6 offset:41728
    ds_read_b128 v[146:149], v6 offset:62208
    s_waitcnt lgkmcnt(4)
    v_mfma_f32_16x16x32_bf16 v[94:97], v[62:65], v[118:121], v[94:97]
    v_mfma_f32_16x16x32_bf16 v[98:101], v[62:65], v[122:125], v[98:101]
    v_mfma_f32_16x16x32_bf16 v[102:105], v[62:65], v[126:129], v[102:105]
    v_mfma_f32_16x16x32_bf16 v[106:109], v[62:65], v[130:133], v[106:109]
    ds_read_b128 v[118:121], v7 offset:896
    ds_read_b128 v[122:125], v7 offset:21376
    ds_read_b128 v[126:129], v7 offset:41856
    ds_read_b128 v[130:133], v7 offset:62336
    s_waitcnt lgkmcnt(4)
    v_mfma_f32_16x16x32_bf16 v[94:97], v[66:69], v[134:137], v[94:97]
    v_mfma_f32_16x16x32_bf16 v[98:101], v[66:69], v[138:141], v[98:101]
    v_mfma_f32_16x16x32_bf16 v[102:105], v[66:69], v[142:145], v[102:105]
    v_mfma_f32_16x16x32_bf16 v[106:109], v[66:69], v[146:149], v[106:109]
    ds_read_b128 v[134:137], v6 offset:896
    ds_read_b128 v[138:141], v6 offset:21376
    ds_read_b128 v[142:145], v6 offset:41856
    ds_read_b128 v[146:149], v6 offset:62336
    s_waitcnt lgkmcnt(4)
    v_mfma_f32_16x16x32_bf16 v[94:97], v[70:73], v[118:121], v[94:97]
    v_mfma_f32_16x16x32_bf16 v[98:101], v[70:73], v[122:125], v[98:101]
    v_mfma_f32_16x16x32_bf16 v[102:105], v[70:73], v[126:129], v[102:105]
    v_mfma_f32_16x16x32_bf16 v[106:109], v[70:73], v[130:133], v[106:109]
    ds_read_b128 v[118:121], v7 offset:1024
    ds_read_b128 v[122:125], v7 offset:21504
    ds_read_b128 v[126:129], v7 offset:41984
    ds_read_b128 v[130:133], v7 offset:62464
    s_waitcnt lgkmcnt(4)
    v_mfma_f32_16x16x32_bf16 v[94:97], v[74:77], v[134:137], v[94:97]
    v_mfma_f32_16x16x32_bf16 v[98:101], v[74:77], v[138:141], v[98:101]
    v_mfma_f32_16x16x32_bf16 v[102:105], v[74:77], v[142:145], v[102:105]
    v_mfma_f32_16x16x32_bf16 v[106:109], v[74:77], v[146:149], v[106:109]
    ds_read_b128 v[134:137], v6 offset:1024
    ds_read_b128 v[138:141], v6 offset:21504
    ds_read_b128 v[142:145], v6 offset:41984
    ds_read_b128 v[146:149], v6 offset:62464
    s_waitcnt lgkmcnt(4)
    v_mfma_f32_16x16x32_bf16 v[94:97], v[78:81], v[118:121], v[94:97]
    v_mfma_f32_16x16x32_bf16 v[98:101], v[78:81], v[122:125], v[98:101]
    v_mfma_f32_16x16x32_bf16 v[102:105], v[78:81], v[126:129], v[102:105]
    v_mfma_f32_16x16x32_bf16 v[106:109], v[78:81], v[130:133], v[106:109]
    ds_read_b128 v[118:121], v7 offset:1152
    ds_read_b128 v[122:125], v7 offset:21632
    ds_read_b128 v[126:129], v7 offset:42112
    ds_read_b128 v[130:133], v7 offset:62592
    s_waitcnt lgkmcnt(4)
    v_mfma_f32_16x16x32_bf16 v[94:97], v[82:85], v[134:137], v[94:97]
    v_mfma_f32_16x16x32_bf16 v[98:101], v[82:85], v[138:141], v[98:101]
    v_mfma_f32_16x16x32_bf16 v[102:105], v[82:85], v[142:145], v[102:105]
    v_mfma_f32_16x16x32_bf16 v[106:109], v[82:85], v[146:149], v[106:109]
    ds_read_b128 v[134:137], v6 offset:1152
    ds_read_b128 v[138:141], v6 offset:21632
    ds_read_b128 v[142:145], v6 offset:42112
    ds_read_b128 v[146:149], v6 offset:62592
    s_waitcnt lgkmcnt(4)
    v_mfma_f32_16x16x32_bf16 v[94:97], v[86:89], v[118:121], v[94:97]
    v_mfma_f32_16x16x32_bf16 v[98:101], v[86:89], v[122:125], v[98:101]
    v_mfma_f32_16x16x32_bf16 v[102:105], v[86:89], v[126:129], v[102:105]
    v_mfma_f32_16x16x32_bf16 v[106:109], v[86:89], v[130:133], v[106:109]
    s_waitcnt lgkmcnt(0)
    v_mfma_f32_16x16x32_bf16 v[94:97], v[90:93], v[134:137], v[94:97]
    v_mfma_f32_16x16x32_bf16 v[98:101], v[90:93], v[138:141], v[98:101]
    v_mfma_f32_16x16x32_bf16 v[102:105], v[90:93], v[142:145], v[102:105]
    v_mfma_f32_16x16x32_bf16 v[106:109], v[90:93], v[146:149], v[106:109]
    s_nop 7
    s_nop 7
    v_lshlrev_b32 v118, 16, v110
    v_add_f32 v94, v94, v118
    v_and_b32 v118, 0xffff0000, v110
    v_add_f32 v95, v95, v118
    v_lshlrev_b32 v118, 16, v111
    v_add_f32 v96, v96, v118
    v_and_b32 v118, 0xffff0000, v111
    v_add_f32 v97, v97, v118
    v_cvt_pk_bf16_f32 v94, v94, v95
    v_cvt_pk_bf16_f32 v95, v96, v97
    s_mov_b32 s34, 19333120
    buffer_store_dwordx2 v[94:95], v5, s[8:11], s34 offen
    v_lshlrev_b32 v118, 16, v112
    v_add_f32 v98, v98, v118
    v_and_b32 v118, 0xffff0000, v112
    v_add_f32 v99, v99, v118
    v_lshlrev_b32 v118, 16, v113
    v_add_f32 v100, v100, v118
    v_and_b32 v118, 0xffff0000, v113
    v_add_f32 v101, v101, v118
    v_cvt_pk_bf16_f32 v98, v98, v99
    v_cvt_pk_bf16_f32 v99, v100, v101
    s_mov_b32 s34, 19353600
    buffer_store_dwordx2 v[98:99], v5, s[8:11], s34 offen
    v_lshlrev_b32 v118, 16, v114
    v_add_f32 v102, v102, v118
    v_and_b32 v118, 0xffff0000, v114
    v_add_f32 v103, v103, v118
    v_lshlrev_b32 v118, 16, v115
    v_add_f32 v104, v104, v118
    v_and_b32 v118, 0xffff0000, v115
    v_add_f32 v105, v105, v118
    v_cvt_pk_bf16_f32 v102, v102, v103
    v_cvt_pk_bf16_f32 v103, v104, v105
    s_mov_b32 s34, 19374080
    buffer_store_dwordx2 v[102:103], v5, s[8:11], s34 offen
    v_lshlrev_b32 v118, 16, v116
    v_add_f32 v106, v106, v118
    v_and_b32 v118, 0xffff0000, v116
    v_add_f32 v107, v107, v118
    v_lshlrev_b32 v118, 16, v117
    v_add_f32 v108, v108, v118
    v_and_b32 v118, 0xffff0000, v117
    v_add_f32 v109, v109, v118
    v_cvt_pk_bf16_f32 v106, v106, v107
    v_cvt_pk_bf16_f32 v107, v108, v109
    s_mov_b32 s34, 19394560
    buffer_store_dwordx2 v[106:107], v5, s[8:11], s34 offen
mix2_done:
    s_endpgm
.globl mlp1_kernel
.p2align 8
.type mlp1_kernel,@function
mlp1_kernel:
    s_cmp_ge_u32 s2, 512
    s_cbranch_scc1 mlp1_done
    s_load_dwordx2 s[4:5], s[0:1], 80
    s_load_dwordx2 s[6:7], s[0:1], 0
    s_load_dwordx2 s[28:29], s[0:1], 64
    s_mul_hi_u32 s30, s2, 268435457
    s_mul_i32 s31, s30, 16
    s_sub_u32 s31, s2, s31
    v_lshrrev_b32 v1, 6, v0
    s_nop 0
    v_readfirstlane_b32 s32, v1
    v_and_b32 v1, 63, v0
    s_waitcnt lgkmcnt(0)
    s_mov_b32 s8, s4
    s_mov_b32 s9, s5
    s_and_b32 s9, s9, 0xffff
    s_mov_b32 s10, 268435456
    s_mov_b32 s11, 0x00020000
    s_mov_b32 s12, s6
    s_mov_b32 s13, s7
    s_and_b32 s13, s13, 0xffff
    s_mov_b32 s14, 2621440
    s_mov_b32 s15, 0x00020000
    s_mov_b32 s16, s28
    s_mov_b32 s17, s29
    s_and_b32 s17, s17, 0xffff
    s_mov_b32 s18, 2621440
    s_mov_b32 s19, 0x00020000
    s_mul_i32 s33, s31, 6
    s_add_u32 s33, s33, s32
    s_mul_i32 s33, s33, 20480
    s_add_u32 s33, s33, 4096000
    v_lshlrev_b32 v2, 4, v1
    s_add_u32 s34, s33, 0
    buffer_load_dwordx4 v[14:17], v2, s[8:11], s34 offen
    s_add_u32 s34, s33, 1024
    buffer_load_dwordx4 v[18:21], v2, s[8:11], s34 offen
    s_add_u32 s34, s33, 2048
    buffer_load_dwordx4 v[22:25], v2, s[8:11], s34 offen
    s_add_u32 s34, s33, 3072
    buffer_load_dwordx4 v[26:29], v2, s[8:11], s34 offen
    s_add_u32 s34, s33, 4096
    buffer_load_dwordx4 v[30:33], v2, s[8:11], s34 offen
    s_add_u32 s34, s33, 5120
    buffer_load_dwordx4 v[34:37], v2, s[8:11], s34 offen
    s_add_u32 s34, s33, 6144
    buffer_load_dwordx4 v[38:41], v2, s[8:11], s34 offen
    s_add_u32 s34, s33, 7168
    buffer_load_dwordx4 v[42:45], v2, s[8:11], s34 offen
    s_add_u32 s34, s33, 8192
    buffer_load_dwordx4 v[46:49], v2, s[8:11], s34 offen
    s_add_u32 s34, s33, 9216
    buffer_load_dwordx4 v[50:53], v2, s[8:11], s34 offen
    s_add_u32 s34, s33, 10240
    buffer_load_dwordx4 v[54:57], v2, s[8:11], s34 offen
    s_add_u32 s34, s33, 11264
    buffer_load_dwordx4 v[58:61], v2, s[8:11], s34 offen
    s_add_u32 s34, s33, 12288
    buffer_load_dwordx4 v[62:65], v2, s[8:11], s34 offen
    s_add_u32 s34, s33, 13312
    buffer_load_dwordx4 v[66:69], v2, s[8:11], s34 offen
    s_add_u32 s34, s33, 14336
    buffer_load_dwordx4 v[70:73], v2, s[8:11], s34 offen
    s_add_u32 s34, s33, 15360
    buffer_load_dwordx4 v[74:77], v2, s[8:11], s34 offen
    s_add_u32 s34, s33, 16384
    buffer_load_dwordx4 v[78:81], v2, s[8:11], s34 offen
    s_add_u32 s34, s33, 17408
    buffer_load_dwordx4 v[82:85], v2, s[8:11], s34 offen
    s_add_u32 s34, s33, 18432
    buffer_load_dwordx4 v[86:89], v2, s[8:11], s34 offen
    s_add_u32 s34, s33, 19456
    buffer_load_dwordx4 v[90:93], v2, s[8:11], s34 offen
    v_and_b32 v3, 15, v1
    v_lshrrev_b32 v4, 4, v1
    s_lshl_b32 s35, s30, 6
    v_add_u32 v5, s35, v3
    s_mov_b32 s36, 3072
    v_mul_lo_u32 v5, v5, s36
    s_mul_i32 s36, s31, 192
    s_mul_i32 s37, s32, 32
    s_add_u32 s36, s36, s37
    v_lshl_add_u32 v5, v4, 3, v5
    v_add_u32 v5, s36, v5
    v_and_b32 v6, 7, v1
    v_xor_b32 v7, v4, v6
    v_or_b32 v6, 4, v4
    v_and_b32 v3, 7, v1
    v_xor_b32 v6, v6, v3
    v_and_b32 v3, 15, v1
    v_mul_u32_u24 v3, 1280, v3
    v_lshl_add_u32 v7, v7, 4, v3
    v_lshl_add_u32 v6, v6, 4, v3
    v_mov_b32 v94, 0
    v_mov_b32 v95, 0
    v_mov_b32 v96, 0
    v_mov_b32 v97, 0
    v_mov_b32 v98, 0
    v_mov_b32 v99, 0
    v_mov_b32 v100, 0
    v_mov_b32 v101, 0
    v_mov_b32 v102, 0
    v_mov_b32 v103, 0
    v_mov_b32 v104, 0
    v_mov_b32 v105, 0
    v_mov_b32 v106, 0
    v_mov_b32 v107, 0
    v_mov_b32 v108, 0
    v_mov_b32 v109, 0
    s_cmp_ge_u32 s32, 4
    s_cbranch_scc1 mlp1_psk0
    v_and_b32 v3, 15, v1
    s_lshl_b32 s34, s32, 4
    s_add_u32 s34, s34, s35
    v_add_u32 v8, s34, v4
    s_mov_b32 s34, 1280
    v_mul_lo_u32 v8, v8, s34
    v_lshl_add_u32 v8, v3, 4, v8
    s_lshl_b32 s34, s32, 4
    v_add_u32 v9, s34, v4
    v_mul_u32_u24 v9, 1280, v9
    s_mov_b32 s34, 19333120
    buffer_load_dwordx4 v[110:113], v8, s[8:11], s34 offen
    s_mov_b32 s34, 19333376
    buffer_load_dwordx4 v[114:117], v8, s[8:11], s34 offen
    s_mov_b32 s34, 19333632
    buffer_load_dwordx4 v[118:121], v8, s[8:11], s34 offen
    s_mov_b32 s34, 19333888
    buffer_load_dwordx4 v[122:125], v8, s[8:11], s34 offen
    s_mov_b32 s34, 19334144
    buffer_load_dwordx4 v[126:129], v8, s[8:11], s34 offen
    s_mov_b32 s34, 19338240
    buffer_load_dwordx4 v[130:133], v8, s[8:11], s34 offen
    s_mov_b32 s34, 19338496
    buffer_load_dwordx4 v[134:137], v8, s[8:11], s34 offen
    s_mov_b32 s34, 19338752
    buffer_load_dwordx4 v[138:141], v8, s[8:11], s34 offen
    s_mov_b32 s34, 19339008
    buffer_load_dwordx4 v[142:145], v8, s[8:11], s34 offen
    s_mov_b32 s34, 19339264
    buffer_load_dwordx4 v[146:149], v8, s[8:11], s34 offen
    s_mov_b32 s34, 19343360
    buffer_load_dwordx4 v[150:153], v8, s[8:11], s34 offen
    s_mov_b32 s34, 19343616
    buffer_load_dwordx4 v[154:157], v8, s[8:11], s34 offen
    s_mov_b32 s34, 19343872
    buffer_load_dwordx4 v[158:161], v8, s[8:11], s34 offen
    s_mov_b32 s34, 19344128
    buffer_load_dwordx4 v[162:165], v8, s[8:11], s34 offen
    s_mov_b32 s34, 19344384
    buffer_load_dwordx4 v[166:169], v8, s[8:11], s34 offen
    s_mov_b32 s34, 19348480
    buffer_load_dwordx4 v[170:173], v8, s[8:11], s34 offen
    s_mov_b32 s34, 19348736
    buffer_load_dwordx4 v[174:177], v8, s[8:11], s34 offen
    s_mov_b32 s34, 19348992
    buffer_load_dwordx4 v[178:181], v8, s[8:11], s34 offen
    s_mov_b32 s34, 19349248
    buffer_load_dwordx4 v[182:185], v8, s[8:11], s34 offen
    s_mov_b32 s34, 19349504
    buffer_load_dwordx4 v[186:189], v8, s[8:11], s34 offen
    s_waitcnt vmcnt(15)
    v_lshlrev_b32 v190, 16, v110
    v_and_b32 v191, 0xffff0000, v110
    v_lshlrev_b32 v192, 16, v111
    v_and_b32 v193, 0xffff0000, v111
    v_lshlrev_b32 v194, 16, v112
    v_and_b32 v195, 0xffff0000, v112
    v_lshlrev_b32 v196, 16, v113
    v_and_b32 v197, 0xffff0000, v113
    v_lshlrev_b32 v198, 16, v114
    v_and_b32 v199, 0xffff0000, v114
    v_lshlrev_b32 v200, 16, v115
    v_and_b32 v201, 0xffff0000, v115
    v_lshlrev_b32 v202, 16, v116
    v_and_b32 v203, 0xffff0000, v116
    v_lshlrev_b32 v204, 16, v117
    v_and_b32 v205, 0xffff0000, v117
    v_lshlrev_b32 v206, 16, v118
    v_and_b32 v207, 0xffff0000, v118
    v_lshlrev_b32 v208, 16, v119
    v_and_b32 v209, 0xffff0000, v119
    v_lshlrev_b32 v210, 16, v120
    v_and_b32 v211, 0xffff0000, v120
    v_lshlrev_b32 v212, 16, v121
    v_and_b32 v213, 0xffff0000, v121
    v_lshlrev_b32 v214, 16, v122
    v_and_b32 v215, 0xffff0000, v122
    v_lshlrev_b32 v216, 16, v123
    v_and_b32 v217, 0xffff0000, v123
    v_lshlrev_b32 v218, 16, v124
    v_and_b32 v219, 0xffff0000, v124
    v_lshlrev_b32 v220, 16, v125
    v_and_b32 v221, 0xffff0000, v125
    v_lshlrev_b32 v222, 16, v126
    v_and_b32 v223, 0xffff0000, v126
    v_lshlrev_b32 v224, 16, v127
    v_and_b32 v225, 0xffff0000, v127
    v_lshlrev_b32 v226, 16, v128
    v_and_b32 v227, 0xffff0000, v128
    v_lshlrev_b32 v228, 16, v129
    v_and_b32 v229, 0xffff0000, v129
    v_add_f32 v230, v190, v191
    v_add_f32 v230, v230, v192
    v_add_f32 v230, v230, v193
    v_add_f32 v230, v230, v194
    v_add_f32 v230, v230, v195
    v_add_f32 v230, v230, v196
    v_add_f32 v230, v230, v197
    v_add_f32 v230, v230, v198
    v_add_f32 v230, v230, v199
    v_add_f32 v230, v230, v200
    v_add_f32 v230, v230, v201
    v_add_f32 v230, v230, v202
    v_add_f32 v230, v230, v203
    v_add_f32 v230, v230, v204
    v_add_f32 v230, v230, v205
    v_add_f32 v230, v230, v206
    v_add_f32 v230, v230, v207
    v_add_f32 v230, v230, v208
    v_add_f32 v230, v230, v209
    v_add_f32 v230, v230, v210
    v_add_f32 v230, v230, v211
    v_add_f32 v230, v230, v212
    v_add_f32 v230, v230, v213
    v_add_f32 v230, v230, v214
    v_add_f32 v230, v230, v215
    v_add_f32 v230, v230, v216
    v_add_f32 v230, v230, v217
    v_add_f32 v230, v230, v218
    v_add_f32 v230, v230, v219
    v_add_f32 v230, v230, v220
    v_add_f32 v230, v230, v221
    v_add_f32 v230, v230, v222
    v_add_f32 v230, v230, v223
    v_add_f32 v230, v230, v224
    v_add_f32 v230, v230, v225
    v_add_f32 v230, v230, v226
    v_add_f32 v230, v230, v227
    v_add_f32 v230, v230, v228
    v_add_f32 v230, v230, v229
    s_nop 1
    v_add_f32_dpp v230, v230, v230 row_ror:8 row_mask:0xf bank_mask:0xf
    s_nop 1
    v_add_f32_dpp v230, v230, v230 row_ror:4 row_mask:0xf bank_mask:0xf
    s_nop 1
    v_add_f32_dpp v230, v230, v230 row_ror:2 row_mask:0xf bank_mask:0xf
    s_nop 1
    v_add_f32_dpp v230, v230, v230 row_ror:1 row_mask:0xf bank_mask:0xf
    v_mul_f32 v230, 0.0015625, v230
    v_sub_f32 v190, v190, v230
    v_sub_f32 v191, v191, v230
    v_sub_f32 v192, v192, v230
    v_sub_f32 v193, v193, v230
    v_sub_f32 v194, v194, v230
    v_sub_f32 v195, v195, v230
    v_sub_f32 v196, v196, v230
    v_sub_f32 v197, v197, v230
    v_sub_f32 v198, v198, v230
    v_sub_f32 v199, v199, v230
    v_sub_f32 v200, v200, v230
    v_sub_f32 v201, v201, v230
    v_sub_f32 v202, v202, v230
    v_sub_f32 v203, v203, v230
    v_sub_f32 v204, v204, v230
    v_sub_f32 v205, v205, v230
    v_sub_f32 v206, v206, v230
    v_sub_f32 v207, v207, v230
    v_sub_f32 v208, v208, v230
    v_sub_f32 v209, v209, v230
    v_sub_f32 v210, v210, v230
    v_sub_f32 v211, v211, v230
    v_sub_f32 v212, v212, v230
    v_sub_f32 v213, v213, v230
    v_sub_f32 v214, v214, v230
    v_sub_f32 v215, v215, v230
    v_sub_f32 v216, v216, v230
    v_sub_f32 v217, v217, v230
    v_sub_f32 v218, v218, v230
    v_sub_f32 v219, v219, v230
    v_sub_f32 v220, v220, v230
    v_sub_f32 v221, v221, v230
    v_sub_f32 v222, v222, v230
    v_sub_f32 v223, v223, v230
    v_sub_f32 v224, v224, v230
    v_sub_f32 v225, v225, v230
    v_sub_f32 v226, v226, v230
    v_sub_f32 v227, v227, v230
    v_sub_f32 v228, v228, v230
    v_sub_f32 v229, v229, v230
    v_mul_f32 v230, v190, v190
    v_fmac_f32 v230, v191, v191
    v_fmac_f32 v230, v192, v192
    v_fmac_f32 v230, v193, v193
    v_fmac_f32 v230, v194, v194
    v_fmac_f32 v230, v195, v195
    v_fmac_f32 v230, v196, v196
    v_fmac_f32 v230, v197, v197
    v_fmac_f32 v230, v198, v198
    v_fmac_f32 v230, v199, v199
    v_fmac_f32 v230, v200, v200
    v_fmac_f32 v230, v201, v201
    v_fmac_f32 v230, v202, v202
    v_fmac_f32 v230, v203, v203
    v_fmac_f32 v230, v204, v204
    v_fmac_f32 v230, v205, v205
    v_fmac_f32 v230, v206, v206
    v_fmac_f32 v230, v207, v207
    v_fmac_f32 v230, v208, v208
    v_fmac_f32 v230, v209, v209
    v_fmac_f32 v230, v210, v210
    v_fmac_f32 v230, v211, v211
    v_fmac_f32 v230, v212, v212
    v_fmac_f32 v230, v213, v213
    v_fmac_f32 v230, v214, v214
    v_fmac_f32 v230, v215, v215
    v_fmac_f32 v230, v216, v216
    v_fmac_f32 v230, v217, v217
    v_fmac_f32 v230, v218, v218
    v_fmac_f32 v230, v219, v219
    v_fmac_f32 v230, v220, v220
    v_fmac_f32 v230, v221, v221
    v_fmac_f32 v230, v222, v222
    v_fmac_f32 v230, v223, v223
    v_fmac_f32 v230, v224, v224
    v_fmac_f32 v230, v225, v225
    v_fmac_f32 v230, v226, v226
    v_fmac_f32 v230, v227, v227
    v_fmac_f32 v230, v228, v228
    v_fmac_f32 v230, v229, v229
    s_nop 1
    v_add_f32_dpp v230, v230, v230 row_ror:8 row_mask:0xf bank_mask:0xf
    s_nop 1
    v_add_f32_dpp v230, v230, v230 row_ror:4 row_mask:0xf bank_mask:0xf
    s_nop 1
    v_add_f32_dpp v230, v230, v230 row_ror:2 row_mask:0xf bank_mask:0xf
    s_nop 1
    v_add_f32_dpp v230, v230, v230 row_ror:1 row_mask:0xf bank_mask:0xf
    v_mov_b32 v231, 0x3727c5ac
    v_fmac_f32 v231, 0.0015625, v230
    v_rsq_f32 v231, v231
    s_nop 0
    v_mul_f32 v190, v190, v231
    v_mul_f32 v191, v191, v231
    v_mul_f32 v192, v192, v231
    v_mul_f32 v193, v193, v231
    v_mul_f32 v194, v194, v231
    v_mul_f32 v195, v195, v231
    v_mul_f32 v196, v196, v231
    v_mul_f32 v197, v197, v231
    v_mul_f32 v198, v198, v231
    v_mul_f32 v199, v199, v231
    v_mul_f32 v200, v200, v231
    v_mul_f32 v201, v201, v231
    v_mul_f32 v202, v202, v231
    v_mul_f32 v203, v203, v231
    v_mul_f32 v204, v204, v231
    v_mul_f32 v205, v205, v231
    v_mul_f32 v206, v206, v231
    v_mul_f32 v207, v207, v231
    v_mul_f32 v208, v208, v231
    v_mul_f32 v209, v209, v231
    v_mul_f32 v210, v210, v231
    v_mul_f32 v211, v211, v231
    v_mul_f32 v212, v212, v231
    v_mul_f32 v213, v213, v231
    v_mul_f32 v214, v214, v231
    v_mul_f32 v215, v215, v231
    v_mul_f32 v216, v216, v231
    v_mul_f32 v217, v217, v231
    v_mul_f32 v218, v218, v231
    v_mul_f32 v219, v219, v231
    v_mul_f32 v220, v220, v231
    v_mul_f32 v221, v221, v231
    v_mul_f32 v222, v222, v231
    v_mul_f32 v223, v223, v231
    v_mul_f32 v224, v224, v231
    v_mul_f32 v225, v225, v231
    v_mul_f32 v226, v226, v231
    v_mul_f32 v227, v227, v231
    v_mul_f32 v228, v228, v231
    v_mul_f32 v229, v229, v231
    v_and_b32 v3, 15, v1
    v_add_u32 v10, 0, v4
    v_xor_b32 v3, v3, v10
    v_lshl_add_u32 v3, v3, 4, v9
    v_cvt_pk_bf16_f32 v190, v190, v191
    v_cvt_pk_bf16_f32 v191, v192, v193
    v_cvt_pk_bf16_f32 v192, v194, v195
    v_cvt_pk_bf16_f32 v193, v196, v197
    ds_write_b128 v3, v[190:193] offset:0
    v_cvt_pk_bf16_f32 v198, v198, v199
    v_cvt_pk_bf16_f32 v199, v200, v201
    v_cvt_pk_bf16_f32 v200, v202, v203
    v_cvt_pk_bf16_f32 v201, v204, v205
    ds_write_b128 v3, v[198:201] offset:256
    v_cvt_pk_bf16_f32 v206, v206, v207
    v_cvt_pk_bf16_f32 v207, v208, v209
    v_cvt_pk_bf16_f32 v208, v210, v211
    v_cvt_pk_bf16_f32 v209, v212, v213
    ds_write_b128 v3, v[206:209] offset:512
    v_cvt_pk_bf16_f32 v214, v214, v215
    v_cvt_pk_bf16_f32 v215, v216, v217
    v_cvt_pk_bf16_f32 v216, v218, v219
    v_cvt_pk_bf16_f32 v217, v220, v221
    ds_write_b128 v3, v[214:217] offset:768
    v_cvt_pk_bf16_f32 v222, v222, v223
    v_cvt_pk_bf16_f32 v223, v224, v225
    v_cvt_pk_bf16_f32 v224, v226, v227
    v_cvt_pk_bf16_f32 v225, v228, v229
    ds_write_b128 v3, v[222:225] offset:1024
    s_nop 0
    s_waitcnt vmcnt(10)
    v_lshlrev_b32 v190, 16, v130
    v_and_b32 v191, 0xffff0000, v130
    v_lshlrev_b32 v192, 16, v131
    v_and_b32 v193, 0xffff0000, v131
    v_lshlrev_b32 v194, 16, v132
    v_and_b32 v195, 0xffff0000, v132
    v_lshlrev_b32 v196, 16, v133
    v_and_b32 v197, 0xffff0000, v133
    v_lshlrev_b32 v198, 16, v134
    v_and_b32 v199, 0xffff0000, v134
    v_lshlrev_b32 v200, 16, v135
    v_and_b32 v201, 0xffff0000, v135
    v_lshlrev_b32 v202, 16, v136
    v_and_b32 v203, 0xffff0000, v136
    v_lshlrev_b32 v204, 16, v137
    v_and_b32 v205, 0xffff0000, v137
    v_lshlrev_b32 v206, 16, v138
    v_and_b32 v207, 0xffff0000, v138
    v_lshlrev_b32 v208, 16, v139
    v_and_b32 v209, 0xffff0000, v139
    v_lshlrev_b32 v210, 16, v140
    v_and_b32 v211, 0xffff0000, v140
    v_lshlrev_b32 v212, 16, v141
    v_and_b32 v213, 0xffff0000, v141
    v_lshlrev_b32 v214, 16, v142
    v_and_b32 v215, 0xffff0000, v142
    v_lshlrev_b32 v216, 16, v143
    v_and_b32 v217, 0xffff0000, v143
    v_lshlrev_b32 v218, 16, v144
    v_and_b32 v219, 0xffff0000, v144
    v_lshlrev_b32 v220, 16, v145
    v_and_b32 v221, 0xffff0000, v145
    v_lshlrev_b32 v222, 16, v146
    v_and_b32 v223, 0xffff0000, v146
    v_lshlrev_b32 v224, 16, v147
    v_and_b32 v225, 0xffff0000, v147
    v_lshlrev_b32 v226, 16, v148
    v_and_b32 v227, 0xffff0000, v148
    v_lshlrev_b32 v228, 16, v149
    v_and_b32 v229, 0xffff0000, v149
    v_add_f32 v230, v190, v191
    v_add_f32 v230, v230, v192
    v_add_f32 v230, v230, v193
    v_add_f32 v230, v230, v194
    v_add_f32 v230, v230, v195
    v_add_f32 v230, v230, v196
    v_add_f32 v230, v230, v197
    v_add_f32 v230, v230, v198
    v_add_f32 v230, v230, v199
    v_add_f32 v230, v230, v200
    v_add_f32 v230, v230, v201
    v_add_f32 v230, v230, v202
    v_add_f32 v230, v230, v203
    v_add_f32 v230, v230, v204
    v_add_f32 v230, v230, v205
    v_add_f32 v230, v230, v206
    v_add_f32 v230, v230, v207
    v_add_f32 v230, v230, v208
    v_add_f32 v230, v230, v209
    v_add_f32 v230, v230, v210
    v_add_f32 v230, v230, v211
    v_add_f32 v230, v230, v212
    v_add_f32 v230, v230, v213
    v_add_f32 v230, v230, v214
    v_add_f32 v230, v230, v215
    v_add_f32 v230, v230, v216
    v_add_f32 v230, v230, v217
    v_add_f32 v230, v230, v218
    v_add_f32 v230, v230, v219
    v_add_f32 v230, v230, v220
    v_add_f32 v230, v230, v221
    v_add_f32 v230, v230, v222
    v_add_f32 v230, v230, v223
    v_add_f32 v230, v230, v224
    v_add_f32 v230, v230, v225
    v_add_f32 v230, v230, v226
    v_add_f32 v230, v230, v227
    v_add_f32 v230, v230, v228
    v_add_f32 v230, v230, v229
    s_nop 1
    v_add_f32_dpp v230, v230, v230 row_ror:8 row_mask:0xf bank_mask:0xf
    s_nop 1
    v_add_f32_dpp v230, v230, v230 row_ror:4 row_mask:0xf bank_mask:0xf
    s_nop 1
    v_add_f32_dpp v230, v230, v230 row_ror:2 row_mask:0xf bank_mask:0xf
    s_nop 1
    v_add_f32_dpp v230, v230, v230 row_ror:1 row_mask:0xf bank_mask:0xf
    v_mul_f32 v230, 0.0015625, v230
    v_sub_f32 v190, v190, v230
    v_sub_f32 v191, v191, v230
    v_sub_f32 v192, v192, v230
    v_sub_f32 v193, v193, v230
    v_sub_f32 v194, v194, v230
    v_sub_f32 v195, v195, v230
    v_sub_f32 v196, v196, v230
    v_sub_f32 v197, v197, v230
    v_sub_f32 v198, v198, v230
    v_sub_f32 v199, v199, v230
    v_sub_f32 v200, v200, v230
    v_sub_f32 v201, v201, v230
    v_sub_f32 v202, v202, v230
    v_sub_f32 v203, v203, v230
    v_sub_f32 v204, v204, v230
    v_sub_f32 v205, v205, v230
    v_sub_f32 v206, v206, v230
    v_sub_f32 v207, v207, v230
    v_sub_f32 v208, v208, v230
    v_sub_f32 v209, v209, v230
    v_sub_f32 v210, v210, v230
    v_sub_f32 v211, v211, v230
    v_sub_f32 v212, v212, v230
    v_sub_f32 v213, v213, v230
    v_sub_f32 v214, v214, v230
    v_sub_f32 v215, v215, v230
    v_sub_f32 v216, v216, v230
    v_sub_f32 v217, v217, v230
    v_sub_f32 v218, v218, v230
    v_sub_f32 v219, v219, v230
    v_sub_f32 v220, v220, v230
    v_sub_f32 v221, v221, v230
    v_sub_f32 v222, v222, v230
    v_sub_f32 v223, v223, v230
    v_sub_f32 v224, v224, v230
    v_sub_f32 v225, v225, v230
    v_sub_f32 v226, v226, v230
    v_sub_f32 v227, v227, v230
    v_sub_f32 v228, v228, v230
    v_sub_f32 v229, v229, v230
    v_mul_f32 v230, v190, v190
    v_fmac_f32 v230, v191, v191
    v_fmac_f32 v230, v192, v192
    v_fmac_f32 v230, v193, v193
    v_fmac_f32 v230, v194, v194
    v_fmac_f32 v230, v195, v195
    v_fmac_f32 v230, v196, v196
    v_fmac_f32 v230, v197, v197
    v_fmac_f32 v230, v198, v198
    v_fmac_f32 v230, v199, v199
    v_fmac_f32 v230, v200, v200
    v_fmac_f32 v230, v201, v201
    v_fmac_f32 v230, v202, v202
    v_fmac_f32 v230, v203, v203
    v_fmac_f32 v230, v204, v204
    v_fmac_f32 v230, v205, v205
    v_fmac_f32 v230, v206, v206
    v_fmac_f32 v230, v207, v207
    v_fmac_f32 v230, v208, v208
    v_fmac_f32 v230, v209, v209
    v_fmac_f32 v230, v210, v210
    v_fmac_f32 v230, v211, v211
    v_fmac_f32 v230, v212, v212
    v_fmac_f32 v230, v213, v213
    v_fmac_f32 v230, v214, v214
    v_fmac_f32 v230, v215, v215
    v_fmac_f32 v230, v216, v216
    v_fmac_f32 v230, v217, v217
    v_fmac_f32 v230, v218, v218
    v_fmac_f32 v230, v219, v219
    v_fmac_f32 v230, v220, v220
    v_fmac_f32 v230, v221, v221
    v_fmac_f32 v230, v222, v222
    v_fmac_f32 v230, v223, v223
    v_fmac_f32 v230, v224, v224
    v_fmac_f32 v230, v225, v225
    v_fmac_f32 v230, v226, v226
    v_fmac_f32 v230, v227, v227
    v_fmac_f32 v230, v228, v228
    v_fmac_f32 v230, v229, v229
    s_nop 1
    v_add_f32_dpp v230, v230, v230 row_ror:8 row_mask:0xf bank_mask:0xf
    s_nop 1
    v_add_f32_dpp v230, v230, v230 row_ror:4 row_mask:0xf bank_mask:0xf
    s_nop 1
    v_add_f32_dpp v230, v230, v230 row_ror:2 row_mask:0xf bank_mask:0xf
    s_nop 1
    v_add_f32_dpp v230, v230, v230 row_ror:1 row_mask:0xf bank_mask:0xf
    v_mov_b32 v231, 0x3727c5ac
    v_fmac_f32 v231, 0.0015625, v230
    v_rsq_f32 v231, v231
    s_nop 0
    v_mul_f32 v190, v190, v231
    v_mul_f32 v191, v191, v231
    v_mul_f32 v192, v192, v231
    v_mul_f32 v193, v193, v231
    v_mul_f32 v194, v194, v231
    v_mul_f32 v195, v195, v231
    v_mul_f32 v196, v196, v231
    v_mul_f32 v197, v197, v231
    v_mul_f32 v198, v198, v231
    v_mul_f32 v199, v199, v231
    v_mul_f32 v200, v200, v231
    v_mul_f32 v201, v201, v231
    v_mul_f32 v202, v202, v231
    v_mul_f32 v203, v203, v231
    v_mul_f32 v204, v204, v231
    v_mul_f32 v205, v205, v231
    v_mul_f32 v206, v206, v231
    v_mul_f32 v207, v207, v231
    v_mul_f32 v208, v208, v231
    v_mul_f32 v209, v209, v231
    v_mul_f32 v210, v210, v231
    v_mul_f32 v211, v211, v231
    v_mul_f32 v212, v212, v231
    v_mul_f32 v213, v213, v231
    v_mul_f32 v214, v214, v231
    v_mul_f32 v215, v215, v231
    v_mul_f32 v216, v216, v231
    v_mul_f32 v217, v217, v231
    v_mul_f32 v218, v218, v231
    v_mul_f32 v219, v219, v231
    v_mul_f32 v220, v220, v231
    v_mul_f32 v221, v221, v231
    v_mul_f32 v222, v222, v231
    v_mul_f32 v223, v223, v231
    v_mul_f32 v224, v224, v231
    v_mul_f32 v225, v225, v231
    v_mul_f32 v226, v226, v231
    v_mul_f32 v227, v227, v231
    v_mul_f32 v228, v228, v231
    v_mul_f32 v229, v229, v231
    v_and_b32 v3, 15, v1
    v_add_u32 v10, 4, v4
    v_xor_b32 v3, v3, v10
    v_lshl_add_u32 v3, v3, 4, v9
    v_cvt_pk_bf16_f32 v190, v190, v191
    v_cvt_pk_bf16_f32 v191, v192, v193
    v_cvt_pk_bf16_f32 v192, v194, v195
    v_cvt_pk_bf16_f32 v193, v196, v197
    ds_write_b128 v3, v[190:193] offset:5120
    v_cvt_pk_bf16_f32 v198, v198, v199
    v_cvt_pk_bf16_f32 v199, v200, v201
    v_cvt_pk_bf16_f32 v200, v202, v203
    v_cvt_pk_bf16_f32 v201, v204, v205
    ds_write_b128 v3, v[198:201] offset:5376
    v_cvt_pk_bf16_f32 v206, v206, v207
    v_cvt_pk_bf16_f32 v207, v208, v209
    v_cvt_pk_bf16_f32 v208, v210, v211
    v_cvt_pk_bf16_f32 v209, v212, v213
    ds_write_b128 v3, v[206:209] offset:5632
    v_cvt_pk_bf16_f32 v214, v214, v215
    v_cvt_pk_bf16_f32 v215, v216, v217
    v_cvt_pk_bf16_f32 v216, v218, v219
    v_cvt_pk_bf16_f32 v217, v220, v221
    ds_write_b128 v3, v[214:217] offset:5888
    v_cvt_pk_bf16_f32 v222, v222, v223
    v_cvt_pk_bf16_f32 v223, v224, v225
    v_cvt_pk_bf16_f32 v224, v226, v227
    v_cvt_pk_bf16_f32 v225, v228, v229
    ds_write_b128 v3, v[222:225] offset:6144
    s_nop 0
    s_waitcnt vmcnt(5)
    v_lshlrev_b32 v190, 16, v150
    v_and_b32 v191, 0xffff0000, v150
    v_lshlrev_b32 v192, 16, v151
    v_and_b32 v193, 0xffff0000, v151
    v_lshlrev_b32 v194, 16, v152
    v_and_b32 v195, 0xffff0000, v152
    v_lshlrev_b32 v196, 16, v153
    v_and_b32 v197, 0xffff0000, v153
    v_lshlrev_b32 v198, 16, v154
    v_and_b32 v199, 0xffff0000, v154
    v_lshlrev_b32 v200, 16, v155
    v_and_b32 v201, 0xffff0000, v155
    v_lshlrev_b32 v202, 16, v156
    v_and_b32 v203, 0xffff0000, v156
    v_lshlrev_b32 v204, 16, v157
    v_and_b32 v205, 0xffff0000, v157
    v_lshlrev_b32 v206, 16, v158
    v_and_b32 v207, 0xffff0000, v158
    v_lshlrev_b32 v208, 16, v159
    v_and_b32 v209, 0xffff0000, v159
    v_lshlrev_b32 v210, 16, v160
    v_and_b32 v211, 0xffff0000, v160
    v_lshlrev_b32 v212, 16, v161
    v_and_b32 v213, 0xffff0000, v161
    v_lshlrev_b32 v214, 16, v162
    v_and_b32 v215, 0xffff0000, v162
    v_lshlrev_b32 v216, 16, v163
    v_and_b32 v217, 0xffff0000, v163
    v_lshlrev_b32 v218, 16, v164
    v_and_b32 v219, 0xffff0000, v164
    v_lshlrev_b32 v220, 16, v165
    v_and_b32 v221, 0xffff0000, v165
    v_lshlrev_b32 v222, 16, v166
    v_and_b32 v223, 0xffff0000, v166
    v_lshlrev_b32 v224, 16, v167
    v_and_b32 v225, 0xffff0000, v167
    v_lshlrev_b32 v226, 16, v168
    v_and_b32 v227, 0xffff0000, v168
    v_lshlrev_b32 v228, 16, v169
    v_and_b32 v229, 0xffff0000, v169
    v_add_f32 v230, v190, v191
    v_add_f32 v230, v230, v192
    v_add_f32 v230, v230, v193
    v_add_f32 v230, v230, v194
    v_add_f32 v230, v230, v195
    v_add_f32 v230, v230, v196
    v_add_f32 v230, v230, v197
    v_add_f32 v230, v230, v198
    v_add_f32 v230, v230, v199
    v_add_f32 v230, v230, v200
    v_add_f32 v230, v230, v201
    v_add_f32 v230, v230, v202
    v_add_f32 v230, v230, v203
    v_add_f32 v230, v230, v204
    v_add_f32 v230, v230, v205
    v_add_f32 v230, v230, v206
    v_add_f32 v230, v230, v207
    v_add_f32 v230, v230, v208
    v_add_f32 v230, v230, v209
    v_add_f32 v230, v230, v210
    v_add_f32 v230, v230, v211
    v_add_f32 v230, v230, v212
    v_add_f32 v230, v230, v213
    v_add_f32 v230, v230, v214
    v_add_f32 v230, v230, v215
    v_add_f32 v230, v230, v216
    v_add_f32 v230, v230, v217
    v_add_f32 v230, v230, v218
    v_add_f32 v230, v230, v219
    v_add_f32 v230, v230, v220
    v_add_f32 v230, v230, v221
    v_add_f32 v230, v230, v222
    v_add_f32 v230, v230, v223
    v_add_f32 v230, v230, v224
    v_add_f32 v230, v230, v225
    v_add_f32 v230, v230, v226
    v_add_f32 v230, v230, v227
    v_add_f32 v230, v230, v228
    v_add_f32 v230, v230, v229
    s_nop 1
    v_add_f32_dpp v230, v230, v230 row_ror:8 row_mask:0xf bank_mask:0xf
    s_nop 1
    v_add_f32_dpp v230, v230, v230 row_ror:4 row_mask:0xf bank_mask:0xf
    s_nop 1
    v_add_f32_dpp v230, v230, v230 row_ror:2 row_mask:0xf bank_mask:0xf
    s_nop 1
    v_add_f32_dpp v230, v230, v230 row_ror:1 row_mask:0xf bank_mask:0xf
    v_mul_f32 v230, 0.0015625, v230
    v_sub_f32 v190, v190, v230
    v_sub_f32 v191, v191, v230
    v_sub_f32 v192, v192, v230
    v_sub_f32 v193, v193, v230
    v_sub_f32 v194, v194, v230
    v_sub_f32 v195, v195, v230
    v_sub_f32 v196, v196, v230
    v_sub_f32 v197, v197, v230
    v_sub_f32 v198, v198, v230
    v_sub_f32 v199, v199, v230
    v_sub_f32 v200, v200, v230
    v_sub_f32 v201, v201, v230
    v_sub_f32 v202, v202, v230
    v_sub_f32 v203, v203, v230
    v_sub_f32 v204, v204, v230
    v_sub_f32 v205, v205, v230
    v_sub_f32 v206, v206, v230
    v_sub_f32 v207, v207, v230
    v_sub_f32 v208, v208, v230
    v_sub_f32 v209, v209, v230
    v_sub_f32 v210, v210, v230
    v_sub_f32 v211, v211, v230
    v_sub_f32 v212, v212, v230
    v_sub_f32 v213, v213, v230
    v_sub_f32 v214, v214, v230
    v_sub_f32 v215, v215, v230
    v_sub_f32 v216, v216, v230
    v_sub_f32 v217, v217, v230
    v_sub_f32 v218, v218, v230
    v_sub_f32 v219, v219, v230
    v_sub_f32 v220, v220, v230
    v_sub_f32 v221, v221, v230
    v_sub_f32 v222, v222, v230
    v_sub_f32 v223, v223, v230
    v_sub_f32 v224, v224, v230
    v_sub_f32 v225, v225, v230
    v_sub_f32 v226, v226, v230
    v_sub_f32 v227, v227, v230
    v_sub_f32 v228, v228, v230
    v_sub_f32 v229, v229, v230
    v_mul_f32 v230, v190, v190
    v_fmac_f32 v230, v191, v191
    v_fmac_f32 v230, v192, v192
    v_fmac_f32 v230, v193, v193
    v_fmac_f32 v230, v194, v194
    v_fmac_f32 v230, v195, v195
    v_fmac_f32 v230, v196, v196
    v_fmac_f32 v230, v197, v197
    v_fmac_f32 v230, v198, v198
    v_fmac_f32 v230, v199, v199
    v_fmac_f32 v230, v200, v200
    v_fmac_f32 v230, v201, v201
    v_fmac_f32 v230, v202, v202
    v_fmac_f32 v230, v203, v203
    v_fmac_f32 v230, v204, v204
    v_fmac_f32 v230, v205, v205
    v_fmac_f32 v230, v206, v206
    v_fmac_f32 v230, v207, v207
    v_fmac_f32 v230, v208, v208
    v_fmac_f32 v230, v209, v209
    v_fmac_f32 v230, v210, v210
    v_fmac_f32 v230, v211, v211
    v_fmac_f32 v230, v212, v212
    v_fmac_f32 v230, v213, v213
    v_fmac_f32 v230, v214, v214
    v_fmac_f32 v230, v215, v215
    v_fmac_f32 v230, v216, v216
    v_fmac_f32 v230, v217, v217
    v_fmac_f32 v230, v218, v218
    v_fmac_f32 v230, v219, v219
    v_fmac_f32 v230, v220, v220
    v_fmac_f32 v230, v221, v221
    v_fmac_f32 v230, v222, v222
    v_fmac_f32 v230, v223, v223
    v_fmac_f32 v230, v224, v224
    v_fmac_f32 v230, v225, v225
    v_fmac_f32 v230, v226, v226
    v_fmac_f32 v230, v227, v227
    v_fmac_f32 v230, v228, v228
    v_fmac_f32 v230, v229, v229
    s_nop 1
    v_add_f32_dpp v230, v230, v230 row_ror:8 row_mask:0xf bank_mask:0xf
    s_nop 1
    v_add_f32_dpp v230, v230, v230 row_ror:4 row_mask:0xf bank_mask:0xf
    s_nop 1
    v_add_f32_dpp v230, v230, v230 row_ror:2 row_mask:0xf bank_mask:0xf
    s_nop 1
    v_add_f32_dpp v230, v230, v230 row_ror:1 row_mask:0xf bank_mask:0xf
    v_mov_b32 v231, 0x3727c5ac
    v_fmac_f32 v231, 0.0015625, v230
    v_rsq_f32 v231, v231
    s_nop 0
    v_mul_f32 v190, v190, v231
    v_mul_f32 v191, v191, v231
    v_mul_f32 v192, v192, v231
    v_mul_f32 v193, v193, v231
    v_mul_f32 v194, v194, v231
    v_mul_f32 v195, v195, v231
    v_mul_f32 v196, v196, v231
    v_mul_f32 v197, v197, v231
    v_mul_f32 v198, v198, v231
    v_mul_f32 v199, v199, v231
    v_mul_f32 v200, v200, v231
    v_mul_f32 v201, v201, v231
    v_mul_f32 v202, v202, v231
    v_mul_f32 v203, v203, v231
    v_mul_f32 v204, v204, v231
    v_mul_f32 v205, v205, v231
    v_mul_f32 v206, v206, v231
    v_mul_f32 v207, v207, v231
    v_mul_f32 v208, v208, v231
    v_mul_f32 v209, v209, v231
    v_mul_f32 v210, v210, v231
    v_mul_f32 v211, v211, v231
    v_mul_f32 v212, v212, v231
    v_mul_f32 v213, v213, v231
    v_mul_f32 v214, v214, v231
    v_mul_f32 v215, v215, v231
    v_mul_f32 v216, v216, v231
    v_mul_f32 v217, v217, v231
    v_mul_f32 v218, v218, v231
    v_mul_f32 v219, v219, v231
    v_mul_f32 v220, v220, v231
    v_mul_f32 v221, v221, v231
    v_mul_f32 v222, v222, v231
    v_mul_f32 v223, v223, v231
    v_mul_f32 v224, v224, v231
    v_mul_f32 v225, v225, v231
    v_mul_f32 v226, v226, v231
    v_mul_f32 v227, v227, v231
    v_mul_f32 v228, v228, v231
    v_mul_f32 v229, v229, v231
    v_and_b32 v3, 15, v1
    v_add_u32 v10, 0, v4
    v_xor_b32 v3, v3, v10
    v_lshl_add_u32 v3, v3, 4, v9
    v_cvt_pk_bf16_f32 v190, v190, v191
    v_cvt_pk_bf16_f32 v191, v192, v193
    v_cvt_pk_bf16_f32 v192, v194, v195
    v_cvt_pk_bf16_f32 v193, v196, v197
    ds_write_b128 v3, v[190:193] offset:10240
    v_cvt_pk_bf16_f32 v198, v198, v199
    v_cvt_pk_bf16_f32 v199, v200, v201
    v_cvt_pk_bf16_f32 v200, v202, v203
    v_cvt_pk_bf16_f32 v201, v204, v205
    ds_write_b128 v3, v[198:201] offset:10496
    v_cvt_pk_bf16_f32 v206, v206, v207
    v_cvt_pk_bf16_f32 v207, v208, v209
    v_cvt_pk_bf16_f32 v208, v210, v211
    v_cvt_pk_bf16_f32 v209, v212, v213
    ds_write_b128 v3, v[206:209] offset:10752
    v_cvt_pk_bf16_f32 v214, v214, v215
    v_cvt_pk_bf16_f32 v215, v216, v217
    v_cvt_pk_bf16_f32 v216, v218, v219
    v_cvt_pk_bf16_f32 v217, v220, v221
    ds_write_b128 v3, v[214:217] offset:11008
    v_cvt_pk_bf16_f32 v222, v222, v223
    v_cvt_pk_bf16_f32 v223, v224, v225
    v_cvt_pk_bf16_f32 v224, v226, v227
    v_cvt_pk_bf16_f32 v225, v228, v229
    ds_write_b128 v3, v[222:225] offset:11264
    s_nop 0
    s_waitcnt vmcnt(0)
    v_lshlrev_b32 v190, 16, v170
    v_and_b32 v191, 0xffff0000, v170
    v_lshlrev_b32 v192, 16, v171
    v_and_b32 v193, 0xffff0000, v171
    v_lshlrev_b32 v194, 16, v172
    v_and_b32 v195, 0xffff0000, v172
    v_lshlrev_b32 v196, 16, v173
    v_and_b32 v197, 0xffff0000, v173
    v_lshlrev_b32 v198, 16, v174
    v_and_b32 v199, 0xffff0000, v174
    v_lshlrev_b32 v200, 16, v175
    v_and_b32 v201, 0xffff0000, v175
    v_lshlrev_b32 v202, 16, v176
    v_and_b32 v203, 0xffff0000, v176
    v_lshlrev_b32 v204, 16, v177
    v_and_b32 v205, 0xffff0000, v177
    v_lshlrev_b32 v206, 16, v178
    v_and_b32 v207, 0xffff0000, v178
    v_lshlrev_b32 v208, 16, v179
    v_and_b32 v209, 0xffff0000, v179
    v_lshlrev_b32 v210, 16, v180
    v_and_b32 v211, 0xffff0000, v180
    v_lshlrev_b32 v212, 16, v181
    v_and_b32 v213, 0xffff0000, v181
    v_lshlrev_b32 v214, 16, v182
    v_and_b32 v215, 0xffff0000, v182
    v_lshlrev_b32 v216, 16, v183
    v_and_b32 v217, 0xffff0000, v183
    v_lshlrev_b32 v218, 16, v184
    v_and_b32 v219, 0xffff0000, v184
    v_lshlrev_b32 v220, 16, v185
    v_and_b32 v221, 0xffff0000, v185
    v_lshlrev_b32 v222, 16, v186
    v_and_b32 v223, 0xffff0000, v186
    v_lshlrev_b32 v224, 16, v187
    v_and_b32 v225, 0xffff0000, v187
    v_lshlrev_b32 v226, 16, v188
    v_and_b32 v227, 0xffff0000, v188
    v_lshlrev_b32 v228, 16, v189
    v_and_b32 v229, 0xffff0000, v189
    v_add_f32 v230, v190, v191
    v_add_f32 v230, v230, v192
    v_add_f32 v230, v230, v193
    v_add_f32 v230, v230, v194
    v_add_f32 v230, v230, v195
    v_add_f32 v230, v230, v196
    v_add_f32 v230, v230, v197
    v_add_f32 v230, v230, v198
    v_add_f32 v230, v230, v199
    v_add_f32 v230, v230, v200
    v_add_f32 v230, v230, v201
    v_add_f32 v230, v230, v202
    v_add_f32 v230, v230, v203
    v_add_f32 v230, v230, v204
    v_add_f32 v230, v230, v205
    v_add_f32 v230, v230, v206
    v_add_f32 v230, v230, v207
    v_add_f32 v230, v230, v208
    v_add_f32 v230, v230, v209
    v_add_f32 v230, v230, v210
    v_add_f32 v230, v230, v211
    v_add_f32 v230, v230, v212
    v_add_f32 v230, v230, v213
    v_add_f32 v230, v230, v214
    v_add_f32 v230, v230, v215
    v_add_f32 v230, v230, v216
    v_add_f32 v230, v230, v217
    v_add_f32 v230, v230, v218
    v_add_f32 v230, v230, v219
    v_add_f32 v230, v230, v220
    v_add_f32 v230, v230, v221
    v_add_f32 v230, v230, v222
    v_add_f32 v230, v230, v223
    v_add_f32 v230, v230, v224
    v_add_f32 v230, v230, v225
    v_add_f32 v230, v230, v226
    v_add_f32 v230, v230, v227
    v_add_f32 v230, v230, v228
    v_add_f32 v230, v230, v229
    s_nop 1
    v_add_f32_dpp v230, v230, v230 row_ror:8 row_mask:0xf bank_mask:0xf
    s_nop 1
    v_add_f32_dpp v230, v230, v230 row_ror:4 row_mask:0xf bank_mask:0xf
    s_nop 1
    v_add_f32_dpp v230, v230, v230 row_ror:2 row_mask:0xf bank_mask:0xf
    s_nop 1
    v_add_f32_dpp v230, v230, v230 row_ror:1 row_mask:0xf bank_mask:0xf
    v_mul_f32 v230, 0.0015625, v230
    v_sub_f32 v190, v190, v230
    v_sub_f32 v191, v191, v230
    v_sub_f32 v192, v192, v230
    v_sub_f32 v193, v193, v230
    v_sub_f32 v194, v194, v230
    v_sub_f32 v195, v195, v230
    v_sub_f32 v196, v196, v230
    v_sub_f32 v197, v197, v230
    v_sub_f32 v198, v198, v230
    v_sub_f32 v199, v199, v230
    v_sub_f32 v200, v200, v230
    v_sub_f32 v201, v201, v230
    v_sub_f32 v202, v202, v230
    v_sub_f32 v203, v203, v230
    v_sub_f32 v204, v204, v230
    v_sub_f32 v205, v205, v230
    v_sub_f32 v206, v206, v230
    v_sub_f32 v207, v207, v230
    v_sub_f32 v208, v208, v230
    v_sub_f32 v209, v209, v230
    v_sub_f32 v210, v210, v230
    v_sub_f32 v211, v211, v230
    v_sub_f32 v212, v212, v230
    v_sub_f32 v213, v213, v230
    v_sub_f32 v214, v214, v230
    v_sub_f32 v215, v215, v230
    v_sub_f32 v216, v216, v230
    v_sub_f32 v217, v217, v230
    v_sub_f32 v218, v218, v230
    v_sub_f32 v219, v219, v230
    v_sub_f32 v220, v220, v230
    v_sub_f32 v221, v221, v230
    v_sub_f32 v222, v222, v230
    v_sub_f32 v223, v223, v230
    v_sub_f32 v224, v224, v230
    v_sub_f32 v225, v225, v230
    v_sub_f32 v226, v226, v230
    v_sub_f32 v227, v227, v230
    v_sub_f32 v228, v228, v230
    v_sub_f32 v229, v229, v230
    v_mul_f32 v230, v190, v190
    v_fmac_f32 v230, v191, v191
    v_fmac_f32 v230, v192, v192
    v_fmac_f32 v230, v193, v193
    v_fmac_f32 v230, v194, v194
    v_fmac_f32 v230, v195, v195
    v_fmac_f32 v230, v196, v196
    v_fmac_f32 v230, v197, v197
    v_fmac_f32 v230, v198, v198
    v_fmac_f32 v230, v199, v199
    v_fmac_f32 v230, v200, v200
    v_fmac_f32 v230, v201, v201
    v_fmac_f32 v230, v202, v202
    v_fmac_f32 v230, v203, v203
    v_fmac_f32 v230, v204, v204
    v_fmac_f32 v230, v205, v205
    v_fmac_f32 v230, v206, v206
    v_fmac_f32 v230, v207, v207
    v_fmac_f32 v230, v208, v208
    v_fmac_f32 v230, v209, v209
    v_fmac_f32 v230, v210, v210
    v_fmac_f32 v230, v211, v211
    v_fmac_f32 v230, v212, v212
    v_fmac_f32 v230, v213, v213
    v_fmac_f32 v230, v214, v214
    v_fmac_f32 v230, v215, v215
    v_fmac_f32 v230, v216, v216
    v_fmac_f32 v230, v217, v217
    v_fmac_f32 v230, v218, v218
    v_fmac_f32 v230, v219, v219
    v_fmac_f32 v230, v220, v220
    v_fmac_f32 v230, v221, v221
    v_fmac_f32 v230, v222, v222
    v_fmac_f32 v230, v223, v223
    v_fmac_f32 v230, v224, v224
    v_fmac_f32 v230, v225, v225
    v_fmac_f32 v230, v226, v226
    v_fmac_f32 v230, v227, v227
    v_fmac_f32 v230, v228, v228
    v_fmac_f32 v230, v229, v229
    s_nop 1
    v_add_f32_dpp v230, v230, v230 row_ror:8 row_mask:0xf bank_mask:0xf
    s_nop 1
    v_add_f32_dpp v230, v230, v230 row_ror:4 row_mask:0xf bank_mask:0xf
    s_nop 1
    v_add_f32_dpp v230, v230, v230 row_ror:2 row_mask:0xf bank_mask:0xf
    s_nop 1
    v_add_f32_dpp v230, v230, v230 row_ror:1 row_mask:0xf bank_mask:0xf
    v_mov_b32 v231, 0x3727c5ac
    v_fmac_f32 v231, 0.0015625, v230
    v_rsq_f32 v231, v231
    s_nop 0
    v_mul_f32 v190, v190, v231
    v_mul_f32 v191, v191, v231
    v_mul_f32 v192, v192, v231
    v_mul_f32 v193, v193, v231
    v_mul_f32 v194, v194, v231
    v_mul_f32 v195, v195, v231
    v_mul_f32 v196, v196, v231
    v_mul_f32 v197, v197, v231
    v_mul_f32 v198, v198, v231
    v_mul_f32 v199, v199, v231
    v_mul_f32 v200, v200, v231
    v_mul_f32 v201, v201, v231
    v_mul_f32 v202, v202, v231
    v_mul_f32 v203, v203, v231
    v_mul_f32 v204, v204, v231
    v_mul_f32 v205, v205, v231
    v_mul_f32 v206, v206, v231
    v_mul_f32 v207, v207, v231
    v_mul_f32 v208, v208, v231
    v_mul_f32 v209, v209, v231
    v_mul_f32 v210, v210, v231
    v_mul_f32 v211, v211, v231
    v_mul_f32 v212, v212, v231
    v_mul_f32 v213, v213, v231
    v_mul_f32 v214, v214, v231
    v_mul_f32 v215, v215, v231
    v_mul_f32 v216, v216, v231
    v_mul_f32 v217, v217, v231
    v_mul_f32 v218, v218, v231
    v_mul_f32 v219, v219, v231
    v_mul_f32 v220, v220, v231
    v_mul_f32 v221, v221, v231
    v_mul_f32 v222, v222, v231
    v_mul_f32 v223, v223, v231
    v_mul_f32 v224, v224, v231
    v_mul_f32 v225, v225, v231
    v_mul_f32 v226, v226, v231
    v_mul_f32 v227, v227, v231
    v_mul_f32 v228, v228, v231
    v_mul_f32 v229, v229, v231
    v_and_b32 v3, 15, v1
    v_add_u32 v10, 4, v4
    v_xor_b32 v3, v3, v10
    v_lshl_add_u32 v3, v3, 4, v9
    v_cvt_pk_bf16_f32 v190, v190, v191
    v_cvt_pk_bf16_f32 v191, v192, v193
    v_cvt_pk_bf16_f32 v192, v194, v195
    v_cvt_pk_bf16_f32 v193, v196, v197
    ds_write_b128 v3, v[190:193] offset:15360
    v_cvt_pk_bf16_f32 v198, v198, v199
    v_cvt_pk_bf16_f32 v199, v200, v201
    v_cvt_pk_bf16_f32 v200, v202, v203
    v_cvt_pk_bf16_f32 v201, v204, v205
    ds_write_b128 v3, v[198:201] offset:15616
    v_cvt_pk_bf16_f32 v206, v206, v207
    v_cvt_pk_bf16_f32 v207, v208, v209
    v_cvt_pk_bf16_f32 v208, v210, v211
    v_cvt_pk_bf16_f32 v209, v212, v213
    ds_write_b128 v3, v[206:209] offset:15872
    v_cvt_pk_bf16_f32 v214, v214, v215
    v_cvt_pk_bf16_f32 v215, v216, v217
    v_cvt_pk_bf16_f32 v216, v218, v219
    v_cvt_pk_bf16_f32 v217, v220, v221
    ds_write_b128 v3, v[214:217] offset:16128
    v_cvt_pk_bf16_f32 v222, v222, v223
    v_cvt_pk_bf16_f32 v223, v224, v225
    v_cvt_pk_bf16_f32 v224, v226, v227
    v_cvt_pk_bf16_f32 v225, v228, v229
    ds_write_b128 v3, v[222:225] offset:16384
    s_nop 0
mlp1_psk0:
    s_waitcnt vmcnt(0) lgkmcnt(0)
    s_barrier
    ds_read_b128 v[110:113], v7 offset:0
    ds_read_b128 v[114:117], v7 offset:20480
    ds_read_b128 v[118:121], v7 offset:40960
    ds_read_b128 v[122:125], v7 offset:61440
    ds_read_b128 v[126:129], v6 offset:0
    ds_read_b128 v[130:133], v6 offset:20480
    ds_read_b128 v[134:137], v6 offset:40960
    ds_read_b128 v[138:141], v6 offset:61440
    s_waitcnt lgkmcnt(4)
    v_mfma_f32_16x16x32_bf16 v[94:97], v[14:17], v[110:113], v[94:97]
    v_mfma_f32_16x16x32_bf16 v[98:101], v[14:17], v[114:117], v[98:101]
    v_mfma_f32_16x16x32_bf16 v[102:105], v[14:17], v[118:121], v[102:105]
    v_mfma_f32_16x16x32_bf16 v[106:109], v[14:17], v[122:125], v[106:109]
    ds_read_b128 v[110:113], v7 offset:128
    ds_read_b128 v[114:117], v7 offset:20608
    ds_read_b128 v[118:121], v7 offset:41088
    ds_read_b128 v[122:125], v7 offset:61568
    s_waitcnt lgkmcnt(4)
    v_mfma_f32_16x16x32_bf16 v[94:97], v[18:21], v[126:129], v[94:97]
    v_mfma_f32_16x16x32_bf16 v[98:101], v[18:21], v[130:133], v[98:101]
    v_mfma_f32_16x16x32_bf16 v[102:105], v[18:21], v[134:137], v[102:105]
    v_mfma_f32_16x16x32_bf16 v[106:109], v[18:21], v[138:141], v[106:109]
    ds_read_b128 v[126:129], v6 offset:128
    ds_read_b128 v[130:133], v6 offset:20608
    ds_read_b128 v[134:137], v6 offset:41088
    ds_read_b128 v[138:141], v6 offset:61568
    s_waitcnt lgkmcnt(4)
    v_mfma_f32_16x16x32_bf16 v[94:97], v[22:25], v[110:113], v[94:97]
    v_mfma_f32_16x16x32_bf16 v[98:101], v[22:25], v[114:117], v[98:101]
    v_mfma_f32_16x16x32_bf16 v[102:105], v[22:25], v[118:121], v[102:105]
    v_mfma_f32_16x16x32_bf16 v[106:109], v[22:25], v[122:125], v[106:109]
    ds_read_b128 v[110:113], v7 offset:256
    ds_read_b128 v[114:117], v7 offset:20736
    ds_read_b128 v[118:121], v7 offset:41216
    ds_read_b128 v[122:125], v7 offset:61696
    s_waitcnt lgkmcnt(4)
    v_mfma_f32_16x16x32_bf16 v[94:97], v[26:29], v[126:129], v[94:97]
    v_mfma_f32_16x16x32_bf16 v[98:101], v[26:29], v[130:133], v[98:101]
    v_mfma_f32_16x16x32_bf16 v[102:105], v[26:29], v[134:137], v[102:105]
    v_mfma_f32_16x16x32_bf16 v[106:109], v[26:29], v[138:141], v[106:109]
    ds_read_b128 v[126:129], v6 offset:256
    ds_read_b128 v[130:133], v6 offset:20736
    ds_read_b128 v[134:137], v6 offset:41216
    ds_read_b128 v[138:141], v6 offset:61696
    s_waitcnt lgkmcnt(4)
    v_mfma_f32_16x16x32_bf16 v[94:97], v[30:33], v[110:113], v[94:97]
    v_mfma_f32_16x16x32_bf16 v[98:101], v[30:33], v[114:117], v[98:101]
    v_mfma_f32_16x16x32_bf16 v[102:105], v[30:33], v[118:121], v[102:105]
    v_mfma_f32_16x16x32_bf16 v[106:109], v[30:33], v[122:125], v[106:109]
    ds_read_b128 v[110:113], v7 offset:384
    ds_read_b128 v[114:117], v7 offset:20864
    ds_read_b128 v[118:121], v7 offset:41344
    ds_read_b128 v[122:125], v7 offset:61824
    s_waitcnt lgkmcnt(4)
    v_mfma_f32_16x16x32_bf16 v[94:97], v[34:37], v[126:129], v[94:97]
    v_mfma_f32_16x16x32_bf16 v[98:101], v[34:37], v[130:133], v[98:101]
    v_mfma_f32_16x16x32_bf16 v[102:105], v[34:37], v[134:137], v[102:105]
    v_mfma_f32_16x16x32_bf16 v[106:109], v[34:37], v[138:141], v[106:109]
    ds_read_b128 v[126:129], v6 offset:384
    ds_read_b128 v[130:133], v6 offset:20864
    ds_read_b128 v[134:137], v6 offset:41344
    ds_read_b128 v[138:141], v6 offset:61824
    s_waitcnt lgkmcnt(4)
    v_mfma_f32_16x16x32_bf16 v[94:97], v[38:41], v[110:113], v[94:97]
    v_mfma_f32_16x16x32_bf16 v[98:101], v[38:41], v[114:117], v[98:101]
    v_mfma_f32_16x16x32_bf16 v[102:105], v[38:41], v[118:121], v[102:105]
    v_mfma_f32_16x16x32_bf16 v[106:109], v[38:41], v[122:125], v[106:109]
    ds_read_b128 v[110:113], v7 offset:512
    ds_read_b128 v[114:117], v7 offset:20992
    ds_read_b128 v[118:121], v7 offset:41472
    ds_read_b128 v[122:125], v7 offset:61952
    s_waitcnt lgkmcnt(4)
    v_mfma_f32_16x16x32_bf16 v[94:97], v[42:45], v[126:129], v[94:97]
    v_mfma_f32_16x16x32_bf16 v[98:101], v[42:45], v[130:133], v[98:101]
    v_mfma_f32_16x16x32_bf16 v[102:105], v[42:45], v[134:137], v[102:105]
    v_mfma_f32_16x16x32_bf16 v[106:109], v[42:45], v[138:141], v[106:109]
    ds_read_b128 v[126:129], v6 offset:512
    ds_read_b128 v[130:133], v6 offset:20992
    ds_read_b128 v[134:137], v6 offset:41472
    ds_read_b128 v[138:141], v6 offset:61952
    s_waitcnt lgkmcnt(4)
    v_mfma_f32_16x16x32_bf16 v[94:97], v[46:49], v[110:113], v[94:97]
    v_mfma_f32_16x16x32_bf16 v[98:101], v[46:49], v[114:117], v[98:101]
    v_mfma_f32_16x16x32_bf16 v[102:105], v[46:49], v[118:121], v[102:105]
    v_mfma_f32_16x16x32_bf16 v[106:109], v[46:49], v[122:125], v[106:109]
    ds_read_b128 v[110:113], v7 offset:640
    ds_read_b128 v[114:117], v7 offset:21120
    ds_read_b128 v[118:121], v7 offset:41600
    ds_read_b128 v[122:125], v7 offset:62080
    s_waitcnt lgkmcnt(4)
    v_mfma_f32_16x16x32_bf16 v[94:97], v[50:53], v[126:129], v[94:97]
    v_mfma_f32_16x16x32_bf16 v[98:101], v[50:53], v[130:133], v[98:101]
    v_mfma_f32_16x16x32_bf16 v[102:105], v[50:53], v[134:137], v[102:105]
    v_mfma_f32_16x16x32_bf16 v[106:109], v[50:53], v[138:141], v[106:109]
    ds_read_b128 v[126:129], v6 offset:640
    ds_read_b128 v[130:133], v6 offset:21120
    ds_read_b128 v[134:137], v6 offset:41600
    ds_read_b128 v[138:141], v6 offset:62080
    s_waitcnt lgkmcnt(4)
    v_mfma_f32_16x16x32_bf16 v[94:97], v[54:57], v[110:113], v[94:97]
    v_mfma_f32_16x16x32_bf16 v[98:101], v[54:57], v[114:117], v[98:101]
    v_mfma_f32_16x16x32_bf16 v[102:105], v[54:57], v[118:121], v[102:105]
    v_mfma_f32_16x16x32_bf16 v[106:109], v[54:57], v[122:125], v[106:109]
    ds_read_b128 v[110:113], v7 offset:768
    ds_read_b128 v[114:117], v7 offset:21248
    ds_read_b128 v[118:121], v7 offset:41728
    ds_read_b128 v[122:125], v7 offset:62208
    s_waitcnt lgkmcnt(4)
    v_mfma_f32_16x16x32_bf16 v[94:97], v[58:61], v[126:129], v[94:97]
    v_mfma_f32_16x16x32_bf16 v[98:101], v[58:61], v[130:133], v[98:101]
    v_mfma_f32_16x16x32_bf16 v[102:105], v[58:61], v[134:137], v[102:105]
    v_mfma_f32_16x16x32_bf16 v[106:109], v[58:61], v[138:141], v[106:109]
    ds_read_b128 v[126:129], v6 offset:768
    ds_read_b128 v[130:133], v6 offset:21248
    ds_read_b128 v[134:137], v6 offset:41728
    ds_read_b128 v[138:141], v6 offset:62208
    s_waitcnt lgkmcnt(4)
    v_mfma_f32_16x16x32_bf16 v[94:97], v[62:65], v[110:113], v[94:97]
    v_mfma_f32_16x16x32_bf16 v[98:101], v[62:65], v[114:117], v[98:101]
    v_mfma_f32_16x16x32_bf16 v[102:105], v[62:65], v[118:121], v[102:105]
    v_mfma_f32_16x16x32_bf16 v[106:109], v[62:65], v[122:125], v[106:109]
    ds_read_b128 v[110:113], v7 offset:896
    ds_read_b128 v[114:117], v7 offset:21376
    ds_read_b128 v[118:121], v7 offset:41856
    ds_read_b128 v[122:125], v7 offset:62336
    s_waitcnt lgkmcnt(4)
    v_mfma_f32_16x16x32_bf16 v[94:97], v[66:69], v[126:129], v[94:97]
    v_mfma_f32_16x16x32_bf16 v[98:101], v[66:69], v[130:133], v[98:101]
    v_mfma_f32_16x16x32_bf16 v[102:105], v[66:69], v[134:137], v[102:105]
    v_mfma_f32_16x16x32_bf16 v[106:109], v[66:69], v[138:141], v[106:109]
    ds_read_b128 v[126:129], v6 offset:896
    ds_read_b128 v[130:133], v6 offset:21376
    ds_read_b128 v[134:137], v6 offset:41856
    ds_read_b128 v[138:141], v6 offset:62336
    s_waitcnt lgkmcnt(4)
    v_mfma_f32_16x16x32_bf16 v[94:97], v[70:73], v[110:113], v[94:97]
    v_mfma_f32_16x16x32_bf16 v[98:101], v[70:73], v[114:117], v[98:101]
    v_mfma_f32_16x16x32_bf16 v[102:105], v[70:73], v[118:121], v[102:105]
    v_mfma_f32_16x16x32_bf16 v[106:109], v[70:73], v[122:125], v[106:109]
    ds_read_b128 v[110:113], v7 offset:1024
    ds_read_b128 v[114:117], v7 offset:21504
    ds_read_b128 v[118:121], v7 offset:41984
    ds_read_b128 v[122:125], v7 offset:62464
    s_waitcnt lgkmcnt(4)
    v_mfma_f32_16x16x32_bf16 v[94:97], v[74:77], v[126:129], v[94:97]
    v_mfma_f32_16x16x32_bf16 v[98:101], v[74:77], v[130:133], v[98:101]
    v_mfma_f32_16x16x32_bf16 v[102:105], v[74:77], v[134:137], v[102:105]
    v_mfma_f32_16x16x32_bf16 v[106:109], v[74:77], v[138:141], v[106:109]
    ds_read_b128 v[126:129], v6 offset:1024
    ds_read_b128 v[130:133], v6 offset:21504
    ds_read_b128 v[134:137], v6 offset:41984
    ds_read_b128 v[138:141], v6 offset:62464
    s_waitcnt lgkmcnt(4)
    v_mfma_f32_16x16x32_bf16 v[94:97], v[78:81], v[110:113], v[94:97]
    v_mfma_f32_16x16x32_bf16 v[98:101], v[78:81], v[114:117], v[98:101]
    v_mfma_f32_16x16x32_bf16 v[102:105], v[78:81], v[118:121], v[102:105]
    v_mfma_f32_16x16x32_bf16 v[106:109], v[78:81], v[122:125], v[106:109]
    ds_read_b128 v[110:113], v7 offset:1152
    ds_read_b128 v[114:117], v7 offset:21632
    ds_read_b128 v[118:121], v7 offset:42112
    ds_read_b128 v[122:125], v7 offset:62592
    s_waitcnt lgkmcnt(4)
    v_mfma_f32_16x16x32_bf16 v[94:97], v[82:85], v[126:129], v[94:97]
    v_mfma_f32_16x16x32_bf16 v[98:101], v[82:85], v[130:133], v[98:101]
    v_mfma_f32_16x16x32_bf16 v[102:105], v[82:85], v[134:137], v[102:105]
    v_mfma_f32_16x16x32_bf16 v[106:109], v[82:85], v[138:141], v[106:109]
    ds_read_b128 v[126:129], v6 offset:1152
    ds_read_b128 v[130:133], v6 offset:21632
    ds_read_b128 v[134:137], v6 offset:42112
    ds_read_b128 v[138:141], v6 offset:62592
    s_waitcnt lgkmcnt(4)
    v_mfma_f32_16x16x32_bf16 v[94:97], v[86:89], v[110:113], v[94:97]
    v_mfma_f32_16x16x32_bf16 v[98:101], v[86:89], v[114:117], v[98:101]
    v_mfma_f32_16x16x32_bf16 v[102:105], v[86:89], v[118:121], v[102:105]
    v_mfma_f32_16x16x32_bf16 v[106:109], v[86:89], v[122:125], v[106:109]
    s_waitcnt lgkmcnt(0)
    v_mfma_f32_16x16x32_bf16 v[94:97], v[90:93], v[126:129], v[94:97]
    v_mfma_f32_16x16x32_bf16 v[98:101], v[90:93], v[130:133], v[98:101]
    v_mfma_f32_16x16x32_bf16 v[102:105], v[90:93], v[134:137], v[102:105]
    v_mfma_f32_16x16x32_bf16 v[106:109], v[90:93], v[138:141], v[106:109]
    s_nop 7
    s_nop 7
    v_mul_f32 v110, v94, v94
    v_mov_b32 v111, 0x3f4c422a
    v_fmac_f32 v111, 0x3d122279, v110
    v_mul_f32 v111, v111, v94
    v_mul_f32 v111, 0xc038aa3b, v111
    v_exp_f32 v111, v111
    s_nop 0
    v_add_f32 v111, 1.0, v111
    v_rcp_f32 v111, v111
    s_nop 0
    v_mul_f32 v94, v94, v111
    v_mul_f32 v110, v95, v95
    v_mov_b32 v111, 0x3f4c422a
    v_fmac_f32 v111, 0x3d122279, v110
    v_mul_f32 v111, v111, v95
    v_mul_f32 v111, 0xc038aa3b, v111
    v_exp_f32 v111, v111
    s_nop 0
    v_add_f32 v111, 1.0, v111
    v_rcp_f32 v111, v111
    s_nop 0
    v_mul_f32 v95, v95, v111
    v_mul_f32 v110, v96, v96
    v_mov_b32 v111, 0x3f4c422a
    v_fmac_f32 v111, 0x3d122279, v110
    v_mul_f32 v111, v111, v96
    v_mul_f32 v111, 0xc038aa3b, v111
    v_exp_f32 v111, v111
    s_nop 0
    v_add_f32 v111, 1.0, v111
    v_rcp_f32 v111, v111
    s_nop 0
    v_mul_f32 v96, v96, v111
    v_mul_f32 v110, v97, v97
    v_mov_b32 v111, 0x3f4c422a
    v_fmac_f32 v111, 0x3d122279, v110
    v_mul_f32 v111, v111, v97
    v_mul_f32 v111, 0xc038aa3b, v111
    v_exp_f32 v111, v111
    s_nop 0
    v_add_f32 v111, 1.0, v111
    v_rcp_f32 v111, v111
    s_nop 0
    v_mul_f32 v97, v97, v111
    v_cvt_pk_bf16_f32 v94, v94, v95
    v_cvt_pk_bf16_f32 v95, v96, v97
    s_mov_b32 s34, 21954560
    buffer_store_dwordx2 v[94:95], v5, s[8:11], s34 offen
    v_mul_f32 v110, v98, v98
    v_mov_b32 v111, 0x3f4c422a
    v_fmac_f32 v111, 0x3d122279, v110
    v_mul_f32 v111, v111, v98
    v_mul_f32 v111, 0xc038aa3b, v111
    v_exp_f32 v111, v111
    s_nop 0
    v_add_f32 v111, 1.0, v111
    v_rcp_f32 v111, v111
    s_nop 0
    v_mul_f32 v98, v98, v111
    v_mul_f32 v110, v99, v99
    v_mov_b32 v111, 0x3f4c422a
    v_fmac_f32 v111, 0x3d122279, v110
    v_mul_f32 v111, v111, v99
    v_mul_f32 v111, 0xc038aa3b, v111
    v_exp_f32 v111, v111
    s_nop 0
    v_add_f32 v111, 1.0, v111
    v_rcp_f32 v111, v111
    s_nop 0
    v_mul_f32 v99, v99, v111
    v_mul_f32 v110, v100, v100
    v_mov_b32 v111, 0x3f4c422a
    v_fmac_f32 v111, 0x3d122279, v110
    v_mul_f32 v111, v111, v100
    v_mul_f32 v111, 0xc038aa3b, v111
    v_exp_f32 v111, v111
    s_nop 0
    v_add_f32 v111, 1.0, v111
    v_rcp_f32 v111, v111
    s_nop 0
    v_mul_f32 v100, v100, v111
    v_mul_f32 v110, v101, v101
    v_mov_b32 v111, 0x3f4c422a
    v_fmac_f32 v111, 0x3d122279, v110
    v_mul_f32 v111, v111, v101
    v_mul_f32 v111, 0xc038aa3b, v111
    v_exp_f32 v111, v111
    s_nop 0
    v_add_f32 v111, 1.0, v111
    v_rcp_f32 v111, v111
    s_nop 0
    v_mul_f32 v101, v101, v111
    v_cvt_pk_bf16_f32 v98, v98, v99
    v_cvt_pk_bf16_f32 v99, v100, v101
    s_mov_b32 s34, 22003712
    buffer_store_dwordx2 v[98:99], v5, s[8:11], s34 offen
    v_mul_f32 v110, v102, v102
    v_mov_b32 v111, 0x3f4c422a
    v_fmac_f32 v111, 0x3d122279, v110
    v_mul_f32 v111, v111, v102
    v_mul_f32 v111, 0xc038aa3b, v111
    v_exp_f32 v111, v111
    s_nop 0
    v_add_f32 v111, 1.0, v111
    v_rcp_f32 v111, v111
    s_nop 0
    v_mul_f32 v102, v102, v111
    v_mul_f32 v110, v103, v103
    v_mov_b32 v111, 0x3f4c422a
    v_fmac_f32 v111, 0x3d122279, v110
    v_mul_f32 v111, v111, v103
    v_mul_f32 v111, 0xc038aa3b, v111
    v_exp_f32 v111, v111
    s_nop 0
    v_add_f32 v111, 1.0, v111
    v_rcp_f32 v111, v111
    s_nop 0
    v_mul_f32 v103, v103, v111
    v_mul_f32 v110, v104, v104
    v_mov_b32 v111, 0x3f4c422a
    v_fmac_f32 v111, 0x3d122279, v110
    v_mul_f32 v111, v111, v104
    v_mul_f32 v111, 0xc038aa3b, v111
    v_exp_f32 v111, v111
    s_nop 0
    v_add_f32 v111, 1.0, v111
    v_rcp_f32 v111, v111
    s_nop 0
    v_mul_f32 v104, v104, v111
    v_mul_f32 v110, v105, v105
    v_mov_b32 v111, 0x3f4c422a
    v_fmac_f32 v111, 0x3d122279, v110
    v_mul_f32 v111, v111, v105
    v_mul_f32 v111, 0xc038aa3b, v111
    v_exp_f32 v111, v111
    s_nop 0
    v_add_f32 v111, 1.0, v111
    v_rcp_f32 v111, v111
    s_nop 0
    v_mul_f32 v105, v105, v111
    v_cvt_pk_bf16_f32 v102, v102, v103
    v_cvt_pk_bf16_f32 v103, v104, v105
    s_mov_b32 s34, 22052864
    buffer_store_dwordx2 v[102:103], v5, s[8:11], s34 offen
    v_mul_f32 v110, v106, v106
    v_mov_b32 v111, 0x3f4c422a
    v_fmac_f32 v111, 0x3d122279, v110
    v_mul_f32 v111, v111, v106
    v_mul_f32 v111, 0xc038aa3b, v111
    v_exp_f32 v111, v111
    s_nop 0
    v_add_f32 v111, 1.0, v111
    v_rcp_f32 v111, v111
    s_nop 0
    v_mul_f32 v106, v106, v111
    v_mul_f32 v110, v107, v107
    v_mov_b32 v111, 0x3f4c422a
    v_fmac_f32 v111, 0x3d122279, v110
    v_mul_f32 v111, v111, v107
    v_mul_f32 v111, 0xc038aa3b, v111
    v_exp_f32 v111, v111
    s_nop 0
    v_add_f32 v111, 1.0, v111
    v_rcp_f32 v111, v111
    s_nop 0
    v_mul_f32 v107, v107, v111
    v_mul_f32 v110, v108, v108
    v_mov_b32 v111, 0x3f4c422a
    v_fmac_f32 v111, 0x3d122279, v110
    v_mul_f32 v111, v111, v108
    v_mul_f32 v111, 0xc038aa3b, v111
    v_exp_f32 v111, v111
    s_nop 0
    v_add_f32 v111, 1.0, v111
    v_rcp_f32 v111, v111
    s_nop 0
    v_mul_f32 v108, v108, v111
    v_mul_f32 v110, v109, v109
    v_mov_b32 v111, 0x3f4c422a
    v_fmac_f32 v111, 0x3d122279, v110
    v_mul_f32 v111, v111, v109
    v_mul_f32 v111, 0xc038aa3b, v111
    v_exp_f32 v111, v111
    s_nop 0
    v_add_f32 v111, 1.0, v111
    v_rcp_f32 v111, v111
    s_nop 0
    v_mul_f32 v109, v109, v111
    v_cvt_pk_bf16_f32 v106, v106, v107
    v_cvt_pk_bf16_f32 v107, v108, v109
    s_mov_b32 s34, 22102016
    buffer_store_dwordx2 v[106:107], v5, s[8:11], s34 offen
mlp1_done:
    s_endpgm
.globl mlp2_kernel
.p2align 8
.type mlp2_kernel,@function
mlp2_kernel:
    s_cmp_ge_u32 s2, 256
    s_cbranch_scc1 mlp2_done
    s_load_dwordx2 s[4:5], s[0:1], 80
    s_load_dwordx2 s[6:7], s[0:1], 0
    s_load_dwordx2 s[28:29], s[0:1], 64
    s_mul_hi_u32 s30, s2, 536870913
    s_mul_i32 s31, s30, 8
    s_sub_u32 s31, s2, s31
    v_lshrrev_b32 v1, 6, v0
    s_nop 0
    v_readfirstlane_b32 s32, v1
    v_and_b32 v1, 63, v0
    s_waitcnt lgkmcnt(0)
    s_mov_b32 s8, s4
    s_mov_b32 s9, s5
    s_and_b32 s9, s9, 0xffff
    s_mov_b32 s10, 268435456
    s_mov_b32 s11, 0x00020000
    s_mov_b32 s12, s6
    s_mov_b32 s13, s7
    s_and_b32 s13, s13, 0xffff
    s_mov_b32 s14, 2621440
    s_mov_b32 s15, 0x00020000
    s_mov_b32 s16, s28
    s_mov_b32 s17, s29
    s_and_b32 s17, s17, 0xffff
    s_mov_b32 s18, 2621440
    s_mov_b32 s19, 0x00020000
    s_mul_i32 s33, s31, 5
    s_add_u32 s33, s33, s32
    s_mul_i32 s33, s33, 49152
    s_add_u32 s33, s33, 6062080
    v_lshlrev_b32 v2, 4, v1
    s_add_u32 s34, s33, 0
    buffer_load_dwordx4 v[14:17], v2, s[8:11], s34 offen
    s_add_u32 s34, s33, 1024
    buffer_load_dwordx4 v[18:21], v2, s[8:11], s34 offen
    s_add_u32 s34, s33, 2048
    buffer_load_dwordx4 v[22:25], v2, s[8:11], s34 offen
    s_add_u32 s34, s33, 3072
    buffer_load_dwordx4 v[26:29], v2, s[8:11], s34 offen
    s_add_u32 s34, s33, 4096
    buffer_load_dwordx4 v[30:33], v2, s[8:11], s34 offen
    s_add_u32 s34, s33, 5120
    buffer_load_dwordx4 v[34:37], v2, s[8:11], s34 offen
    s_add_u32 s34, s33, 6144
    buffer_load_dwordx4 v[38:41], v2, s[8:11], s34 offen
    s_add_u32 s34, s33, 7168
    buffer_load_dwordx4 v[42:45], v2, s[8:11], s34 offen
    s_add_u32 s34, s33, 8192
    buffer_load_dwordx4 v[46:49], v2, s[8:11], s34 offen
    s_add_u32 s34, s33, 9216
    buffer_load_dwordx4 v[50:53], v2, s[8:11], s34 offen
    s_add_u32 s34, s33, 10240
    buffer_load_dwordx4 v[54:57], v2, s[8:11], s34 offen
    s_add_u32 s34, s33, 11264
    buffer_load_dwordx4 v[58:61], v2, s[8:11], s34 offen
    s_add_u32 s34, s33, 12288
    buffer_load_dwordx4 v[62:65], v2, s[8:11], s34 offen
    s_add_u32 s34, s33, 13312
    buffer_load_dwordx4 v[66:69], v2, s[8:11], s34 offen
    s_add_u32 s34, s33, 14336
    buffer_load_dwordx4 v[70:73], v2, s[8:11], s34 offen
    s_add_u32 s34, s33, 15360
    buffer_load_dwordx4 v[74:77], v2, s[8:11], s34 offen
    v_and_b32 v3, 15, v1
    v_lshrrev_b32 v4, 4, v1
    s_lshl_b32 s35, s30, 6
    v_add_u32 v5, s35, v3
    s_mov_b32 s36, 1280
    v_mul_lo_u32 v5, v5, s36
    s_mul_i32 s36, s31, 160
    s_mul_i32 s37, s32, 32
    s_add_u32 s36, s36, s37
    v_lshl_add_u32 v5, v4, 3, v5
    v_add_u32 v5, s36, v5
    s_mov_b32 s34, 19333120
    buffer_load_dwordx2 v[94:95], v5, s[8:11], s34 offen
    s_mov_b32 s34, 19353600
    buffer_load_dwordx2 v[96:97], v5, s[8:11], s34 offen
    s_mov_b32 s34, 19374080
    buffer_load_dwordx2 v[98:99], v5, s[8:11], s34 offen
    s_mov_b32 s34, 19394560
    buffer_load_dwordx2 v[100:101], v5, s[8:11], s34 offen
    s_mov_b32 s34, 11468800
    buffer_load_dwordx2 v[102:103], v5, s[8:11], s34 offen
    s_mov_b32 s34, 11489280
    buffer_load_dwordx2 v[104:105], v5, s[8:11], s34 offen
    s_mov_b32 s34, 11509760
    buffer_load_dwordx2 v[106:107], v5, s[8:11], s34 offen
    s_mov_b32 s34, 11530240
    buffer_load_dwordx2 v[108:109], v5, s[8:11], s34 offen
    v_and_b32 v6, 7, v1
    v_xor_b32 v7, v4, v6
    v_or_b32 v6, 4, v4
    v_and_b32 v3, 7, v1
    v_xor_b32 v6, v6, v3
    v_and_b32 v3, 15, v1
    v_mul_u32_u24 v3, 1536, v3
    v_lshl_add_u32 v7, v7, 4, v3
    v_lshl_add_u32 v6, v6, 4, v3
    v_mov_b32 v78, 0
    v_mov_b32 v79, 0
    v_mov_b32 v80, 0
    v_mov_b32 v81, 0
    v_mov_b32 v82, 0
    v_mov_b32 v83, 0
    v_mov_b32 v84, 0
    v_mov_b32 v85, 0
    v_mov_b32 v86, 0
    v_mov_b32 v87, 0
    v_mov_b32 v88, 0
    v_mov_b32 v89, 0
    v_mov_b32 v90, 0
    v_mov_b32 v91, 0
    v_mov_b32 v92, 0
    v_mov_b32 v93, 0
    s_cmp_ge_u32 s32, 4
    s_cbranch_scc1 mlp2_psk0
    v_and_b32 v3, 15, v1
    s_lshl_b32 s34, s32, 4
    s_add_u32 s34, s34, s35
    v_add_u32 v8, s34, v4
    s_mov_b32 s34, 3072
    v_mul_lo_u32 v8, v8, s34
    v_lshl_add_u32 v8, v3, 4, v8
    s_lshl_b32 s34, s32, 4
    v_add_u32 v9, s34, v4
    v_mul_u32_u24 v9, 1536, v9
    v_and_b32 v3, 15, v1
    v_add_u32 v10, 0, v4
    v_xor_b32 v3, v3, v10
    v_lshl_add_u32 v3, v3, 4, v9
    s_mov_b32 s34, 21954560
    buffer_load_dwordx4 v[110:113], v8, s[8:11], s34 offen
    s_mov_b32 s34, 21954816
    buffer_load_dwordx4 v[114:117], v8, s[8:11], s34 offen
    s_mov_b32 s34, 21955072
    buffer_load_dwordx4 v[118:121], v8, s[8:11], s34 offen
    s_mov_b32 s34, 21955328
    buffer_load_dwordx4 v[122:125], v8, s[8:11], s34 offen
    s_mov_b32 s34, 21955584
    buffer_load_dwordx4 v[126:129], v8, s[8:11], s34 offen
    s_mov_b32 s34, 21955840
    buffer_load_dwordx4 v[130:133], v8, s[8:11], s34 offen
    s_waitcnt vmcnt(0)
    ds_write_b128 v3, v[110:113] offset:0
    ds_write_b128 v3, v[114:117] offset:256
    ds_write_b128 v3, v[118:121] offset:512
    ds_write_b128 v3, v[122:125] offset:768
    ds_write_b128 v3, v[126:129] offset:1024
    ds_write_b128 v3, v[130:133] offset:1280
    s_waitcnt lgkmcnt(0)
    v_and_b32 v3, 15, v1
    v_add_u32 v10, 4, v4
    v_xor_b32 v3, v3, v10
    v_lshl_add_u32 v3, v3, 4, v9
    s_mov_b32 s34, 21966848
    buffer_load_dwordx4 v[110:113], v8, s[8:11], s34 offen
    s_mov_b32 s34, 21967104
    buffer_load_dwordx4 v[114:117], v8, s[8:11], s34 offen
    s_mov_b32 s34, 21967360
    buffer_load_dwordx4 v[118:121], v8, s[8:11], s34 offen
    s_mov_b32 s34, 21967616
    buffer_load_dwordx4 v[122:125], v8, s[8:11], s34 offen
    s_mov_b32 s34, 21967872
    buffer_load_dwordx4 v[126:129], v8, s[8:11], s34 offen
    s_mov_b32 s34, 21968128
    buffer_load_dwordx4 v[130:133], v8, s[8:11], s34 offen
    s_waitcnt vmcnt(0)
    ds_write_b128 v3, v[110:113] offset:6144
    ds_write_b128 v3, v[114:117] offset:6400
    ds_write_b128 v3, v[118:121] offset:6656
    ds_write_b128 v3, v[122:125] offset:6912
    ds_write_b128 v3, v[126:129] offset:7168
    ds_write_b128 v3, v[130:133] offset:7424
    s_waitcnt lgkmcnt(0)
    v_and_b32 v3, 15, v1
    v_add_u32 v10, 0, v4
    v_xor_b32 v3, v3, v10
    v_lshl_add_u32 v3, v3, 4, v9
    s_mov_b32 s34, 21979136
    buffer_load_dwordx4 v[110:113], v8, s[8:11], s34 offen
    s_mov_b32 s34, 21979392
    buffer_load_dwordx4 v[114:117], v8, s[8:11], s34 offen
    s_mov_b32 s34, 21979648
    buffer_load_dwordx4 v[118:121], v8, s[8:11], s34 offen
    s_mov_b32 s34, 21979904
    buffer_load_dwordx4 v[122:125], v8, s[8:11], s34 offen
    s_mov_b32 s34, 21980160
    buffer_load_dwordx4 v[126:129], v8, s[8:11], s34 offen
    s_mov_b32 s34, 21980416
    buffer_load_dwordx4 v[130:133], v8, s[8:11], s34 offen
    s_waitcnt vmcnt(0)
    ds_write_b128 v3, v[110:113] offset:12288
    ds_write_b128 v3, v[114:117] offset:12544
    ds_write_b128 v3, v[118:121] offset:12800
    ds_write_b128 v3, v[122:125] offset:13056
    ds_write_b128 v3, v[126:129] offset:13312
    ds_write_b128 v3, v[130:133] offset:13568
    s_waitcnt lgkmcnt(0)
    v_and_b32 v3, 15, v1
    v_add_u32 v10, 4, v4
    v_xor_b32 v3, v3, v10
    v_lshl_add_u32 v3, v3, 4, v9
    s_mov_b32 s34, 21991424
    buffer_load_dwordx4 v[110:113], v8, s[8:11], s34 offen
    s_mov_b32 s34, 21991680
    buffer_load_dwordx4 v[114:117], v8, s[8:11], s34 offen
    s_mov_b32 s34, 21991936
    buffer_load_dwordx4 v[118:121], v8, s[8:11], s34 offen
    s_mov_b32 s34, 21992192
    buffer_load_dwordx4 v[122:125], v8, s[8:11], s34 offen
    s_mov_b32 s34, 21992448
    buffer_load_dwordx4 v[126:129], v8, s[8:11], s34 offen
    s_mov_b32 s34, 21992704
    buffer_load_dwordx4 v[130:133], v8, s[8:11], s34 offen
    s_waitcnt vmcnt(0)
    ds_write_b128 v3, v[110:113] offset:18432
    ds_write_b128 v3, v[114:117] offset:18688
    ds_write_b128 v3, v[118:121] offset:18944
    ds_write_b128 v3, v[122:125] offset:19200
    ds_write_b128 v3, v[126:129] offset:19456
    ds_write_b128 v3, v[130:133] offset:19712
    s_waitcnt lgkmcnt(0)
mlp2_psk0:
    s_waitcnt vmcnt(0) lgkmcnt(0)
    s_barrier
    ds_read_b128 v[110:113], v7 offset:0
    ds_read_b128 v[114:117], v7 offset:24576
    ds_read_b128 v[118:121], v7 offset:49152
    v_add_u32 v3, 73728, v7
    ds_read_b128 v[122:125], v3 offset:0
    ds_read_b128 v[126:129], v6 offset:0
    ds_read_b128 v[130:133], v6 offset:24576
    ds_read_b128 v[134:137], v6 offset:49152
    v_add_u32 v3, 73728, v6
    ds_read_b128 v[138:141], v3 offset:0
    s_waitcnt vmcnt(15) lgkmcnt(4)
    v_mfma_f32_16x16x32_bf16 v[78:81], v[14:17], v[110:113], v[78:81]
    v_mfma_f32_16x16x32_bf16 v[82:85], v[14:17], v[114:117], v[82:85]
    v_mfma_f32_16x16x32_bf16 v[86:89], v[14:17], v[118:121], v[86:89]
    v_mfma_f32_16x16x32_bf16 v[90:93], v[14:17], v[122:125], v[90:93]
    s_add_u32 s34, s33, 16384
    buffer_load_dwordx4 v[14:17], v2, s[8:11], s34 offen
    ds_read_b128 v[110:113], v7 offset:128
    ds_read_b128 v[114:117], v7 offset:24704
    ds_read_b128 v[118:121], v7 offset:49280
    v_add_u32 v3, 73728, v7
    ds_read_b128 v[122:125], v3 offset:128
    s_waitcnt vmcnt(15) lgkmcnt(4)
    v_mfma_f32_16x16x32_bf16 v[78:81], v[18:21], v[126:129], v[78:81]
    v_mfma_f32_16x16x32_bf16 v[82:85], v[18:21], v[130:133], v[82:85]
    v_mfma_f32_16x16x32_bf16 v[86:89], v[18:21], v[134:137], v[86:89]
    v_mfma_f32_16x16x32_bf16 v[90:93], v[18:21], v[138:141], v[90:93]
    s_add_u32 s34, s33, 17408
    buffer_load_dwordx4 v[18:21], v2, s[8:11], s34 offen
    ds_read_b128 v[126:129], v6 offset:128
    ds_read_b128 v[130:133], v6 offset:24704
    ds_read_b128 v[134:137], v6 offset:49280
    v_add_u32 v3, 73728, v6
    ds_read_b128 v[138:141], v3 offset:128
    s_waitcnt vmcnt(15) lgkmcnt(4)
    v_mfma_f32_16x16x32_bf16 v[78:81], v[22:25], v[110:113], v[78:81]
    v_mfma_f32_16x16x32_bf16 v[82:85], v[22:25], v[114:117], v[82:85]
    v_mfma_f32_16x16x32_bf16 v[86:89], v[22:25], v[118:121], v[86:89]
    v_mfma_f32_16x16x32_bf16 v[90:93], v[22:25], v[122:125], v[90:93]
    s_add_u32 s34, s33, 18432
    buffer_load_dwordx4 v[22:25], v2, s[8:11], s34 offen
    ds_read_b128 v[110:113], v7 offset:256
    ds_read_b128 v[114:117], v7 offset:24832
    ds_read_b128 v[118:121], v7 offset:49408
    v_add_u32 v3, 73728, v7
    ds_read_b128 v[122:125], v3 offset:256
    s_waitcnt vmcnt(15) lgkmcnt(4)
    v_mfma_f32_16x16x32_bf16 v[78:81], v[26:29], v[126:129], v[78:81]
    v_mfma_f32_16x16x32_bf16 v[82:85], v[26:29], v[130:133], v[82:85]
    v_mfma_f32_16x16x32_bf16 v[86:89], v[26:29], v[134:137], v[86:89]
    v_mfma_f32_16x16x32_bf16 v[90:93], v[26:29], v[138:141], v[90:93]
    s_add_u32 s34, s33, 19456
    buffer_load_dwordx4 v[26:29], v2, s[8:11], s34 offen
    ds_read_b128 v[126:129], v6 offset:256
    ds_read_b128 v[130:133], v6 offset:24832
    ds_read_b128 v[134:137], v6 offset:49408
    v_add_u32 v3, 73728, v6
    ds_read_b128 v[138:141], v3 offset:256
    s_waitcnt vmcnt(15) lgkmcnt(4)
    v_mfma_f32_16x16x32_bf16 v[78:81], v[30:33], v[110:113], v[78:81]
    v_mfma_f32_16x16x32_bf16 v[82:85], v[30:33], v[114:117], v[82:85]
    v_mfma_f32_16x16x32_bf16 v[86:89], v[30:33], v[118:121], v[86:89]
    v_mfma_f32_16x16x32_bf16 v[90:93], v[30:33], v[122:125], v[90:93]
    s_add_u32 s34, s33, 20480
    buffer_load_dwordx4 v[30:33], v2, s[8:11], s34 offen
    ds_read_b128 v[110:113], v7 offset:384
    ds_read_b128 v[114:117], v7 offset:24960
    ds_read_b128 v[118:121], v7 offset:49536
    v_add_u32 v3, 73728, v7
    ds_read_b128 v[122:125], v3 offset:384
    s_waitcnt vmcnt(15) lgkmcnt(4)
    v_mfma_f32_16x16x32_bf16 v[78:81], v[34:37], v[126:129], v[78:81]
    v_mfma_f32_16x16x32_bf16 v[82:85], v[34:37], v[130:133], v[82:85]
    v_mfma_f32_16x16x32_bf16 v[86:89], v[34:37], v[134:137], v[86:89]
    v_mfma_f32_16x16x32_bf16 v[90:93], v[34:37], v[138:141], v[90:93]
    s_add_u32 s34, s33, 21504
    buffer_load_dwordx4 v[34:37], v2, s[8:11], s34 offen
    ds_read_b128 v[126:129], v6 offset:384
    ds_read_b128 v[130:133], v6 offset:24960
    ds_read_b128 v[134:137], v6 offset:49536
    v_add_u32 v3, 73728, v6
    ds_read_b128 v[138:141], v3 offset:384
    s_waitcnt vmcnt(15) lgkmcnt(4)
    v_mfma_f32_16x16x32_bf16 v[78:81], v[38:41], v[110:113], v[78:81]
    v_mfma_f32_16x16x32_bf16 v[82:85], v[38:41], v[114:117], v[82:85]
    v_mfma_f32_16x16x32_bf16 v[86:89], v[38:41], v[118:121], v[86:89]
    v_mfma_f32_16x16x32_bf16 v[90:93], v[38:41], v[122:125], v[90:93]
    s_add_u32 s34, s33, 22528
    buffer_load_dwordx4 v[38:41], v2, s[8:11], s34 offen
    ds_read_b128 v[110:113], v7 offset:512
    ds_read_b128 v[114:117], v7 offset:25088
    ds_read_b128 v[118:121], v7 offset:49664
    v_add_u32 v3, 73728, v7
    ds_read_b128 v[122:125], v3 offset:512
    s_waitcnt vmcnt(15) lgkmcnt(4)
    v_mfma_f32_16x16x32_bf16 v[78:81], v[42:45], v[126:129], v[78:81]
    v_mfma_f32_16x16x32_bf16 v[82:85], v[42:45], v[130:133], v[82:85]
    v_mfma_f32_16x16x32_bf16 v[86:89], v[42:45], v[134:137], v[86:89]
    v_mfma_f32_16x16x32_bf16 v[90:93], v[42:45], v[138:141], v[90:93]
    s_add_u32 s34, s33, 23552
    buffer_load_dwordx4 v[42:45], v2, s[8:11], s34 offen
    ds_read_b128 v[126:129], v6 offset:512
    ds_read_b128 v[130:133], v6 offset:25088
    ds_read_b128 v[134:137], v6 offset:49664
    v_add_u32 v3, 73728, v6
    ds_read_b128 v[138:141], v3 offset:512
    s_waitcnt vmcnt(15) lgkmcnt(4)
    v_mfma_f32_16x16x32_bf16 v[78:81], v[46:49], v[110:113], v[78:81]
    v_mfma_f32_16x16x32_bf16 v[82:85], v[46:49], v[114:117], v[82:85]
    v_mfma_f32_16x16x32_bf16 v[86:89], v[46:49], v[118:121], v[86:89]
    v_mfma_f32_16x16x32_bf16 v[90:93], v[46:49], v[122:125], v[90:93]
    s_add_u32 s34, s33, 24576
    buffer_load_dwordx4 v[46:49], v2, s[8:11], s34 offen
    ds_read_b128 v[110:113], v7 offset:640
    ds_read_b128 v[114:117], v7 offset:25216
    ds_read_b128 v[118:121], v7 offset:49792
    v_add_u32 v3, 73728, v7
    ds_read_b128 v[122:125], v3 offset:640
    s_waitcnt vmcnt(15) lgkmcnt(4)
    v_mfma_f32_16x16x32_bf16 v[78:81], v[50:53], v[126:129], v[78:81]
    v_mfma_f32_16x16x32_bf16 v[82:85], v[50:53], v[130:133], v[82:85]
    v_mfma_f32_16x16x32_bf16 v[86:89], v[50:53], v[134:137], v[86:89]
    v_mfma_f32_16x16x32_bf16 v[90:93], v[50:53], v[138:141], v[90:93]
    s_add_u32 s34, s33, 25600
    buffer_load_dwordx4 v[50:53], v2, s[8:11], s34 offen
    ds_read_b128 v[126:129], v6 offset:640
    ds_read_b128 v[130:133], v6 offset:25216
    ds_read_b128 v[134:137], v6 offset:49792
    v_add_u32 v3, 73728, v6
    ds_read_b128 v[138:141], v3 offset:640
    s_waitcnt vmcnt(15) lgkmcnt(4)
    v_mfma_f32_16x16x32_bf16 v[78:81], v[54:57], v[110:113], v[78:81]
    v_mfma_f32_16x16x32_bf16 v[82:85], v[54:57], v[114:117], v[82:85]
    v_mfma_f32_16x16x32_bf16 v[86:89], v[54:57], v[118:121], v[86:89]
    v_mfma_f32_16x16x32_bf16 v[90:93], v[54:57], v[122:125], v[90:93]
    s_add_u32 s34, s33, 26624
    buffer_load_dwordx4 v[54:57], v2, s[8:11], s34 offen
    ds_read_b128 v[110:113], v7 offset:768
    ds_read_b128 v[114:117], v7 offset:25344
    ds_read_b128 v[118:121], v7 offset:49920
    v_add_u32 v3, 73728, v7
    ds_read_b128 v[122:125], v3 offset:768
    s_waitcnt vmcnt(15) lgkmcnt(4)
    v_mfma_f32_16x16x32_bf16 v[78:81], v[58:61], v[126:129], v[78:81]
    v_mfma_f32_16x16x32_bf16 v[82:85], v[58:61], v[130:133], v[82:85]
    v_mfma_f32_16x16x32_bf16 v[86:89], v[58:61], v[134:137], v[86:89]
    v_mfma_f32_16x16x32_bf16 v[90:93], v[58:61], v[138:141], v[90:93]
    s_add_u32 s34, s33, 27648
    buffer_load_dwordx4 v[58:61], v2, s[8:11], s34 offen
    ds_read_b128 v[126:129], v6 offset:768
    ds_read_b128 v[130:133], v6 offset:25344
    ds_read_b128 v[134:137], v6 offset:49920
    v_add_u32 v3, 73728, v6
    ds_read_b128 v[138:141], v3 offset:768
    s_waitcnt vmcnt(15) lgkmcnt(4)
    v_mfma_f32_16x16x32_bf16 v[78:81], v[62:65], v[110:113], v[78:81]
    v_mfma_f32_16x16x32_bf16 v[82:85], v[62:65], v[114:117], v[82:85]
    v_mfma_f32_16x16x32_bf16 v[86:89], v[62:65], v[118:121], v[86:89]
    v_mfma_f32_16x16x32_bf16 v[90:93], v[62:65], v[122:125], v[90:93]
    s_add_u32 s34, s33, 28672
    buffer_load_dwordx4 v[62:65], v2, s[8:11], s34 offen
    ds_read_b128 v[110:113], v7 offset:896
    ds_read_b128 v[114:117], v7 offset:25472
    ds_read_b128 v[118:121], v7 offset:50048
    v_add_u32 v3, 73728, v7
    ds_read_b128 v[122:125], v3 offset:896
    s_waitcnt vmcnt(15) lgkmcnt(4)
    v_mfma_f32_16x16x32_bf16 v[78:81], v[66:69], v[126:129], v[78:81]
    v_mfma_f32_16x16x32_bf16 v[82:85], v[66:69], v[130:133], v[82:85]
    v_mfma_f32_16x16x32_bf16 v[86:89], v[66:69], v[134:137], v[86:89]
    v_mfma_f32_16x16x32_bf16 v[90:93], v[66:69], v[138:141], v[90:93]
    s_add_u32 s34, s33, 29696
    buffer_load_dwordx4 v[66:69], v2, s[8:11], s34 offen
    ds_read_b128 v[126:129], v6 offset:896
    ds_read_b128 v[130:133], v6 offset:25472
    ds_read_b128 v[134:137], v6 offset:50048
    v_add_u32 v3, 73728, v6
    ds_read_b128 v[138:141], v3 offset:896
    s_waitcnt vmcnt(15) lgkmcnt(4)
    v_mfma_f32_16x16x32_bf16 v[78:81], v[70:73], v[110:113], v[78:81]
    v_mfma_f32_16x16x32_bf16 v[82:85], v[70:73], v[114:117], v[82:85]
    v_mfma_f32_16x16x32_bf16 v[86:89], v[70:73], v[118:121], v[86:89]
    v_mfma_f32_16x16x32_bf16 v[90:93], v[70:73], v[122:125], v[90:93]
    s_add_u32 s34, s33, 30720
    buffer_load_dwordx4 v[70:73], v2, s[8:11], s34 offen
    ds_read_b128 v[110:113], v7 offset:1024
    ds_read_b128 v[114:117], v7 offset:25600
    ds_read_b128 v[118:121], v7 offset:50176
    v_add_u32 v3, 73728, v7
    ds_read_b128 v[122:125], v3 offset:1024
    s_waitcnt vmcnt(15) lgkmcnt(4)
    v_mfma_f32_16x16x32_bf16 v[78:81], v[74:77], v[126:129], v[78:81]
    v_mfma_f32_16x16x32_bf16 v[82:85], v[74:77], v[130:133], v[82:85]
    v_mfma_f32_16x16x32_bf16 v[86:89], v[74:77], v[134:137], v[86:89]
    v_mfma_f32_16x16x32_bf16 v[90:93], v[74:77], v[138:141], v[90:93]
    s_add_u32 s34, s33, 31744
    buffer_load_dwordx4 v[74:77], v2, s[8:11], s34 offen
    ds_read_b128 v[126:129], v6 offset:1024
    ds_read_b128 v[130:133], v6 offset:25600
    ds_read_b128 v[134:137], v6 offset:50176
    v_add_u32 v3, 73728, v6
    ds_read_b128 v[138:141], v3 offset:1024
    s_waitcnt vmcnt(15) lgkmcnt(4)
    v_mfma_f32_16x16x32_bf16 v[78:81], v[14:17], v[110:113], v[78:81]
    v_mfma_f32_16x16x32_bf16 v[82:85], v[14:17], v[114:117], v[82:85]
    v_mfma_f32_16x16x32_bf16 v[86:89], v[14:17], v[118:121], v[86:89]
    v_mfma_f32_16x16x32_bf16 v[90:93], v[14:17], v[122:125], v[90:93]
    s_add_u32 s34, s33, 32768
    buffer_load_dwordx4 v[14:17], v2, s[8:11], s34 offen
    ds_read_b128 v[110:113], v7 offset:1152
    ds_read_b128 v[114:117], v7 offset:25728
    ds_read_b128 v[118:121], v7 offset:50304
    v_add_u32 v3, 73728, v7
    ds_read_b128 v[122:125], v3 offset:1152
    s_waitcnt vmcnt(15) lgkmcnt(4)
    v_mfma_f32_16x16x32_bf16 v[78:81], v[18:21], v[126:129], v[78:81]
    v_mfma_f32_16x16x32_bf16 v[82:85], v[18:21], v[130:133], v[82:85]
    v_mfma_f32_16x16x32_bf16 v[86:89], v[18:21], v[134:137], v[86:89]
    v_mfma_f32_16x16x32_bf16 v[90:93], v[18:21], v[138:141], v[90:93]
    s_add_u32 s34, s33, 33792
    buffer_load_dwordx4 v[18:21], v2, s[8:11], s34 offen
    ds_read_b128 v[126:129], v6 offset:1152
    ds_read_b128 v[130:133], v6 offset:25728
    ds_read_b128 v[134:137], v6 offset:50304
    v_add_u32 v3, 73728, v6
    ds_read_b128 v[138:141], v3 offset:1152
    s_waitcnt vmcnt(15) lgkmcnt(4)
    v_mfma_f32_16x16x32_bf16 v[78:81], v[22:25], v[110:113], v[78:81]
    v_mfma_f32_16x16x32_bf16 v[82:85], v[22:25], v[114:117], v[82:85]
    v_mfma_f32_16x16x32_bf16 v[86:89], v[22:25], v[118:121], v[86:89]
    v_mfma_f32_16x16x32_bf16 v[90:93], v[22:25], v[122:125], v[90:93]
    s_add_u32 s34, s33, 34816
    buffer_load_dwordx4 v[22:25], v2, s[8:11], s34 offen
    ds_read_b128 v[110:113], v7 offset:1280
    ds_read_b128 v[114:117], v7 offset:25856
    ds_read_b128 v[118:121], v7 offset:50432
    v_add_u32 v3, 73728, v7
    ds_read_b128 v[122:125], v3 offset:1280
    s_waitcnt vmcnt(15) lgkmcnt(4)
    v_mfma_f32_16x16x32_bf16 v[78:81], v[26:29], v[126:129], v[78:81]
    v_mfma_f32_16x16x32_bf16 v[82:85], v[26:29], v[130:133], v[82:85]
    v_mfma_f32_16x16x32_bf16 v[86:89], v[26:29], v[134:137], v[86:89]
    v_mfma_f32_16x16x32_bf16 v[90:93], v[26:29], v[138:141], v[90:93]
    s_add_u32 s34, s33, 35840
    buffer_load_dwordx4 v[26:29], v2, s[8:11], s34 offen
    ds_read_b128 v[126:129], v6 offset:1280
    ds_read_b128 v[130:133], v6 offset:25856
    ds_read_b128 v[134:137], v6 offset:50432
    v_add_u32 v3, 73728, v6
    ds_read_b128 v[138:141], v3 offset:1280
    s_waitcnt vmcnt(15) lgkmcnt(4)
    v_mfma_f32_16x16x32_bf16 v[78:81], v[30:33], v[110:113], v[78:81]
    v_mfma_f32_16x16x32_bf16 v[82:85], v[30:33], v[114:117], v[82:85]
    v_mfma_f32_16x16x32_bf16 v[86:89], v[30:33], v[118:121], v[86:89]
    v_mfma_f32_16x16x32_bf16 v[90:93], v[30:33], v[122:125], v[90:93]
    s_add_u32 s34, s33, 36864
    buffer_load_dwordx4 v[30:33], v2, s[8:11], s34 offen
    ds_read_b128 v[110:113], v7 offset:1408
    ds_read_b128 v[114:117], v7 offset:25984
    ds_read_b128 v[118:121], v7 offset:50560
    v_add_u32 v3, 73728, v7
    ds_read_b128 v[122:125], v3 offset:1408
    s_waitcnt vmcnt(15) lgkmcnt(4)
    v_mfma_f32_16x16x32_bf16 v[78:81], v[34:37], v[126:129], v[78:81]
    v_mfma_f32_16x16x32_bf16 v[82:85], v[34:37], v[130:133], v[82:85]
    v_mfma_f32_16x16x32_bf16 v[86:89], v[34:37], v[134:137], v[86:89]
    v_mfma_f32_16x16x32_bf16 v[90:93], v[34:37], v[138:141], v[90:93]
    s_add_u32 s34, s33, 37888
    buffer_load_dwordx4 v[34:37], v2, s[8:11], s34 offen
    ds_read_b128 v[126:129], v6 offset:1408
    ds_read_b128 v[130:133], v6 offset:25984
    ds_read_b128 v[134:137], v6 offset:50560
    v_add_u32 v3, 73728, v6
    ds_read_b128 v[138:141], v3 offset:1408
    s_waitcnt vmcnt(15) lgkmcnt(4)
    v_mfma_f32_16x16x32_bf16 v[78:81], v[38:41], v[110:113], v[78:81]
    v_mfma_f32_16x16x32_bf16 v[82:85], v[38:41], v[114:117], v[82:85]
    v_mfma_f32_16x16x32_bf16 v[86:89], v[38:41], v[118:121], v[86:89]
    v_mfma_f32_16x16x32_bf16 v[90:93], v[38:41], v[122:125], v[90:93]
    s_add_u32 s34, s33, 38912
    buffer_load_dwordx4 v[38:41], v2, s[8:11], s34 offen
    s_waitcnt vmcnt(15) lgkmcnt(0)
    v_mfma_f32_16x16x32_bf16 v[78:81], v[42:45], v[126:129], v[78:81]
    v_mfma_f32_16x16x32_bf16 v[82:85], v[42:45], v[130:133], v[82:85]
    v_mfma_f32_16x16x32_bf16 v[86:89], v[42:45], v[134:137], v[86:89]
    v_mfma_f32_16x16x32_bf16 v[90:93], v[42:45], v[138:141], v[90:93]
    s_add_u32 s34, s33, 39936
    buffer_load_dwordx4 v[42:45], v2, s[8:11], s34 offen
    s_barrier
    s_cmp_ge_u32 s32, 4
    s_cbranch_scc1 mlp2_psk1
    v_and_b32 v3, 15, v1
    s_lshl_b32 s34, s32, 4
    s_add_u32 s34, s34, s35
    v_add_u32 v8, s34, v4
    s_mov_b32 s34, 3072
    v_mul_lo_u32 v8, v8, s34
    v_lshl_add_u32 v8, v3, 4, v8
    s_lshl_b32 s34, s32, 4
    v_add_u32 v9, s34, v4
    v_mul_u32_u24 v9, 1536, v9
    v_and_b32 v3, 15, v1
    v_add_u32 v10, 0, v4
    v_xor_b32 v3, v3, v10
    v_lshl_add_u32 v3, v3, 4, v9
    s_mov_b32 s34, 21956096
    buffer_load_dwordx4 v[110:113], v8, s[8:11], s34 offen
    s_mov_b32 s34, 21956352
    buffer_load_dwordx4 v[114:117], v8, s[8:11], s34 offen
    s_mov_b32 s34, 21956608
    buffer_load_dwordx4 v[118:121], v8, s[8:11], s34 offen
    s_mov_b32 s34, 21956864
    buffer_load_dwordx4 v[122:125], v8, s[8:11], s34 offen
    s_mov_b32 s34, 21957120
    buffer_load_dwordx4 v[126:129], v8, s[8:11], s34 offen
    s_mov_b32 s34, 21957376
    buffer_load_dwordx4 v[130:133], v8, s[8:11], s34 offen
    s_waitcnt vmcnt(0)
    ds_write_b128 v3, v[110:113] offset:0
    ds_write_b128 v3, v[114:117] offset:256
    ds_write_b128 v3, v[118:121] offset:512
    ds_write_b128 v3, v[122:125] offset:768
    ds_write_b128 v3, v[126:129] offset:1024
    ds_write_b128 v3, v[130:133] offset:1280
    s_waitcnt lgkmcnt(0)
    v_and_b32 v3, 15, v1
    v_add_u32 v10, 4, v4
    v_xor_b32 v3, v3, v10
    v_lshl_add_u32 v3, v3, 4, v9
    s_mov_b32 s34, 21968384
    buffer_load_dwordx4 v[110:113], v8, s[8:11], s34 offen
    s_mov_b32 s34, 21968640
    buffer_load_dwordx4 v[114:117], v8, s[8:11], s34 offen
    s_mov_b32 s34, 21968896
    buffer_load_dwordx4 v[118:121], v8, s[8:11], s34 offen
    s_mov_b32 s34, 21969152
    buffer_load_dwordx4 v[122:125], v8, s[8:11], s34 offen
    s_mov_b32 s34, 21969408
    buffer_load_dwordx4 v[126:129], v8, s[8:11], s34 offen
    s_mov_b32 s34, 21969664
    buffer_load_dwordx4 v[130:133], v8, s[8:11], s34 offen
    s_waitcnt vmcnt(0)
    ds_write_b128 v3, v[110:113] offset:6144
    ds_write_b128 v3, v[114:117] offset:6400
    ds_write_b128 v3, v[118:121] offset:6656
    ds_write_b128 v3, v[122:125] offset:6912
    ds_write_b128 v3, v[126:129] offset:7168
    ds_write_b128 v3, v[130:133] offset:7424
    s_waitcnt lgkmcnt(0)
    v_and_b32 v3, 15, v1
    v_add_u32 v10, 0, v4
    v_xor_b32 v3, v3, v10
    v_lshl_add_u32 v3, v3, 4, v9
    s_mov_b32 s34, 21980672
    buffer_load_dwordx4 v[110:113], v8, s[8:11], s34 offen
    s_mov_b32 s34, 21980928
    buffer_load_dwordx4 v[114:117], v8, s[8:11], s34 offen
    s_mov_b32 s34, 21981184
    buffer_load_dwordx4 v[118:121], v8, s[8:11], s34 offen
    s_mov_b32 s34, 21981440
    buffer_load_dwordx4 v[122:125], v8, s[8:11], s34 offen
    s_mov_b32 s34, 21981696
    buffer_load_dwordx4 v[126:129], v8, s[8:11], s34 offen
    s_mov_b32 s34, 21981952
    buffer_load_dwordx4 v[130:133], v8, s[8:11], s34 offen
    s_waitcnt vmcnt(0)
    ds_write_b128 v3, v[110:113] offset:12288
    ds_write_b128 v3, v[114:117] offset:12544
    ds_write_b128 v3, v[118:121] offset:12800
    ds_write_b128 v3, v[122:125] offset:13056
    ds_write_b128 v3, v[126:129] offset:13312
    ds_write_b128 v3, v[130:133] offset:13568
    s_waitcnt lgkmcnt(0)
    v_and_b32 v3, 15, v1
    v_add_u32 v10, 4, v4
    v_xor_b32 v3, v3, v10
    v_lshl_add_u32 v3, v3, 4, v9
    s_mov_b32 s34, 21992960
    buffer_load_dwordx4 v[110:113], v8, s[8:11], s34 offen
    s_mov_b32 s34, 21993216
    buffer_load_dwordx4 v[114:117], v8, s[8:11], s34 offen
    s_mov_b32 s34, 21993472
    buffer_load_dwordx4 v[118:121], v8, s[8:11], s34 offen
    s_mov_b32 s34, 21993728
    buffer_load_dwordx4 v[122:125], v8, s[8:11], s34 offen
    s_mov_b32 s34, 21993984
    buffer_load_dwordx4 v[126:129], v8, s[8:11], s34 offen
    s_mov_b32 s34, 21994240
    buffer_load_dwordx4 v[130:133], v8, s[8:11], s34 offen
    s_waitcnt vmcnt(0)
    ds_write_b128 v3, v[110:113] offset:18432
    ds_write_b128 v3, v[114:117] offset:18688
    ds_write_b128 v3, v[118:121] offset:18944
    ds_write_b128 v3, v[122:125] offset:19200
    ds_write_b128 v3, v[126:129] offset:19456
    ds_write_b128 v3, v[130:133] offset:19712
    s_waitcnt lgkmcnt(0)
mlp2_psk1:
    s_waitcnt vmcnt(0) lgkmcnt(0)
    s_barrier
    ds_read_b128 v[110:113], v7 offset:0
    ds_read_b128 v[114:117], v7 offset:24576
    ds_read_b128 v[118:121], v7 offset:49152
    v_add_u32 v3, 73728, v7
    ds_read_b128 v[122:125], v3 offset:0
    ds_read_b128 v[126:129], v6 offset:0
    ds_read_b128 v[130:133], v6 offset:24576
    ds_read_b128 v[134:137], v6 offset:49152
    v_add_u32 v3, 73728, v6
    ds_read_b128 v[138:141], v3 offset:0
    s_waitcnt vmcnt(15) lgkmcnt(4)
    v_mfma_f32_16x16x32_bf16 v[78:81], v[46:49], v[110:113], v[78:81]
    v_mfma_f32_16x16x32_bf16 v[82:85], v[46:49], v[114:117], v[82:85]
    v_mfma_f32_16x16x32_bf16 v[86:89], v[46:49], v[118:121], v[86:89]
    v_mfma_f32_16x16x32_bf16 v[90:93], v[46:49], v[122:125], v[90:93]
    s_add_u32 s34, s33, 40960
    buffer_load_dwordx4 v[46:49], v2, s[8:11], s34 offen
    ds_read_b128 v[110:113], v7 offset:128
    ds_read_b128 v[114:117], v7 offset:24704
    ds_read_b128 v[118:121], v7 offset:49280
    v_add_u32 v3, 73728, v7
    ds_read_b128 v[122:125], v3 offset:128
    s_waitcnt vmcnt(15) lgkmcnt(4)
    v_mfma_f32_16x16x32_bf16 v[78:81], v[50:53], v[126:129], v[78:81]
    v_mfma_f32_16x16x32_bf16 v[82:85], v[50:53], v[130:133], v[82:85]
    v_mfma_f32_16x16x32_bf16 v[86:89], v[50:53], v[134:137], v[86:89]
    v_mfma_f32_16x16x32_bf16 v[90:93], v[50:53], v[138:141], v[90:93]
    s_add_u32 s34, s33, 41984
    buffer_load_dwordx4 v[50:53], v2, s[8:11], s34 offen
    ds_read_b128 v[126:129], v6 offset:128
    ds_read_b128 v[130:133], v6 offset:24704
    ds_read_b128 v[134:137], v6 offset:49280
    v_add_u32 v3, 73728, v6
    ds_read_b128 v[138:141], v3 offset:128
    s_waitcnt vmcnt(15) lgkmcnt(4)
    v_mfma_f32_16x16x32_bf16 v[78:81], v[54:57], v[110:113], v[78:81]
    v_mfma_f32_16x16x32_bf16 v[82:85], v[54:57], v[114:117], v[82:85]
    v_mfma_f32_16x16x32_bf16 v[86:89], v[54:57], v[118:121], v[86:89]
    v_mfma_f32_16x16x32_bf16 v[90:93], v[54:57], v[122:125], v[90:93]
    s_add_u32 s34, s33, 43008
    buffer_load_dwordx4 v[54:57], v2, s[8:11], s34 offen
    ds_read_b128 v[110:113], v7 offset:256
    ds_read_b128 v[114:117], v7 offset:24832
    ds_read_b128 v[118:121], v7 offset:49408
    v_add_u32 v3, 73728, v7
    ds_read_b128 v[122:125], v3 offset:256
    s_waitcnt vmcnt(15) lgkmcnt(4)
    v_mfma_f32_16x16x32_bf16 v[78:81], v[58:61], v[126:129], v[78:81]
    v_mfma_f32_16x16x32_bf16 v[82:85], v[58:61], v[130:133], v[82:85]
    v_mfma_f32_16x16x32_bf16 v[86:89], v[58:61], v[134:137], v[86:89]
    v_mfma_f32_16x16x32_bf16 v[90:93], v[58:61], v[138:141], v[90:93]
    s_add_u32 s34, s33, 44032
    buffer_load_dwordx4 v[58:61], v2, s[8:11], s34 offen
    ds_read_b128 v[126:129], v6 offset:256
    ds_read_b128 v[130:133], v6 offset:24832
    ds_read_b128 v[134:137], v6 offset:49408
    v_add_u32 v3, 73728, v6
    ds_read_b128 v[138:141], v3 offset:256
    s_waitcnt vmcnt(15) lgkmcnt(4)
    v_mfma_f32_16x16x32_bf16 v[78:81], v[62:65], v[110:113], v[78:81]
    v_mfma_f32_16x16x32_bf16 v[82:85], v[62:65], v[114:117], v[82:85]
    v_mfma_f32_16x16x32_bf16 v[86:89], v[62:65], v[118:121], v[86:89]
    v_mfma_f32_16x16x32_bf16 v[90:93], v[62:65], v[122:125], v[90:93]
    s_add_u32 s34, s33, 45056
    buffer_load_dwordx4 v[62:65], v2, s[8:11], s34 offen
    ds_read_b128 v[110:113], v7 offset:384
    ds_read_b128 v[114:117], v7 offset:24960
    ds_read_b128 v[118:121], v7 offset:49536
    v_add_u32 v3, 73728, v7
    ds_read_b128 v[122:125], v3 offset:384
    s_waitcnt vmcnt(15) lgkmcnt(4)
    v_mfma_f32_16x16x32_bf16 v[78:81], v[66:69], v[126:129], v[78:81]
    v_mfma_f32_16x16x32_bf16 v[82:85], v[66:69], v[130:133], v[82:85]
    v_mfma_f32_16x16x32_bf16 v[86:89], v[66:69], v[134:137], v[86:89]
    v_mfma_f32_16x16x32_bf16 v[90:93], v[66:69], v[138:141], v[90:93]
    s_add_u32 s34, s33, 46080
    buffer_load_dwordx4 v[66:69], v2, s[8:11], s34 offen
    ds_read_b128 v[126:129], v6 offset:384
    ds_read_b128 v[130:133], v6 offset:24960
    ds_read_b128 v[134:137], v6 offset:49536
    v_add_u32 v3, 73728, v6
    ds_read_b128 v[138:141], v3 offset:384
    s_waitcnt vmcnt(15) lgkmcnt(4)
    v_mfma_f32_16x16x32_bf16 v[78:81], v[70:73], v[110:113], v[78:81]
    v_mfma_f32_16x16x32_bf16 v[82:85], v[70:73], v[114:117], v[82:85]
    v_mfma_f32_16x16x32_bf16 v[86:89], v[70:73], v[118:121], v[86:89]
    v_mfma_f32_16x16x32_bf16 v[90:93], v[70:73], v[122:125], v[90:93]
    s_add_u32 s34, s33, 47104
    buffer_load_dwordx4 v[70:73], v2, s[8:11], s34 offen
    ds_read_b128 v[110:113], v7 offset:512
    ds_read_b128 v[114:117], v7 offset:25088
    ds_read_b128 v[118:121], v7 offset:49664
    v_add_u32 v3, 73728, v7
    ds_read_b128 v[122:125], v3 offset:512
    s_waitcnt vmcnt(15) lgkmcnt(4)
    v_mfma_f32_16x16x32_bf16 v[78:81], v[74:77], v[126:129], v[78:81]
    v_mfma_f32_16x16x32_bf16 v[82:85], v[74:77], v[130:133], v[82:85]
    v_mfma_f32_16x16x32_bf16 v[86:89], v[74:77], v[134:137], v[86:89]
    v_mfma_f32_16x16x32_bf16 v[90:93], v[74:77], v[138:141], v[90:93]
    s_add_u32 s34, s33, 48128
    buffer_load_dwordx4 v[74:77], v2, s[8:11], s34 offen
    ds_read_b128 v[126:129], v6 offset:512
    ds_read_b128 v[130:133], v6 offset:25088
    ds_read_b128 v[134:137], v6 offset:49664
    v_add_u32 v3, 73728, v6
    ds_read_b128 v[138:141], v3 offset:512
    s_waitcnt vmcnt(15) lgkmcnt(4)
    v_mfma_f32_16x16x32_bf16 v[78:81], v[14:17], v[110:113], v[78:81]
    v_mfma_f32_16x16x32_bf16 v[82:85], v[14:17], v[114:117], v[82:85]
    v_mfma_f32_16x16x32_bf16 v[86:89], v[14:17], v[118:121], v[86:89]
    v_mfma_f32_16x16x32_bf16 v[90:93], v[14:17], v[122:125], v[90:93]
    ds_read_b128 v[110:113], v7 offset:640
    ds_read_b128 v[114:117], v7 offset:25216
    ds_read_b128 v[118:121], v7 offset:49792
    v_add_u32 v3, 73728, v7
    ds_read_b128 v[122:125], v3 offset:640
    s_waitcnt vmcnt(14) lgkmcnt(4)
    v_mfma_f32_16x16x32_bf16 v[78:81], v[18:21], v[126:129], v[78:81]
    v_mfma_f32_16x16x32_bf16 v[82:85], v[18:21], v[130:133], v[82:85]
    v_mfma_f32_16x16x32_bf16 v[86:89], v[18:21], v[134:137], v[86:89]
    v_mfma_f32_16x16x32_bf16 v[90:93], v[18:21], v[138:141], v[90:93]
    ds_read_b128 v[126:129], v6 offset:640
    ds_read_b128 v[130:133], v6 offset:25216
    ds_read_b128 v[134:137], v6 offset:49792
    v_add_u32 v3, 73728, v6
    ds_read_b128 v[138:141], v3 offset:640
    s_waitcnt vmcnt(13) lgkmcnt(4)
    v_mfma_f32_16x16x32_bf16 v[78:81], v[22:25], v[110:113], v[78:81]
    v_mfma_f32_16x16x32_bf16 v[82:85], v[22:25], v[114:117], v[82:85]
    v_mfma_f32_16x16x32_bf16 v[86:89], v[22:25], v[118:121], v[86:89]
    v_mfma_f32_16x16x32_bf16 v[90:93], v[22:25], v[122:125], v[90:93]
    ds_read_b128 v[110:113], v7 offset:768
    ds_read_b128 v[114:117], v7 offset:25344
    ds_read_b128 v[118:121], v7 offset:49920
    v_add_u32 v3, 73728, v7
    ds_read_b128 v[122:125], v3 offset:768
    s_waitcnt vmcnt(12) lgkmcnt(4)
    v_mfma_f32_16x16x32_bf16 v[78:81], v[26:29], v[126:129], v[78:81]
    v_mfma_f32_16x16x32_bf16 v[82:85], v[26:29], v[130:133], v[82:85]
    v_mfma_f32_16x16x32_bf16 v[86:89], v[26:29], v[134:137], v[86:89]
    v_mfma_f32_16x16x32_bf16 v[90:93], v[26:29], v[138:141], v[90:93]
    ds_read_b128 v[126:129], v6 offset:768
    ds_read_b128 v[130:133], v6 offset:25344
    ds_read_b128 v[134:137], v6 offset:49920
    v_add_u32 v3, 73728, v6
    ds_read_b128 v[138:141], v3 offset:768
    s_waitcnt vmcnt(11) lgkmcnt(4)
    v_mfma_f32_16x16x32_bf16 v[78:81], v[30:33], v[110:113], v[78:81]
    v_mfma_f32_16x16x32_bf16 v[82:85], v[30:33], v[114:117], v[82:85]
    v_mfma_f32_16x16x32_bf16 v[86:89], v[30:33], v[118:121], v[86:89]
    v_mfma_f32_16x16x32_bf16 v[90:93], v[30:33], v[122:125], v[90:93]
    ds_read_b128 v[110:113], v7 offset:896
    ds_read_b128 v[114:117], v7 offset:25472
    ds_read_b128 v[118:121], v7 offset:50048
    v_add_u32 v3, 73728, v7
    ds_read_b128 v[122:125], v3 offset:896
    s_waitcnt vmcnt(10) lgkmcnt(4)
    v_mfma_f32_16x16x32_bf16 v[78:81], v[34:37], v[126:129], v[78:81]
    v_mfma_f32_16x16x32_bf16 v[82:85], v[34:37], v[130:133], v[82:85]
    v_mfma_f32_16x16x32_bf16 v[86:89], v[34:37], v[134:137], v[86:89]
    v_mfma_f32_16x16x32_bf16 v[90:93], v[34:37], v[138:141], v[90:93]
    ds_read_b128 v[126:129], v6 offset:896
    ds_read_b128 v[130:133], v6 offset:25472
    ds_read_b128 v[134:137], v6 offset:50048
    v_add_u32 v3, 73728, v6
    ds_read_b128 v[138:141], v3 offset:896
    s_waitcnt vmcnt(9) lgkmcnt(4)
    v_mfma_f32_16x16x32_bf16 v[78:81], v[38:41], v[110:113], v[78:81]
    v_mfma_f32_16x16x32_bf16 v[82:85], v[38:41], v[114:117], v[82:85]
    v_mfma_f32_16x16x32_bf16 v[86:89], v[38:41], v[118:121], v[86:89]
    v_mfma_f32_16x16x32_bf16 v[90:93], v[38:41], v[122:125], v[90:93]
    ds_read_b128 v[110:113], v7 offset:1024
    ds_read_b128 v[114:117], v7 offset:25600
    ds_read_b128 v[118:121], v7 offset:50176
    v_add_u32 v3, 73728, v7
    ds_read_b128 v[122:125], v3 offset:1024
    s_waitcnt vmcnt(8) lgkmcnt(4)
    v_mfma_f32_16x16x32_bf16 v[78:81], v[42:45], v[126:129], v[78:81]
    v_mfma_f32_16x16x32_bf16 v[82:85], v[42:45], v[130:133], v[82:85]
    v_mfma_f32_16x16x32_bf16 v[86:89], v[42:45], v[134:137], v[86:89]
    v_mfma_f32_16x16x32_bf16 v[90:93], v[42:45], v[138:141], v[90:93]
    ds_read_b128 v[126:129], v6 offset:1024
    ds_read_b128 v[130:133], v6 offset:25600
    ds_read_b128 v[134:137], v6 offset:50176
    v_add_u32 v3, 73728, v6
    ds_read_b128 v[138:141], v3 offset:1024
    s_waitcnt vmcnt(7) lgkmcnt(4)
    v_mfma_f32_16x16x32_bf16 v[78:81], v[46:49], v[110:113], v[78:81]
    v_mfma_f32_16x16x32_bf16 v[82:85], v[46:49], v[114:117], v[82:85]
    v_mfma_f32_16x16x32_bf16 v[86:89], v[46:49], v[118:121], v[86:89]
    v_mfma_f32_16x16x32_bf16 v[90:93], v[46:49], v[122:125], v[90:93]
    ds_read_b128 v[110:113], v7 offset:1152
    ds_read_b128 v[114:117], v7 offset:25728
    ds_read_b128 v[118:121], v7 offset:50304
    v_add_u32 v3, 73728, v7
    ds_read_b128 v[122:125], v3 offset:1152
    s_waitcnt vmcnt(6) lgkmcnt(4)
    v_mfma_f32_16x16x32_bf16 v[78:81], v[50:53], v[126:129], v[78:81]
    v_mfma_f32_16x16x32_bf16 v[82:85], v[50:53], v[130:133], v[82:85]
    v_mfma_f32_16x16x32_bf16 v[86:89], v[50:53], v[134:137], v[86:89]
    v_mfma_f32_16x16x32_bf16 v[90:93], v[50:53], v[138:141], v[90:93]
    ds_read_b128 v[126:129], v6 offset:1152
    ds_read_b128 v[130:133], v6 offset:25728
    ds_read_b128 v[134:137], v6 offset:50304
    v_add_u32 v3, 73728, v6
    ds_read_b128 v[138:141], v3 offset:1152
    s_waitcnt vmcnt(5) lgkmcnt(4)
    v_mfma_f32_16x16x32_bf16 v[78:81], v[54:57], v[110:113], v[78:81]
    v_mfma_f32_16x16x32_bf16 v[82:85], v[54:57], v[114:117], v[82:85]
    v_mfma_f32_16x16x32_bf16 v[86:89], v[54:57], v[118:121], v[86:89]
    v_mfma_f32_16x16x32_bf16 v[90:93], v[54:57], v[122:125], v[90:93]
    ds_read_b128 v[110:113], v7 offset:1280
    ds_read_b128 v[114:117], v7 offset:25856
    ds_read_b128 v[118:121], v7 offset:50432
    v_add_u32 v3, 73728, v7
    ds_read_b128 v[122:125], v3 offset:1280
    s_waitcnt vmcnt(4) lgkmcnt(4)
    v_mfma_f32_16x16x32_bf16 v[78:81], v[58:61], v[126:129], v[78:81]
    v_mfma_f32_16x16x32_bf16 v[82:85], v[58:61], v[130:133], v[82:85]
    v_mfma_f32_16x16x32_bf16 v[86:89], v[58:61], v[134:137], v[86:89]
    v_mfma_f32_16x16x32_bf16 v[90:93], v[58:61], v[138:141], v[90:93]
    ds_read_b128 v[126:129], v6 offset:1280
    ds_read_b128 v[130:133], v6 offset:25856
    ds_read_b128 v[134:137], v6 offset:50432
    v_add_u32 v3, 73728, v6
    ds_read_b128 v[138:141], v3 offset:1280
    s_waitcnt vmcnt(3) lgkmcnt(4)
    v_mfma_f32_16x16x32_bf16 v[78:81], v[62:65], v[110:113], v[78:81]
    v_mfma_f32_16x16x32_bf16 v[82:85], v[62:65], v[114:117], v[82:85]
    v_mfma_f32_16x16x32_bf16 v[86:89], v[62:65], v[118:121], v[86:89]
    v_mfma_f32_16x16x32_bf16 v[90:93], v[62:65], v[122:125], v[90:93]
    ds_read_b128 v[110:113], v7 offset:1408
    ds_read_b128 v[114:117], v7 offset:25984
    ds_read_b128 v[118:121], v7 offset:50560
    v_add_u32 v3, 73728, v7
    ds_read_b128 v[122:125], v3 offset:1408
    s_waitcnt vmcnt(2) lgkmcnt(4)
    v_mfma_f32_16x16x32_bf16 v[78:81], v[66:69], v[126:129], v[78:81]
    v_mfma_f32_16x16x32_bf16 v[82:85], v[66:69], v[130:133], v[82:85]
    v_mfma_f32_16x16x32_bf16 v[86:89], v[66:69], v[134:137], v[86:89]
    v_mfma_f32_16x16x32_bf16 v[90:93], v[66:69], v[138:141], v[90:93]
    ds_read_b128 v[126:129], v6 offset:1408
    ds_read_b128 v[130:133], v6 offset:25984
    ds_read_b128 v[134:137], v6 offset:50560
    v_add_u32 v3, 73728, v6
    ds_read_b128 v[138:141], v3 offset:1408
    s_waitcnt vmcnt(1) lgkmcnt(4)
    v_mfma_f32_16x16x32_bf16 v[78:81], v[70:73], v[110:113], v[78:81]
    v_mfma_f32_16x16x32_bf16 v[82:85], v[70:73], v[114:117], v[82:85]
    v_mfma_f32_16x16x32_bf16 v[86:89], v[70:73], v[118:121], v[86:89]
    v_mfma_f32_16x16x32_bf16 v[90:93], v[70:73], v[122:125], v[90:93]
    s_waitcnt vmcnt(0) lgkmcnt(0)
    v_mfma_f32_16x16x32_bf16 v[78:81], v[74:77], v[126:129], v[78:81]
    v_mfma_f32_16x16x32_bf16 v[82:85], v[74:77], v[130:133], v[82:85]
    v_mfma_f32_16x16x32_bf16 v[86:89], v[74:77], v[134:137], v[86:89]
    v_mfma_f32_16x16x32_bf16 v[90:93], v[74:77], v[138:141], v[90:93]
    s_nop 7
    s_nop 7
    v_lshlrev_b32 v110, 16, v94
    v_add_f32 v78, v78, v110
    v_lshlrev_b32 v110, 16, v102
    v_add_f32 v78, v78, v110
    v_and_b32 v110, 0xffff0000, v94
    v_add_f32 v79, v79, v110
    v_and_b32 v110, 0xffff0000, v102
    v_add_f32 v79, v79, v110
    v_lshlrev_b32 v110, 16, v95
    v_add_f32 v80, v80, v110
    v_lshlrev_b32 v110, 16, v103
    v_add_f32 v80, v80, v110
    v_and_b32 v110, 0xffff0000, v95
    v_add_f32 v81, v81, v110
    v_and_b32 v110, 0xffff0000, v103
    v_add_f32 v81, v81, v110
    v_cvt_pk_bf16_f32 v78, v78, v79
    v_cvt_pk_bf16_f32 v79, v80, v81
    s_mov_b32 s34, 0
    buffer_store_dwordx2 v[78:79], v5, s[16:19], s34 offen
    v_lshlrev_b32 v110, 16, v96
    v_add_f32 v82, v82, v110
    v_lshlrev_b32 v110, 16, v104
    v_add_f32 v82, v82, v110
    v_and_b32 v110, 0xffff0000, v96
    v_add_f32 v83, v83, v110
    v_and_b32 v110, 0xffff0000, v104
    v_add_f32 v83, v83, v110
    v_lshlrev_b32 v110, 16, v97
    v_add_f32 v84, v84, v110
    v_lshlrev_b32 v110, 16, v105
    v_add_f32 v84, v84, v110
    v_and_b32 v110, 0xffff0000, v97
    v_add_f32 v85, v85, v110
    v_and_b32 v110, 0xffff0000, v105
    v_add_f32 v85, v85, v110
    v_cvt_pk_bf16_f32 v82, v82, v83
    v_cvt_pk_bf16_f32 v83, v84, v85
    s_mov_b32 s34, 20480
    buffer_store_dwordx2 v[82:83], v5, s[16:19], s34 offen
    v_lshlrev_b32 v110, 16, v98
    v_add_f32 v86, v86, v110
    v_lshlrev_b32 v110, 16, v106
    v_add_f32 v86, v86, v110
    v_and_b32 v110, 0xffff0000, v98
    v_add_f32 v87, v87, v110
    v_and_b32 v110, 0xffff0000, v106
    v_add_f32 v87, v87, v110
    v_lshlrev_b32 v110, 16, v99
    v_add_f32 v88, v88, v110
    v_lshlrev_b32 v110, 16, v107
    v_add_f32 v88, v88, v110
    v_and_b32 v110, 0xffff0000, v99
    v_add_f32 v89, v89, v110
    v_and_b32 v110, 0xffff0000, v107
    v_add_f32 v89, v89, v110
    v_cvt_pk_bf16_f32 v86, v86, v87
    v_cvt_pk_bf16_f32 v87, v88, v89
    s_mov_b32 s34, 40960
    buffer_store_dwordx2 v[86:87], v5, s[16:19], s34 offen
    v_lshlrev_b32 v110, 16, v100
    v_add_f32 v90, v90, v110
    v_lshlrev_b32 v110, 16, v108
    v_add_f32 v90, v90, v110
    v_and_b32 v110, 0xffff0000, v100
    v_add_f32 v91, v91, v110
    v_and_b32 v110, 0xffff0000, v108
    v_add_f32 v91, v91, v110
    v_lshlrev_b32 v110, 16, v101
    v_add_f32 v92, v92, v110
    v_lshlrev_b32 v110, 16, v109
    v_add_f32 v92, v92, v110
    v_and_b32 v110, 0xffff0000, v101
    v_add_f32 v93, v93, v110
    v_and_b32 v110, 0xffff0000, v109
    v_add_f32 v93, v93, v110
    v_cvt_pk_bf16_f32 v90, v90, v91
    v_cvt_pk_bf16_f32 v91, v92, v93
    s_mov_b32 s34, 61440
    buffer_store_dwordx2 v[90:91], v5, s[16:19], s34 offen
mlp2_done:
    s_endpgm
.section .rodata,"a"
.p2align 6
.amdhsa_kernel prep_kernel
  .amdhsa_next_free_vgpr 32
  .amdhsa_next_free_sgpr 102
  .amdhsa_accum_offset 32
  .amdhsa_group_segment_fixed_size 0
  .amdhsa_kernarg_size 88
  .amdhsa_user_sgpr_count 2
  .amdhsa_user_sgpr_kernarg_segment_ptr 1
  .amdhsa_system_sgpr_workgroup_id_x 1
.end_amdhsa_kernel
.p2align 6
.amdhsa_kernel qq_kernel
  .amdhsa_next_free_vgpr 256
  .amdhsa_next_free_sgpr 102
  .amdhsa_accum_offset 256
  .amdhsa_group_segment_fixed_size 0
  .amdhsa_kernarg_size 88
  .amdhsa_user_sgpr_count 2
  .amdhsa_user_sgpr_kernarg_segment_ptr 1
  .amdhsa_system_sgpr_workgroup_id_x 1
.end_amdhsa_kernel
.p2align 6
.amdhsa_kernel kv_kernel
  .amdhsa_next_free_vgpr 256
  .amdhsa_next_free_sgpr 102
  .amdhsa_accum_offset 256
  .amdhsa_group_segment_fixed_size 0
  .amdhsa_kernarg_size 88
  .amdhsa_user_sgpr_count 2
  .amdhsa_user_sgpr_kernarg_segment_ptr 1
  .amdhsa_system_sgpr_workgroup_id_x 1
.end_amdhsa_kernel
.p2align 6
.amdhsa_kernel red_kernel
  .amdhsa_next_free_vgpr 64
  .amdhsa_next_free_sgpr 102
  .amdhsa_accum_offset 64
  .amdhsa_group_segment_fixed_size 0
  .amdhsa_kernarg_size 88
  .amdhsa_user_sgpr_count 2
  .amdhsa_user_sgpr_kernarg_segment_ptr 1
  .amdhsa_system_sgpr_workgroup_id_x 1
.end_amdhsa_kernel
.p2align 6
.amdhsa_kernel attn_kernel
  .amdhsa_next_free_vgpr 256
  .amdhsa_next_free_sgpr 102
  .amdhsa_accum_offset 256
  .amdhsa_group_segment_fixed_size 0
  .amdhsa_kernarg_size 88
  .amdhsa_user_sgpr_count 2
  .amdhsa_user_sgpr_kernarg_segment_ptr 1
  .amdhsa_system_sgpr_workgroup_id_x 1
.end_amdhsa_kernel
.p2align 6
.amdhsa_kernel mix1_kernel
  .amdhsa_next_free_vgpr 256
  .amdhsa_next_free_sgpr 102
  .amdhsa_accum_offset 256
  .amdhsa_group_segment_fixed_size 0
  .amdhsa_kernarg_size 88
  .amdhsa_user_sgpr_count 2
  .amdhsa_user_sgpr_kernarg_segment_ptr 1
  .amdhsa_system_sgpr_workgroup_id_x 1
.end_amdhsa_kernel
.p2align 6
.amdhsa_kernel mix2_kernel
  .amdhsa_next_free_vgpr 256
  .amdhsa_next_free_sgpr 102
  .amdhsa_accum_offset 256
  .amdhsa_group_segment_fixed_size 0
  .amdhsa_kernarg_size 88
  .amdhsa_user_sgpr_count 2
  .amdhsa_user_sgpr_kernarg_segment_ptr 1
  .amdhsa_system_sgpr_workgroup_id_x 1
.end_amdhsa_kernel
.p2align 6
.amdhsa_kernel mlp1_kernel
  .amdhsa_next_free_vgpr 256
  .amdhsa_next_free_sgpr 102
  .amdhsa_accum_offset 256
  .amdhsa_group_segment_fixed_size 0
  .amdhsa_kernarg_size 88
  .amdhsa_user_sgpr_count 2
  .amdhsa_user_sgpr_kernarg_segment_ptr 1
  .amdhsa_system_sgpr_workgroup_id_x 1
.end_amdhsa_kernel
.p2align 6
.amdhsa_kernel mlp2_kernel
  .amdhsa_next_free_vgpr 256
  .amdhsa_next_free_sgpr 102
  .amdhsa_accum_offset 256
  .amdhsa_group_segment_fixed_size 0
  .amdhsa_kernarg_size 88
  .amdhsa_user_sgpr_count 2
  .amdhsa_user_sgpr_kernarg_segment_ptr 1
  .amdhsa_system_sgpr_workgroup_id_x 1
.end_amdhsa_kernel
```
